```python
import torch

def _softmax(x, axis=-1):
    return torch.softmax(x, dim=axis)
def _gelu(x):
    return torch.nn.functional.gelu(x, approximate="tanh")
def _silu(x):
    return torch.nn.functional.silu(x)
def _sigmoid(x):
    return torch.sigmoid(x)
def _layernorm(x, axis=-1, eps=1e-5):
    m = x.mean(dim=axis, keepdim=True)
    v = x.var(dim=axis, keepdim=True, unbiased=False)
    return (x - m) / torch.sqrt(v + eps)
def _scatter_add(tgt, idx, src, axis=0):
    return tgt.clone().index_add_(axis, idx, src)
def _segment_sum(src, seg, n):
    out = torch.zeros((n,) + src.shape[1:], dtype=src.dtype)
    return out.index_add_(0, seg, src)
def _pad(x, pw):
    flat = tuple(v for pair in reversed(pw) for v in pair)
    return torch.nn.functional.pad(x, flat)

kernel_name = 'interleave_layers__sliding_block__glu_gated_bilinear__prompt'

def setup_inputs():

    _w = (lambda a: (lambda t: t.to(torch.bfloat16) if t.is_floating_point() else t)(torch.as_tensor(a)))
    def _A_setup():
        B, S, D = 1, 2048, 640
        return {
            "x": _w((lambda *s: torch.randn(*s, dtype=torch.bfloat16) * 0.05)(B, S, D)),
            "wqkv": _w((lambda *s: torch.randn(*s, dtype=torch.bfloat16) * 0.05)(D, 3 * D)),
            "wo": _w((lambda *s: torch.randn(*s, dtype=torch.bfloat16) * 0.05)(D, D)),
        }
    _A_in = _A_setup()

    def _B_setup():
        B, S, D, F = 1, 2048, 640, 1728
        return {
            "x": _w((lambda *s: torch.randn(*s, dtype=torch.bfloat16) * 0.05)(B, S, D)),
            "w_gate": _w((lambda *s: torch.randn(*s, dtype=torch.bfloat16) * 0.8)(D, F) * (D ** -0.5)),
            "w_up": _w((lambda *s: torch.randn(*s, dtype=torch.bfloat16) * 0.8)(D, F) * (D ** -0.5)),
            "w_down": _w((lambda *s: torch.randn(*s, dtype=torch.bfloat16) * 0.8)(F, D) * (F ** -0.5)),
        }
    _B_in = _B_setup()

    return {
        "A_x": _A_in["x"],
        "A_wqkv": _A_in["wqkv"],
        "A_wo": _A_in["wo"],
        "B_x": _B_in["x"],
        "B_w_gate": _B_in["w_gate"],
        "B_w_up": _B_in["w_up"],
        "B_w_down": _B_in["w_down"],
    }

def reference(A_x, A_wqkv, A_wo, B_x, B_w_gate, B_w_up, B_w_down):
    def _A_ref(x, wqkv, wo):
        B, S, D = x.shape
        H = 32; Dh = D // H; W = 256
        qkv = (lambda x, *d: x.permute(*d))((x @ wqkv).reshape(B, S, 3, H, Dh), 2, 0, 3, 1, 4)
        q, k, v = qkv[0], qkv[1], qkv[2]
        scores = torch.einsum("bhqd,bhkd->bhqk", q, k) * (Dh ** -0.5)
        idx = torch.arange(S)
        mask = (idx[:, None] - idx[None, :] >= 0) & (idx[:, None] - idx[None, :] < W)
        scores = torch.where(mask[None, None], scores, -1e9)
        p = _softmax(scores, axis=-1)
        o = torch.einsum("bhqk,bhkd->bhqd", p, v)
        return (lambda x, *d: x.permute(*d))(o, 0, 2, 1, 3).reshape(B, S, D) @ wo

    def _B_ref(x, w_gate, w_up, w_down):
        g = torch.einsum("bsd,df->bsf", x, w_gate)
        u = torch.einsum("bsd,df->bsf", x, w_up)
        h = g * u
        return torch.einsum("bsf,fd->bsd", h, w_down)

    x = A_x
    x = x + _A_ref(_layernorm(x, axis=-1), A_wqkv, A_wo)
    x = x + _B_ref(_layernorm(x, axis=-1), B_w_gate, B_w_up, B_w_down)
    x = x + _A_ref(_layernorm(x, axis=-1), A_wqkv, A_wo)
    x = x + _B_ref(_layernorm(x, axis=-1), B_w_gate, B_w_up, B_w_down)
    return x
```

```asm
; @launch grid=(256,1,1) block=(512,1,1) lds=163840
.amdgcn_target "amdgcn-amd-amdhsa--gfx950"
.text
.globl interleave_layers__sliding_block__glu_gated_bilinear__prompt_kernel
.p2align 8
.type interleave_layers__sliding_block__glu_gated_bilinear__prompt_kernel,@function
interleave_layers__sliding_block__glu_gated_bilinear__prompt_kernel:
  s_cmp_lt_u32 s2, 256
  s_cbranch_scc1 L_go
  s_endpgm
L_go:
  s_load_dwordx4 s[36:39], s[0:1], 0
  s_load_dwordx2 s[40:41], s[0:1], 16
  s_load_dwordx4 s[44:47], s[0:1], 32
  s_load_dwordx4 s[48:51], s[0:1], 48
  s_load_dwordx4 s[52:55], s[0:1], 64
  v_and_b32 v254, 63, v0
  v_lshrrev_b32 v1, 6, v0
  v_lshlrev_b32 v255, 4, v254
  v_readfirstlane_b32 s5, v1
  s_and_b32 s3, s2, 7
  s_lshl_b32 s3, s3, 1
  s_lshr_b32 s78, s2, 7
  s_add_u32 s3, s3, s78
  s_lshr_b32 s4, s2, 3
  s_and_b32 s4, s4, 15
  s_lshr_b32 s95, s2, 3
  s_and_b32 s67, s4, 7
  s_lshr_b32 s68, s4, 3
  s_mul_i32 s69, s4, 27
  s_lshr_b32 s69, s69, 2
  s_mov_b32 s6, 0
  s_mov_b32 s66, 0
  s_mov_b32 s7, 0
  s_mov_b32 s64, 0
  s_mov_b32 s65, -1
  s_lshl_b32 s78, s3, 2
  s_and_b32 s79, s5, 3
  s_add_u32 s78, s78, s79
  s_add_u32 s79, s78, 0
  s_cmp_lt_u32 s79, 8
  s_cselect_b32 s70, 0xc700, 0
  s_add_u32 s79, s78, 1
  s_cmp_lt_u32 s79, 8
  s_cselect_b32 s71, 0xc700, 0
  s_add_u32 s79, s78, 2
  s_cmp_lt_u32 s79, 8
  s_cselect_b32 s72, 0xc700, 0
  s_add_u32 s79, s78, 3
  s_cmp_lt_u32 s79, 8
  s_cselect_b32 s73, 0xc700, 0
  s_add_u32 s79, s78, 4
  s_cmp_lt_u32 s79, 8
  s_cselect_b32 s74, 0xc700, 0
  s_add_u32 s79, s78, 5
  s_cmp_lt_u32 s79, 8
  s_cselect_b32 s75, 0xc700, 0
  s_add_u32 s79, s78, 6
  s_cmp_lt_u32 s79, 8
  s_cselect_b32 s76, 0xc700, 0
  s_add_u32 s79, s78, 7
  s_cmp_lt_u32 s79, 8
  s_cselect_b32 s77, 0xc700, 0
  s_waitcnt lgkmcnt(0)
  s_mov_b32 s8, s54
  s_and_b32 s9, s55, 0xffff
  s_mov_b32 s10, 268435456
  s_mov_b32 s11, 0x20000
  s_mov_b32 s28, s52
  s_and_b32 s29, s53, 0xffff
  s_mov_b32 s30, 256
  s_mov_b32 s31, 0x20000
  s_mov_b32 s24, s50
  s_and_b32 s25, s51, 0xffff
  s_mov_b32 s26, 2621440
  s_mov_b32 s27, 0x20000
  s_and_b32 s92, s3, 3
  s_lshr_b32 s93, s3, 2
  s_lshr_b32 s85, s3, 1
  s_and_b32 s86, s3, 1
  s_lshl_b32 s86, s86, 4
  s_add_u32 s86, s86, s4
  s_lshr_b32 s87, s85, 1
  s_mul_i32 s94, s87, 37
  s_and_b32 s87, s85, 1
  s_mul_i32 s88, s87, 18
  s_add_u32 s94, s94, s88
  s_lshr_b32 s88, s86, 3
  s_lshl_b32 s89, s88, 2
  s_add_u32 s94, s94, s89
  s_add_u32 s87, s87, 6
  s_cmp_lt_u32 s88, 3
  s_cselect_b32 s90, 4, s87
  s_mul_i32 s0, s85, 27
  s_add_u32 s0, s0, s86
  s_and_b32 s1, s0, 1
  s_lshr_b32 s0, s0, 1
  s_cmp_lt_u32 s86, 27
  s_cselect_b32 s0, s0, 255
  s_cmp_ge_u32 s5, 4
  s_cbranch_scc1 L_p0h_1
  s_mov_b32 s16, s38
  s_and_b32 s17, s39, 0xffff
  s_mov_b32 s18, 2457600
  s_mov_b32 s19, 0x20000
  s_mov_b32 s12, s36
  s_and_b32 s13, s37, 0xffff
  s_mov_b32 s14, 2621440
  s_mov_b32 s15, 0x20000
  v_and_b32 v1, 3, v254
  s_lshl_b32 s85, s92, 2
  v_add_u32 v1, s85, v1
  v_mul_u32_u24 v2, 820, v1
  v_lshrrev_b32 v2, 12, v2
  v_mul_u32_u24 v3, 5, v2
  v_sub_u32 v3, v1, v3
  v_add_u32 v4, 1, v2
  v_mul_u32_u24 v4, 1280, v4
  v_mov_b32 v5, 0
  v_cmp_eq_u32 vcc, 2, v2
  s_nop 1
  v_cndmask_b32 v4, v4, v5, vcc
  v_lshl_add_u32 v4, v3, 4, v4
  v_lshrrev_b32 v3, 2, v254
  v_mul_u32_u24 v3, 3840, v3
  v_add_u32 v4, v4, v3
  s_mul_i32 s85, s4, 80
  v_add_u32 v4, s85, v4
  v_mov_b32 v5, 0x40000000
  v_cmp_eq_u32 vcc, 15, v1
  s_nop 1
  v_cndmask_b32 v10, v4, v5, vcc
  s_mul_i32 s86, s5, 3
  s_min_u32 s86, s86, 8
  s_mul_i32 s85, s93, 10
  s_add_u32 s85, s85, s86
  s_mul_i32 s85, s85, 61440
  s_lshl_b32 s87, s86, 10
  s_add_u32 m0, s87, 0
  s_nop 0
  buffer_load_dwordx4 v10, s[16:19], s85 offen nt lds
  s_add_u32 s85, s85, 61440
  s_add_u32 m0, s87, 1024
  s_nop 0
  buffer_load_dwordx4 v10, s[16:19], s85 offen nt lds
  s_add_u32 s85, s85, 61440
  s_cmp_lt_u32 s5, 2
  s_cbranch_scc0 L_q2_3
  s_add_u32 m0, s87, 2048
  s_nop 0
  buffer_load_dwordx4 v10, s[16:19], s85 offen nt lds
  s_add_u32 s85, s85, 61440
L_q2_3:
  s_and_b32 s87, s4, 3
  s_mul_i32 s87, s87, 10
  s_add_u32 s87, s87, s86
  s_lshr_b32 s88, s4, 2
  s_lshl_b32 s89, s3, 7
  s_lshl_b32 s91, s88, 5
  s_add_u32 s89, s89, s91
  v_and_b32 v1, 31, v254
  v_add_u32 v1, s89, v1
  v_mul_u32_u24 v1, 1280, v1
  v_lshrrev_b32 v2, 5, v254
  v_lshl_add_u32 v1, v2, 4, v1
  s_lshl_b32 s89, s87, 5
  buffer_load_dwordx4 v[100:103], v1, s[12:15], s89 offen nt
  buffer_load_dwordx4 v[104:107], v1, s[12:15], s89 offen offset:32 nt
  s_cmp_lt_u32 s5, 2
  s_cselect_b32 s91, 0, 0x40000000
  v_add_u32 v3, s91, v1
  buffer_load_dwordx4 v[108:111], v3, s[12:15], s89 offen offset:64 nt
  s_mov_b32 s83, s86
  s_mov_b32 s86, s83
  v_bfe_u32 v1, v254, 2, 2
  v_and_b32 v2, 3, v254
  v_bfe_u32 v3, v254, 4, 1
  v_lshrrev_b32 v4, 5, v254
  v_lshl_add_u32 v1, v4, 3, v1
  v_lshlrev_b32 v1, 6, v1
  v_lshl_add_u32 v1, v3, 5, v1
  v_lshl_add_u32 v20, v2, 3, v1
  s_lshl_b32 s89, s86, 10
  v_add_u32 v20, s89, v20
  s_mul_i32 s85, s93, 10
  s_add_u32 s85, s85, s86
  s_lshl_b32 s85, s85, 12
  s_lshl_b32 s89, s92, 10
  s_add_u32 s85, s85, s89
  s_mul_i32 s89, s4, 163840
  s_add_u32 s85, s85, s89
  s_add_u32 s85, s85, 52428800
  v_and_b32 v1, 31, v254
  v_lshrrev_b32 v2, 5, v254
  v_lshlrev_b32 v2, 2, v2
  v_sub_u32 v1, v1, v2
  v_cmp_le_i32 s[32:33], 0, v1
  v_cmp_le_i32 s[34:35], 1, v1
  v_cmp_le_i32 s[36:37], 2, v1
  v_cmp_le_i32 s[38:39], 3, v1
  v_cmp_le_i32 s[40:41], 8, v1
  v_cmp_le_i32 s[42:43], 9, v1
  v_cmp_le_i32 s[44:45], 10, v1
  v_cmp_le_i32 s[46:47], 11, v1
  v_cmp_le_i32 s[48:49], 16, v1
  v_cmp_le_i32 s[50:51], 17, v1
  v_cmp_le_i32 s[52:53], 18, v1
  v_cmp_le_i32 s[54:55], 19, v1
  v_cmp_le_i32 s[56:57], 24, v1
  v_cmp_le_i32 s[58:59], 25, v1
  v_cmp_le_i32 s[60:61], 26, v1
  v_cmp_le_i32 s[62:63], 27, v1
  s_barrier
  s_waitcnt vmcnt(0)
  ds_read_b64_tr_b16 v[24:25], v20 offset:0
  ds_read_b64_tr_b16 v[26:27], v20 offset:256
  ds_read_b64_tr_b16 v[28:29], v20 offset:1024
  ds_read_b64_tr_b16 v[30:31], v20 offset:1280
  ds_read_b64_tr_b16 v[32:33], v20 offset:2048
  ds_read_b64_tr_b16 v[34:35], v20 offset:2304
  s_mul_i32 s89, s3, 163840
  s_mul_i32 s91, s88, 40960
  s_add_u32 s89, s89, s91
  s_lshl_b32 s91, s87, 10
  s_add_u32 s89, s89, s91
  s_add_u32 s89, s89, 25165824
  buffer_store_dwordx4 v[100:103], v255, s[8:11], s89 offen sc1
  buffer_store_dwordx4 v[104:107], v255, s[8:11], s89 offen offset:1024 sc1
  s_cmp_lt_u32 s5, 2
  s_cbranch_scc0 L_n3_4
  buffer_store_dwordx4 v[108:111], v255, s[8:11], s89 offen offset:2048 sc1
L_n3_4:
  v_mov_b32 v40, 0
  v_mov_b32 v41, 0
  s_waitcnt lgkmcnt(0)
  buffer_store_dwordx4 v[24:27], v255, s[8:11], s85 offen sc1
  s_add_u32 s85, s85, 4096
  v_lshlrev_b32 v4, 16, v24
  v_and_b32 v5, 0xffff0000, v24
  v_pk_add_f32 v[40:41], v[40:41], v[4:5]
  v_lshlrev_b32 v4, 16, v25
  v_and_b32 v5, 0xffff0000, v25
  v_pk_add_f32 v[40:41], v[40:41], v[4:5]
  v_lshlrev_b32 v4, 16, v26
  v_and_b32 v5, 0xffff0000, v26
  v_pk_add_f32 v[40:41], v[40:41], v[4:5]
  v_lshlrev_b32 v4, 16, v27
  v_and_b32 v5, 0xffff0000, v27
  v_pk_add_f32 v[40:41], v[40:41], v[4:5]
  buffer_store_dwordx4 v[28:31], v255, s[8:11], s85 offen sc1
  s_add_u32 s85, s85, 4096
  v_lshlrev_b32 v4, 16, v28
  v_and_b32 v5, 0xffff0000, v28
  v_pk_add_f32 v[40:41], v[40:41], v[4:5]
  v_lshlrev_b32 v4, 16, v29
  v_and_b32 v5, 0xffff0000, v29
  v_pk_add_f32 v[40:41], v[40:41], v[4:5]
  v_lshlrev_b32 v4, 16, v30
  v_and_b32 v5, 0xffff0000, v30
  v_pk_add_f32 v[40:41], v[40:41], v[4:5]
  v_lshlrev_b32 v4, 16, v31
  v_and_b32 v5, 0xffff0000, v31
  v_pk_add_f32 v[40:41], v[40:41], v[4:5]
  s_cmp_lt_u32 s5, 2
  s_cbranch_scc0 L_q3_5
  buffer_store_dwordx4 v[32:35], v255, s[8:11], s85 offen sc1
  s_add_u32 s85, s85, 4096
  v_lshlrev_b32 v4, 16, v32
  v_and_b32 v5, 0xffff0000, v32
  v_pk_add_f32 v[40:41], v[40:41], v[4:5]
  v_lshlrev_b32 v4, 16, v33
  v_and_b32 v5, 0xffff0000, v33
  v_pk_add_f32 v[40:41], v[40:41], v[4:5]
  v_lshlrev_b32 v4, 16, v34
  v_and_b32 v5, 0xffff0000, v34
  v_pk_add_f32 v[40:41], v[40:41], v[4:5]
  v_lshlrev_b32 v4, 16, v35
  v_and_b32 v5, 0xffff0000, v35
  v_pk_add_f32 v[40:41], v[40:41], v[4:5]
L_q3_5:
  v_add_f32 v40, v40, v41
  v_mov_b32 v41, v40
  s_nop 1
  v_permlane32_swap_b32 v40, v41
  v_add_f32 v40, v40, v41
  s_mul_i32 s85, s4, 32768
  s_lshl_b32 s89, s92, 11
  s_add_u32 s85, s85, s89
  s_lshl_b32 s89, s93, 2
  s_add_u32 s89, s89, s5
  s_lshl_b32 s89, s89, 7
  s_add_u32 s85, s85, s89
  s_add_u32 s85, s85, 1572864
  v_and_b32 v1, 31, v254
  v_lshlrev_b32 v2, 2, v1
  s_mov_b32 exec_hi, 0
  buffer_store_dword v40, v2, s[8:11], s85 offen sc1
  s_mov_b32 exec_hi, -1
  v_mov_b32 v44, 0
  v_mov_b32 v45, 0
  v_mov_b32 v46, 0
  v_mov_b32 v47, 0
  v_lshlrev_b32 v4, 16, v100
  v_and_b32 v5, 0xffff0000, v100
  v_pk_add_f32 v[44:45], v[44:45], v[4:5]
  v_pk_fma_f32 v[46:47], v[4:5], v[4:5], v[46:47]
  v_lshlrev_b32 v4, 16, v101
  v_and_b32 v5, 0xffff0000, v101
  v_pk_add_f32 v[44:45], v[44:45], v[4:5]
  v_pk_fma_f32 v[46:47], v[4:5], v[4:5], v[46:47]
  v_lshlrev_b32 v4, 16, v102
  v_and_b32 v5, 0xffff0000, v102
  v_pk_add_f32 v[44:45], v[44:45], v[4:5]
  v_pk_fma_f32 v[46:47], v[4:5], v[4:5], v[46:47]
  v_lshlrev_b32 v4, 16, v103
  v_and_b32 v5, 0xffff0000, v103
  v_pk_add_f32 v[44:45], v[44:45], v[4:5]
  v_pk_fma_f32 v[46:47], v[4:5], v[4:5], v[46:47]
  v_lshlrev_b32 v4, 16, v104
  v_and_b32 v5, 0xffff0000, v104
  v_pk_add_f32 v[44:45], v[44:45], v[4:5]
  v_pk_fma_f32 v[46:47], v[4:5], v[4:5], v[46:47]
  v_lshlrev_b32 v4, 16, v105
  v_and_b32 v5, 0xffff0000, v105
  v_pk_add_f32 v[44:45], v[44:45], v[4:5]
  v_pk_fma_f32 v[46:47], v[4:5], v[4:5], v[46:47]
  v_lshlrev_b32 v4, 16, v106
  v_and_b32 v5, 0xffff0000, v106
  v_pk_add_f32 v[44:45], v[44:45], v[4:5]
  v_pk_fma_f32 v[46:47], v[4:5], v[4:5], v[46:47]
  v_lshlrev_b32 v4, 16, v107
  v_and_b32 v5, 0xffff0000, v107
  v_pk_add_f32 v[44:45], v[44:45], v[4:5]
  v_pk_fma_f32 v[46:47], v[4:5], v[4:5], v[46:47]
  v_lshlrev_b32 v4, 16, v108
  v_and_b32 v5, 0xffff0000, v108
  v_pk_add_f32 v[44:45], v[44:45], v[4:5]
  v_pk_fma_f32 v[46:47], v[4:5], v[4:5], v[46:47]
  v_lshlrev_b32 v4, 16, v109
  v_and_b32 v5, 0xffff0000, v109
  v_pk_add_f32 v[44:45], v[44:45], v[4:5]
  v_pk_fma_f32 v[46:47], v[4:5], v[4:5], v[46:47]
  v_lshlrev_b32 v4, 16, v110
  v_and_b32 v5, 0xffff0000, v110
  v_pk_add_f32 v[44:45], v[44:45], v[4:5]
  v_pk_fma_f32 v[46:47], v[4:5], v[4:5], v[46:47]
  v_lshlrev_b32 v4, 16, v111
  v_and_b32 v5, 0xffff0000, v111
  v_pk_add_f32 v[44:45], v[44:45], v[4:5]
  v_pk_fma_f32 v[46:47], v[4:5], v[4:5], v[46:47]
  v_add_f32 v44, v44, v45
  v_add_f32 v45, v46, v47
  v_mov_b32 v46, v44
  v_mov_b32 v47, v45
  s_nop 0
  v_permlane32_swap_b32 v44, v46
  v_permlane32_swap_b32 v45, v47
  v_add_f32 v44, v44, v46
  v_add_f32 v45, v45, v47
  s_lshl_b32 s89, s3, 14
  s_lshl_b32 s91, s88, 12
  s_add_u32 s89, s89, s91
  s_and_b32 s91, s4, 3
  s_lshl_b32 s91, s91, 2
  s_add_u32 s91, s91, s5
  s_and_b32 s85, s91, 1
  s_lshl_b32 s85, s85, 3
  s_lshr_b32 s91, s91, 1
  s_lshl_b32 s91, s91, 9
  s_add_u32 s91, s91, s85
  s_add_u32 s89, s89, s91
  s_add_u32 s89, s89, 65536
  v_and_b32 v1, 31, v254
  v_lshlrev_b32 v1, 4, v1
  s_mov_b32 exec_hi, 0
  buffer_store_dwordx2 v[44:45], v1, s[8:11], s89 offen sc1
  s_mov_b32 exec_hi, -1
  s_waitcnt vmcnt(0)
  s_lshl_b32 s85, s3, 4
  s_add_u32 s85, s85, s4
  s_lshl_b32 s85, s85, 7
  s_lshl_b32 s86, s5, 2
  s_add_u32 s85, s85, s86
  s_add_u32 s85, s85, 4112
  v_mov_b32 v4, 1
  v_mov_b32 v5, 0
  s_mov_b64 exec, 1
  buffer_store_dword v4, v5, s[8:11], s85 offen sc1
  s_mov_b64 exec, -1
  s_barrier
  s_branch L_p0j_2
L_p0h_1:
  s_sub_u32 s2, s5, 4
  s_cmp_eq_u32 s5, 7
  s_cbranch_scc0 L_nz_6
  s_mov_b64 exec, 1
  v_mov_b32 v4, 0
  v_mov_b32 v5, 0
  v_mov_b32 v6, 0
  v_mov_b32 v7, 0
  s_lshl_b32 s78, s3, 8
  s_lshl_b32 s79, s4, 4
  s_add_u32 s78, s78, s79
  s_add_u32 s78, s78, 0
  buffer_store_dwordx4 v[4:7], v4, s[8:11], s78 offen sc1
  s_lshl_b32 s78, s3, 4
  s_add_u32 s78, s78, s4
  s_lshl_b32 s78, s78, 7
  s_add_u32 s78, s78, 4096
  buffer_store_dwordx4 v[4:7], v4, s[8:11], s78 offen offset:0 sc1
  buffer_store_dwordx4 v[4:7], v4, s[8:11], s78 offen offset:16 sc1
  buffer_store_dwordx4 v[4:7], v4, s[8:11], s78 offen offset:32 sc1
  buffer_store_dwordx4 v[4:7], v4, s[8:11], s78 offen offset:48 sc1
  s_waitcnt vmcnt(0)
  s_getreg_b32 s78, hwreg(HW_REG_XCC_ID, 0, 4)
  s_add_u32 s78, s78, 1
  v_mov_b32 v4, s78
  s_lshl_b32 s79, s3, 4
  s_add_u32 s79, s79, s4
  v_mov_b32 v5, s79
  buffer_store_byte v4, v5, s[28:31], 0 offen sc1
  s_mov_b64 exec, -1
L_nz_6:
  s_mov_b32 s12, s40
  s_and_b32 s13, s41, 0xffff
  s_mov_b32 s14, 819200
  s_mov_b32 s15, 0x20000
  s_mov_b32 s16, s48
  s_and_b32 s17, s49, 0xffff
  s_mov_b32 s18, 2211840
  s_mov_b32 s19, 0x20000
  v_lshrrev_b32 v1, 1, v254
  v_mul_u32_u24 v1, 3456, v1
  v_and_b32 v2, 1, v254
  v_lshl_add_u32 v1, v2, 4, v1
  s_lshl_b32 s85, s0, 5
  v_add_u32 v11, s85, v1
  s_cmp_lt_u32 s2, 2
  s_cselect_b32 s20, s44, s46
  s_cselect_b32 s21, s45, s47
  s_cselect_b32 s88, 0, 10368
  s_and_b32 s21, s21, 0xffff
  s_mov_b32 s22, 2211840
  s_mov_b32 s23, 0x20000
  v_add_u32 v1, 0, v254
  v_mul_u32_u24 v4, 410, v1
  v_lshrrev_b32 v4, 12, v4
  v_mul_u32_u24 v5, 10, v4
  v_sub_u32 v1, v1, v5
  v_and_b32 v5, 8, v4
  v_bfe_u32 v6, v4, 1, 2
  v_or_b32 v5, v5, v6
  v_and_b32 v6, 1, v4
  v_lshl_or_b32 v5, v6, 2, v5
  s_mul_i32 s85, s67, 160
  v_lshlrev_b32 v1, 4, v1
  v_add_u32 v1, s85, v1
  v_mul_u32_u24 v7, 1280, v5
  v_add_u32 v12, v7, v1
  v_bfe_u32 v8, v5, 2, 1
  v_mul_u32_u24 v7, 40, v8
  v_lshrrev_b32 v8, 3, v5
  v_mad_u32_u24 v7, v8, 20, v7
  v_and_b32 v8, 3, v5
  v_add_u32 v7, v7, v8
  v_add_u32 v7, 16, v7
  v_mul_u32_u24 v7, 1280, v7
  v_add_u32 v15, v7, v1
  v_add_u32 v1, 64, v254
  v_mul_u32_u24 v4, 410, v1
  v_lshrrev_b32 v4, 12, v4
  v_mul_u32_u24 v5, 10, v4
  v_sub_u32 v1, v1, v5
  v_and_b32 v5, 8, v4
  v_bfe_u32 v6, v4, 1, 2
  v_or_b32 v5, v5, v6
  v_and_b32 v6, 1, v4
  v_lshl_or_b32 v5, v6, 2, v5
  s_mul_i32 s85, s67, 160
  v_lshlrev_b32 v1, 4, v1
  v_add_u32 v1, s85, v1
  v_mul_u32_u24 v7, 1280, v5
  v_add_u32 v13, v7, v1
  v_bfe_u32 v8, v5, 2, 1
  v_mul_u32_u24 v7, 40, v8
  v_lshrrev_b32 v8, 3, v5
  v_mad_u32_u24 v7, v8, 20, v7
  v_and_b32 v8, 3, v5
  v_add_u32 v7, v7, v8
  v_add_u32 v7, 16, v7
  v_mul_u32_u24 v7, 1280, v7
  v_add_u32 v16, v7, v1
  v_add_u32 v1, 128, v254
  v_mul_u32_u24 v4, 410, v1
  v_lshrrev_b32 v4, 12, v4
  v_mul_u32_u24 v5, 10, v4
  v_sub_u32 v1, v1, v5
  v_and_b32 v5, 8, v4
  v_bfe_u32 v6, v4, 1, 2
  v_or_b32 v5, v5, v6
  v_and_b32 v6, 1, v4
  v_lshl_or_b32 v5, v6, 2, v5
  s_mul_i32 s85, s67, 160
  v_lshlrev_b32 v1, 4, v1
  v_add_u32 v1, s85, v1
  v_mul_u32_u24 v7, 1280, v5
  v_add_u32 v14, v7, v1
  v_bfe_u32 v8, v5, 2, 1
  v_mul_u32_u24 v7, 40, v8
  v_lshrrev_b32 v8, 3, v5
  v_mad_u32_u24 v7, v8, 20, v7
  v_and_b32 v8, 3, v5
  v_add_u32 v7, v7, v8
  v_add_u32 v7, 16, v7
  v_mul_u32_u24 v7, 1280, v7
  v_add_u32 v17, v7, v1
  v_and_b32 v1, 31, v254
  v_lshrrev_b32 v2, 5, v254
  v_lshlrev_b32 v2, 2, v2
  v_sub_u32 v1, v1, v2
  v_cmp_le_i32 s[32:33], 0, v1
  v_cmp_le_i32 s[34:35], 1, v1
  v_cmp_le_i32 s[36:37], 2, v1
  v_cmp_le_i32 s[38:39], 3, v1
  v_cmp_le_i32 s[40:41], 8, v1
  v_cmp_le_i32 s[42:43], 9, v1
  v_cmp_le_i32 s[44:45], 10, v1
  v_cmp_le_i32 s[46:47], 11, v1
  v_cmp_le_i32 s[48:49], 16, v1
  v_cmp_le_i32 s[50:51], 17, v1
  v_cmp_le_i32 s[52:53], 18, v1
  v_cmp_le_i32 s[54:55], 19, v1
  v_cmp_le_i32 s[56:57], 24, v1
  v_cmp_le_i32 s[58:59], 25, v1
  v_cmp_le_i32 s[60:61], 26, v1
  v_cmp_le_i32 s[62:63], 27, v1
  s_barrier
  s_barrier
  s_cmp_lt_u32 s0, 108
  s_cbranch_scc0 L_ngu_7
  s_and_b32 s86, s2, 1
  s_mul_i32 s86, s86, 5
  s_lshl_b32 s87, s86, 10
  s_add_u32 s87, s87, s88
  s_add_u32 s87, s87, 10240
  s_mul_i32 s85, s1, 10
  s_add_u32 s85, s85, s86
  s_mul_i32 s85, s85, 110592
  s_add_u32 m0, s87, 0
  s_nop 0
  buffer_load_dwordx4 v11, s[20:23], s85 offen nt lds
  s_add_u32 s85, s85, 110592
  s_add_u32 m0, s87, 1024
  s_nop 0
  buffer_load_dwordx4 v11, s[20:23], s85 offen nt lds
  s_add_u32 s85, s85, 110592
  s_add_u32 m0, s87, 2048
  s_nop 0
  buffer_load_dwordx4 v11, s[20:23], s85 offen nt lds
  s_add_u32 s85, s85, 110592
  s_add_u32 m0, s87, 3072
  s_nop 0
  buffer_load_dwordx4 v11, s[20:23], s85 offen nt lds
  s_add_u32 s85, s85, 110592
  s_add_u32 m0, s87, 4096
  s_nop 0
  buffer_load_dwordx4 v11, s[20:23], s85 offen nt lds
  s_add_u32 s85, s85, 110592
L_ngu_7:
  s_add_u32 s87, s2, 0
  s_cmp_ge_u32 s87, s90
  s_cbranch_scc1 L_cs_8
  s_add_u32 s86, s94, s87
  s_mul_i32 s88, s87, 2560
  s_add_u32 s88, s88, 31744
  s_cmp_ge_u32 s86, 40
  s_cbranch_scc1 L_cd_10
  s_cmp_ge_u32 s86, 32
  s_cbranch_scc1 L_ct_9
  s_mul_i32 s91, s86, 25600
  s_add_u32 m0, s88, 0
  s_nop 0
  buffer_load_dwordx4 v12, s[12:15], s91 offen nt lds
  s_add_u32 m0, s88, 1024
  s_nop 0
  buffer_load_dwordx4 v13, s[12:15], s91 offen nt lds
  s_mov_b32 exec_hi, 0
  s_add_u32 m0, s88, 2048
  s_nop 0
  buffer_load_dwordx4 v14, s[12:15], s91 offen nt lds
  s_mov_b32 exec_hi, -1
  s_branch L_cj_11
L_ct_9:
  s_sub_u32 s91, s86, 32
  s_mul_i32 s91, s91, 102400
  s_add_u32 m0, s88, 0
  s_nop 0
  buffer_load_dwordx4 v15, s[12:15], s91 offen nt lds
  s_add_u32 m0, s88, 1024
  s_nop 0
  buffer_load_dwordx4 v16, s[12:15], s91 offen nt lds
  s_mov_b32 exec_hi, 0
  s_add_u32 m0, s88, 2048
  s_nop 0
  buffer_load_dwordx4 v17, s[12:15], s91 offen nt lds
  s_mov_b32 exec_hi, -1
  s_branch L_cj_11
L_cd_10:
  s_sub_u32 s91, s86, 40
  s_mul_i32 s91, s91, 20480
  s_add_u32 m0, s88, 0
  s_nop 0
  buffer_load_dwordx4 v12, s[16:19], s91 offen nt lds
  s_add_u32 m0, s88, 1024
  s_nop 0
  buffer_load_dwordx4 v13, s[16:19], s91 offen nt lds
  s_mov_b32 exec_hi, 0
  s_add_u32 m0, s88, 2048
  s_nop 0
  buffer_load_dwordx4 v14, s[16:19], s91 offen nt lds
  s_mov_b32 exec_hi, -1
L_cj_11:
L_cs_8:
  s_add_u32 s87, s2, 4
  s_cmp_ge_u32 s87, s90
  s_cbranch_scc1 L_cs_12
  s_add_u32 s86, s94, s87
  s_mul_i32 s88, s87, 2560
  s_add_u32 s88, s88, 31744
  s_cmp_ge_u32 s86, 40
  s_cbranch_scc1 L_cd_14
  s_cmp_ge_u32 s86, 32
  s_cbranch_scc1 L_ct_13
  s_mul_i32 s91, s86, 25600
  s_add_u32 m0, s88, 0
  s_nop 0
  buffer_load_dwordx4 v12, s[12:15], s91 offen nt lds
  s_add_u32 m0, s88, 1024
  s_nop 0
  buffer_load_dwordx4 v13, s[12:15], s91 offen nt lds
  s_mov_b32 exec_hi, 0
  s_add_u32 m0, s88, 2048
  s_nop 0
  buffer_load_dwordx4 v14, s[12:15], s91 offen nt lds
  s_mov_b32 exec_hi, -1
  s_branch L_cj_15
L_ct_13:
  s_sub_u32 s91, s86, 32
  s_mul_i32 s91, s91, 102400
  s_add_u32 m0, s88, 0
  s_nop 0
  buffer_load_dwordx4 v15, s[12:15], s91 offen nt lds
  s_add_u32 m0, s88, 1024
  s_nop 0
  buffer_load_dwordx4 v16, s[12:15], s91 offen nt lds
  s_mov_b32 exec_hi, 0
  s_add_u32 m0, s88, 2048
  s_nop 0
  buffer_load_dwordx4 v17, s[12:15], s91 offen nt lds
  s_mov_b32 exec_hi, -1
  s_branch L_cj_15
L_cd_14:
  s_sub_u32 s91, s86, 40
  s_mul_i32 s91, s91, 20480
  s_add_u32 m0, s88, 0
  s_nop 0
  buffer_load_dwordx4 v12, s[16:19], s91 offen nt lds
  s_add_u32 m0, s88, 1024
  s_nop 0
  buffer_load_dwordx4 v13, s[16:19], s91 offen nt lds
  s_mov_b32 exec_hi, 0
  s_add_u32 m0, s88, 2048
  s_nop 0
  buffer_load_dwordx4 v14, s[16:19], s91 offen nt lds
  s_mov_b32 exec_hi, -1
L_cj_15:
L_cs_12:
  s_waitcnt vmcnt(0)
L_p0j_2:
  s_barrier
  s_cmp_lt_u32 s0, 108
  s_cbranch_scc0 L_ngu2_16
  v_bfe_u32 v1, v254, 2, 2
  v_and_b32 v2, 3, v254
  v_bfe_u32 v3, v254, 4, 1
  v_lshrrev_b32 v4, 5, v254
  v_lshl_add_u32 v1, v4, 3, v1
  v_lshlrev_b32 v1, 5, v1
  v_mul_u32_u24 v3, 10368, v3
  v_add_u32 v1, v1, v3
  v_lshl_add_u32 v20, v2, 3, v1
  s_lshl_b32 s86, s5, 9
  v_add_u32 v20, s86, v20
  ds_read_b64_tr_b16 v[24:25], v20 offset:10240
  ds_read_b64_tr_b16 v[26:27], v20 offset:10368
  ds_read_b64_tr_b16 v[28:29], v20 offset:14336
  ds_read_b64_tr_b16 v[30:31], v20 offset:14464
  ds_read_b64_tr_b16 v[32:33], v20 offset:18432
  ds_read_b64_tr_b16 v[34:35], v20 offset:18560
  s_lshl_b32 s86, s0, 2
  s_add_u32 s86, s86, 3
  s_mul_i32 s86, s86, 2428
  s_lshr_b32 s86, s86, 16
  s_mul_i32 s87, s86, 27
  s_lshr_b32 s87, s87, 2
  s_sub_u32 s87, s0, s87
  s_sub_u32 s88, s86, 1
  s_mul_i32 s89, s88, 27
  s_lshr_b32 s89, s89, 2
  s_sub_u32 s89, s0, s89
  s_cmp_eq_u32 s86, 0
  s_cselect_b32 s89, 99, s89
  v_mov_b32 v40, 0
  v_mov_b32 v41, 0
  s_waitcnt lgkmcnt(0)
  v_lshlrev_b32 v4, 16, v24
  v_and_b32 v5, 0xffff0000, v24
  v_pk_add_f32 v[40:41], v[40:41], v[4:5]
  v_lshlrev_b32 v4, 16, v25
  v_and_b32 v5, 0xffff0000, v25
  v_pk_add_f32 v[40:41], v[40:41], v[4:5]
  v_lshlrev_b32 v4, 16, v26
  v_and_b32 v5, 0xffff0000, v26
  v_pk_add_f32 v[40:41], v[40:41], v[4:5]
  v_lshlrev_b32 v4, 16, v27
  v_and_b32 v5, 0xffff0000, v27
  v_pk_add_f32 v[40:41], v[40:41], v[4:5]
  v_lshlrev_b32 v4, 16, v28
  v_and_b32 v5, 0xffff0000, v28
  v_pk_add_f32 v[40:41], v[40:41], v[4:5]
  v_lshlrev_b32 v4, 16, v29
  v_and_b32 v5, 0xffff0000, v29
  v_pk_add_f32 v[40:41], v[40:41], v[4:5]
  v_lshlrev_b32 v4, 16, v30
  v_and_b32 v5, 0xffff0000, v30
  v_pk_add_f32 v[40:41], v[40:41], v[4:5]
  v_lshlrev_b32 v4, 16, v31
  v_and_b32 v5, 0xffff0000, v31
  v_pk_add_f32 v[40:41], v[40:41], v[4:5]
  s_cmp_lt_u32 s5, 4
  s_cbranch_scc0 L_g4_17
  v_lshlrev_b32 v4, 16, v32
  v_and_b32 v5, 0xffff0000, v32
  v_pk_add_f32 v[40:41], v[40:41], v[4:5]
  v_lshlrev_b32 v4, 16, v33
  v_and_b32 v5, 0xffff0000, v33
  v_pk_add_f32 v[40:41], v[40:41], v[4:5]
  v_lshlrev_b32 v4, 16, v34
  v_and_b32 v5, 0xffff0000, v34
  v_pk_add_f32 v[40:41], v[40:41], v[4:5]
  v_lshlrev_b32 v4, 16, v35
  v_and_b32 v5, 0xffff0000, v35
  v_pk_add_f32 v[40:41], v[40:41], v[4:5]
L_g4_17:
  v_add_f32 v40, v40, v41
  v_mov_b32 v41, v40
  s_nop 1
  v_permlane32_swap_b32 v40, v41
  v_add_f32 v40, v40, v41
  v_and_b32 v1, 31, v254
  v_lshlrev_b32 v2, 2, v1
  s_mul_i32 s85, s1, 20
  s_add_u32 s85, s85, s5
  s_mul_i32 s85, s85, 7168
  s_lshl_b32 s91, s87, 10
  s_add_u32 s85, s85, s91
  s_mul_i32 s91, s86, 286720
  s_add_u32 s85, s85, s91
  s_add_u32 s85, s85, 55574528
  buffer_store_dwordx4 v[24:27], v255, s[8:11], s85 offen sc1
  s_add_u32 s85, s85, 57344
  buffer_store_dwordx4 v[28:31], v255, s[8:11], s85 offen sc1
  s_add_u32 s85, s85, 57344
  s_cmp_lt_u32 s5, 4
  s_cbranch_scc0 L_g5_18
  buffer_store_dwordx4 v[32:35], v255, s[8:11], s85 offen sc1
  s_add_u32 s85, s85, 57344
L_g5_18:
  s_mul_i32 s85, s86, 32768
  s_add_u32 s91, s87, 4
  s_lshl_b32 s91, s91, 11
  s_add_u32 s85, s85, s91
  s_lshl_b32 s91, s1, 3
  s_add_u32 s91, s91, s5
  s_lshl_b32 s91, s91, 7
  s_add_u32 s85, s85, s91
  s_add_u32 s85, s85, 1572864
  s_mov_b32 exec_hi, 0
  buffer_store_dword v40, v2, s[8:11], s85 offen sc1
  s_mov_b32 exec_hi, -1
  s_cmp_le_u32 s89, 6
  s_cbranch_scc0 L_g6_19
  s_mul_i32 s85, s1, 20
  s_add_u32 s85, s85, s5
  s_mul_i32 s85, s85, 7168
  s_lshl_b32 s91, s89, 10
  s_add_u32 s85, s85, s91
  s_mul_i32 s91, s88, 286720
  s_add_u32 s85, s85, s91
  s_add_u32 s85, s85, 55574528
  buffer_store_dwordx4 v[24:27], v255, s[8:11], s85 offen sc1
  s_add_u32 s85, s85, 57344
  buffer_store_dwordx4 v[28:31], v255, s[8:11], s85 offen sc1
  s_add_u32 s85, s85, 57344
  s_cmp_lt_u32 s5, 4
  s_cbranch_scc0 L_g5_20
  buffer_store_dwordx4 v[32:35], v255, s[8:11], s85 offen sc1
  s_add_u32 s85, s85, 57344
L_g5_20:
  s_mul_i32 s85, s88, 32768
  s_add_u32 s91, s89, 4
  s_lshl_b32 s91, s91, 11
  s_add_u32 s85, s85, s91
  s_lshl_b32 s91, s1, 3
  s_add_u32 s91, s91, s5
  s_lshl_b32 s91, s91, 7
  s_add_u32 s85, s85, s91
  s_add_u32 s85, s85, 1572864
  s_mov_b32 exec_hi, 0
  buffer_store_dword v40, v2, s[8:11], s85 offen sc1
  s_mov_b32 exec_hi, -1
L_g6_19:
L_ngu2_16:
  v_bfe_u32 v1, v254, 2, 2
  v_and_b32 v2, 3, v254
  v_bfe_u32 v3, v254, 4, 1
  v_lshrrev_b32 v4, 5, v254
  v_lshl_add_u32 v1, v1, 1, v4
  v_mul_u32_u24 v1, 160, v1
  v_lshl_add_u32 v1, v3, 5, v1
  v_lshl_add_u32 v20, v2, 3, v1
  v_and_b32 v21, 15, v254
  v_lshlrev_b32 v21, 4, v21
  v_lshrrev_b32 v1, 5, v254
  v_lshl_add_u32 v21, v1, 8, v21
  s_sub_u32 s87, 7, s5
  s_cmp_ge_u32 s87, s90
  s_cbranch_scc1 L_cs2_21
  s_add_u32 s86, s94, s87
  s_mul_i32 s88, s87, 2560
  s_add_u32 s88, s88, 31744
  v_add_u32 v22, s88, v20
  ds_read_b64_tr_b16 v[24:25], v22 offset:0
  ds_read_b64_tr_b16 v[26:27], v22 offset:1280
  ds_read_b64_tr_b16 v[28:29], v22 offset:64
  ds_read_b64_tr_b16 v[30:31], v22 offset:1344
  ds_read_b64_tr_b16 v[32:33], v22 offset:128
  ds_read_b64_tr_b16 v[34:35], v22 offset:1408
  s_cmp_ge_u32 s86, 40
  s_cbranch_scc0 L_dw_22
  s_sub_u32 s92, s86, 40
  s_cmp_ge_u32 s92, 54
  s_cselect_b32 s93, 1, 0
  s_mul_i32 s89, s93, 54
  s_sub_u32 s92, s92, s89
  s_mul_i32 s91, s67, 278528
  s_add_u32 s91, s91, 61865984
  s_branch L_dj_24
L_dw_22:
  s_cmp_ge_u32 s86, 32
  s_cbranch_scc1 L_dt_23
  s_lshr_b32 s93, s86, 4
  s_and_b32 s92, s86, 15
  s_mul_i32 s91, s67, 102400
  s_add_u32 s91, s91, 60817408
  s_branch L_dj_24
L_dt_23:
  s_sub_u32 s92, s86, 32
  s_lshr_b32 s93, s92, 2
  s_and_b32 s92, s92, 3
  s_add_u32 s92, s92, 16
  s_mul_i32 s91, s67, 102400
  s_add_u32 s91, s91, 60817408
L_dj_24:
  s_mul_i32 s92, s92, 5120
  s_add_u32 s91, s91, s92
  s_mul_i32 s93, s93, 2560
  s_add_u32 s91, s91, s93
  s_waitcnt lgkmcnt(0)
  buffer_store_dwordx4 v[24:27], v255, s[8:11], s91 offen sc1
  buffer_store_dwordx4 v[28:31], v255, s[8:11], s91 offen offset:1024 sc1
  s_mov_b32 exec_lo, 0xffff
  s_mov_b32 exec_hi, 0xffff
  buffer_store_dwordx4 v[32:35], v21, s[8:11], s91 offen offset:2048 sc1
  s_mov_b64 exec, -1
  s_nop 1
L_cs2_21:
  s_cmp_eq_u32 s5, 0
  s_cbranch_scc0 L_np1_25
  v_and_b32 v6, 15, v254
  v_lshlrev_b32 v7, 2, v254
  s_mov_b32 s96, 0
L_hsp_26:
  buffer_load_dword v9, v7, s[28:31], 0 offen sc1
  s_add_u32 s96, s96, 1
  s_cmp_gt_u32 s96, 200000
  s_cbranch_scc1 L_hsd_27
  s_waitcnt vmcnt(0)
  v_subrev_u32 v8, 0x01010101, v9
  v_not_b32 v10, v9
  v_and_b32 v8, v8, v10
  v_and_b32 v8, 0x80808080, v8
  v_cmp_ne_u32 vcc, 0, v8
  s_cbranch_vccnz L_hsp_26
L_hsd_27:
  s_waitcnt vmcnt(0)
  s_lshl_b32 s86, s3, 2
  v_readlane_b32 s85, v9, s86
  s_nop 1
  s_and_b32 s87, s85, 0xff
  s_mul_i32 s87, s87, 0x01010101
  s_mov_b32 s88, 1
  s_add_u32 s89, s86, 0
  s_nop 3
  v_readlane_b32 s85, v9, s89
  s_nop 1
  s_cmp_eq_u32 s85, s87
  s_cselect_b32 s88, s88, 0
  s_add_u32 s89, s86, 1
  s_nop 3
  v_readlane_b32 s85, v9, s89
  s_nop 1
  s_cmp_eq_u32 s85, s87
  s_cselect_b32 s88, s88, 0
  s_add_u32 s89, s86, 2
  s_nop 3
  v_readlane_b32 s85, v9, s89
  s_nop 1
  s_cmp_eq_u32 s85, s87
  s_cselect_b32 s88, s88, 0
  s_add_u32 s89, s86, 3
  s_nop 3
  v_readlane_b32 s85, v9, s89
  s_nop 1
  s_cmp_eq_u32 s85, s87
  s_cselect_b32 s88, s88, 0
  s_mov_b32 s85, s88
  v_mov_b32 v4, s85
  v_mov_b32 v5, 160768
  ds_write_b32 v5, v4
  v_bfe_u32 v1, v254, 4, 1
  v_lshlrev_b32 v2, 4, v6
  v_add_u32 v2, s4, v2
  s_lshl_b32 s86, s3, 4
  v_add_u32 v3, s86, v6
  v_cmp_eq_u32 vcc, 1, v1
  s_nop 1
  v_cndmask_b32 v2, v2, v3, vcc
  v_lshlrev_b32 v2, 7, v2
  s_mov_b32 s86, 4112
  s_mov_b32 s96, 0
L_pA_28:
  buffer_load_dwordx4 v[8:11], v2, s[8:11], s86 offen sc1
  s_add_u32 s96, s96, 1
  s_cmp_gt_u32 s96, 200000
  s_cbranch_scc1 L_dA_29
  s_waitcnt vmcnt(0)
  v_min_u32 v8, v8, v9
  v_min3_u32 v8, v8, v10, v11
  v_cmp_gt_u32 vcc, 1, v8
  s_cbranch_vccnz L_pA_28
L_dA_29:
  s_lshl_b32 s86, s3, 8
  s_add_u32 s86, s86, 0
  v_lshlrev_b32 v5, 2, v254
  buffer_load_dword v9, v5, s[8:11], s86 offen sc1
  s_waitcnt vmcnt(0) lgkmcnt(0)
L_np1_25:
  s_barrier
  v_mov_b32 v5, 160768
  ds_read_b32 v4, v5
  s_waitcnt lgkmcnt(0)
  v_readfirstlane_b32 s7, v4
  s_mov_b32 s20, s8
  s_mov_b32 s21, s9
  s_mov_b32 s22, s10
  s_mov_b32 s23, s11
  v_mov_b32 v250, 0
  s_mov_b32 s91, 0
  s_cmp_ge_u32 s5, 4
  s_cbranch_scc1 L_helper
  s_mul_i32 s84, s6, 5242880
  s_mul_i32 s78, s3, 163840
  s_add_u32 s84, s84, s78
  s_mul_i32 s78, s5, 40960
  s_add_u32 s84, s84, s78
  s_add_u32 s84, s84, 25165824
L_P_layer:
  buffer_load_dwordx4 v[112:115], v255, s[8:11], s84 offen offset:0 sc1
  buffer_load_dwordx4 v[116:119], v255, s[8:11], s84 offen offset:1024 sc1
  buffer_load_dwordx4 v[120:123], v255, s[8:11], s84 offen offset:2048 sc1
  buffer_load_dwordx4 v[124:127], v255, s[8:11], s84 offen offset:3072 sc1
  s_add_u32 s84, s84, 4096
  buffer_load_dwordx4 v[128:131], v255, s[8:11], s84 offen offset:0 sc1
  buffer_load_dwordx4 v[132:135], v255, s[8:11], s84 offen offset:1024 sc1
  s_barrier
  v_add_u32 v240, 0, v255
  ds_read_b128 v[64:67], v240 offset:0
  ds_read_b128 v[68:71], v240 offset:1024
  ds_read_b128 v[72:75], v240 offset:2048
  ds_read_b128 v[76:79], v240 offset:3072
  ds_read_b128 v[80:83], v240 offset:4096
  ds_read_b128 v[84:87], v240 offset:5120
  ds_read_b128 v[88:91], v240 offset:6144
  ds_read_b128 v[92:95], v240 offset:7168
  s_waitcnt vmcnt(5) lgkmcnt(4)
  v_mfma_f32_32x32x16_bf16 v[0:15], v[64:67], v[112:115], 0
  ds_read_b128 v[96:99], v240 offset:8192
  buffer_load_dwordx4 v[136:139], v255, s[8:11], s84 offen offset:2048 sc1
  buffer_load_dwordx4 v[140:143], v255, s[8:11], s84 offen offset:3072 sc1
  s_add_u32 s84, s84, 4096
  buffer_load_dwordx4 v[144:147], v255, s[8:11], s84 offen offset:0 sc1
  v_mfma_f32_32x32x16_bf16 v[16:31], v[68:71], v[112:115], 0
  ds_read_b128 v[100:103], v240 offset:9216
  v_mfma_f32_32x32x16_bf16 v[32:47], v[72:75], v[112:115], 0
  ds_read_b128 v[104:107], v240 offset:10240
  v_mfma_f32_32x32x16_bf16 v[48:63], v[76:79], v[112:115], 0
  ds_read_b128 v[108:111], v240 offset:11264
  s_waitcnt vmcnt(7) lgkmcnt(4)
  v_mfma_f32_32x32x16_bf16 v[0:15], v[80:83], v[116:119], v[0:15]
  ds_read_b128 v[64:67], v240 offset:12288
  buffer_load_dwordx4 v[148:151], v255, s[8:11], s84 offen offset:1024 sc1
  buffer_load_dwordx4 v[152:155], v255, s[8:11], s84 offen offset:2048 sc1
  buffer_load_dwordx4 v[156:159], v255, s[8:11], s84 offen offset:3072 sc1
  s_add_u32 s84, s84, 4096
  v_mfma_f32_32x32x16_bf16 v[16:31], v[84:87], v[116:119], v[16:31]
  ds_read_b128 v[68:71], v240 offset:13312
  v_mfma_f32_32x32x16_bf16 v[32:47], v[88:91], v[116:119], v[32:47]
  ds_read_b128 v[72:75], v240 offset:14336
  v_mfma_f32_32x32x16_bf16 v[48:63], v[92:95], v[116:119], v[48:63]
  ds_read_b128 v[76:79], v240 offset:15360
  s_barrier
  v_add_u32 v240, 16384, v255
  s_waitcnt vmcnt(9) lgkmcnt(4)
  v_mfma_f32_32x32x16_bf16 v[0:15], v[96:99], v[120:123], v[0:15]
  ds_read_b128 v[80:83], v240 offset:0
  buffer_load_dwordx4 v[160:163], v255, s[8:11], s84 offen offset:0 sc1
  buffer_load_dwordx4 v[164:167], v255, s[8:11], s84 offen offset:1024 sc1
  buffer_load_dwordx4 v[168:171], v255, s[8:11], s84 offen offset:2048 sc1
  v_mfma_f32_32x32x16_bf16 v[16:31], v[100:103], v[120:123], v[16:31]
  ds_read_b128 v[84:87], v240 offset:1024
  v_mfma_f32_32x32x16_bf16 v[32:47], v[104:107], v[120:123], v[32:47]
  ds_read_b128 v[88:91], v240 offset:2048
  v_mfma_f32_32x32x16_bf16 v[48:63], v[108:111], v[120:123], v[48:63]
  ds_read_b128 v[92:95], v240 offset:3072
  s_waitcnt vmcnt(11) lgkmcnt(4)
  v_mfma_f32_32x32x16_bf16 v[0:15], v[64:67], v[124:127], v[0:15]
  ds_read_b128 v[96:99], v240 offset:4096
  buffer_load_dwordx4 v[172:175], v255, s[8:11], s84 offen offset:3072 sc1
  s_add_u32 s84, s84, 4096
  buffer_load_dwordx4 v[176:179], v255, s[8:11], s84 offen offset:0 sc1
  buffer_load_dwordx4 v[180:183], v255, s[8:11], s84 offen offset:1024 sc1
  v_mfma_f32_32x32x16_bf16 v[16:31], v[68:71], v[124:127], v[16:31]
  ds_read_b128 v[100:103], v240 offset:5120
  v_mfma_f32_32x32x16_bf16 v[32:47], v[72:75], v[124:127], v[32:47]
  ds_read_b128 v[104:107], v240 offset:6144
  v_mfma_f32_32x32x16_bf16 v[48:63], v[76:79], v[124:127], v[48:63]
  ds_read_b128 v[108:111], v240 offset:7168
  s_waitcnt vmcnt(13) lgkmcnt(4)
  v_mfma_f32_32x32x16_bf16 v[0:15], v[80:83], v[128:131], v[0:15]
  ds_read_b128 v[64:67], v240 offset:8192
  buffer_load_dwordx4 v[184:187], v255, s[8:11], s84 offen offset:2048 sc1
  buffer_load_dwordx4 v[188:191], v255, s[8:11], s84 offen offset:3072 sc1
  s_add_u32 s84, s84, 4096
  buffer_load_dwordx4 v[192:195], v255, s[8:11], s84 offen offset:0 sc1
  v_mfma_f32_32x32x16_bf16 v[16:31], v[84:87], v[128:131], v[16:31]
  ds_read_b128 v[68:71], v240 offset:9216
  v_mfma_f32_32x32x16_bf16 v[32:47], v[88:91], v[128:131], v[32:47]
  ds_read_b128 v[72:75], v240 offset:10240
  v_mfma_f32_32x32x16_bf16 v[48:63], v[92:95], v[128:131], v[48:63]
  ds_read_b128 v[76:79], v240 offset:11264
  s_waitcnt vmcnt(15) lgkmcnt(4)
  v_mfma_f32_32x32x16_bf16 v[0:15], v[96:99], v[132:135], v[0:15]
  ds_read_b128 v[80:83], v240 offset:12288
  buffer_load_dwordx4 v[196:199], v255, s[8:11], s84 offen offset:1024 sc1
  v_mfma_f32_32x32x16_bf16 v[16:31], v[100:103], v[132:135], v[16:31]
  ds_read_b128 v[84:87], v240 offset:13312
  v_mfma_f32_32x32x16_bf16 v[32:47], v[104:107], v[132:135], v[32:47]
  ds_read_b128 v[88:91], v240 offset:14336
  v_mfma_f32_32x32x16_bf16 v[48:63], v[108:111], v[132:135], v[48:63]
  ds_read_b128 v[92:95], v240 offset:15360
  s_barrier
  v_add_u32 v240, 61440, v255
  s_waitcnt vmcnt(15) lgkmcnt(4)
  v_mfma_f32_32x32x16_bf16 v[0:15], v[64:67], v[136:139], v[0:15]
  ds_read_b128 v[96:99], v240 offset:0
  buffer_load_dwordx4 v[200:203], v255, s[8:11], s84 offen offset:2048 sc1
  v_mfma_f32_32x32x16_bf16 v[16:31], v[68:71], v[136:139], v[16:31]
  ds_read_b128 v[100:103], v240 offset:1024
  v_mfma_f32_32x32x16_bf16 v[32:47], v[72:75], v[136:139], v[32:47]
  ds_read_b128 v[104:107], v240 offset:2048
  v_mfma_f32_32x32x16_bf16 v[48:63], v[76:79], v[136:139], v[48:63]
  ds_read_b128 v[108:111], v240 offset:3072
  s_waitcnt vmcnt(15) lgkmcnt(4)
  v_mfma_f32_32x32x16_bf16 v[0:15], v[80:83], v[140:143], v[0:15]
  ds_read_b128 v[64:67], v240 offset:4096
  buffer_load_dwordx4 v[204:207], v255, s[8:11], s84 offen offset:3072 sc1
  s_add_u32 s84, s84, 4096
  v_mfma_f32_32x32x16_bf16 v[16:31], v[84:87], v[140:143], v[16:31]
  ds_read_b128 v[68:71], v240 offset:5120
  v_mfma_f32_32x32x16_bf16 v[32:47], v[88:91], v[140:143], v[32:47]
  ds_read_b128 v[72:75], v240 offset:6144
  v_mfma_f32_32x32x16_bf16 v[48:63], v[92:95], v[140:143], v[48:63]
  ds_read_b128 v[76:79], v240 offset:7168
  s_waitcnt vmcnt(15) lgkmcnt(4)
  v_mfma_f32_32x32x16_bf16 v[0:15], v[96:99], v[144:147], v[0:15]
  ds_read_b128 v[80:83], v240 offset:8192
  buffer_load_dwordx4 v[208:211], v255, s[8:11], s84 offen offset:0 sc1
  v_mfma_f32_32x32x16_bf16 v[16:31], v[100:103], v[144:147], v[16:31]
  ds_read_b128 v[84:87], v240 offset:9216
  v_mfma_f32_32x32x16_bf16 v[32:47], v[104:107], v[144:147], v[32:47]
  ds_read_b128 v[88:91], v240 offset:10240
  v_mfma_f32_32x32x16_bf16 v[48:63], v[108:111], v[144:147], v[48:63]
  ds_read_b128 v[92:95], v240 offset:11264
  s_waitcnt vmcnt(15) lgkmcnt(4)
  v_mfma_f32_32x32x16_bf16 v[0:15], v[64:67], v[148:151], v[0:15]
  ds_read_b128 v[96:99], v240 offset:12288
  buffer_load_dwordx4 v[212:215], v255, s[8:11], s84 offen offset:1024 sc1
  v_mfma_f32_32x32x16_bf16 v[16:31], v[68:71], v[148:151], v[16:31]
  ds_read_b128 v[100:103], v240 offset:13312
  v_mfma_f32_32x32x16_bf16 v[32:47], v[72:75], v[148:151], v[32:47]
  ds_read_b128 v[104:107], v240 offset:14336
  v_mfma_f32_32x32x16_bf16 v[48:63], v[76:79], v[148:151], v[48:63]
  ds_read_b128 v[108:111], v240 offset:15360
  s_barrier
  v_add_u32 v240, 77824, v255
  s_waitcnt vmcnt(15) lgkmcnt(4)
  v_mfma_f32_32x32x16_bf16 v[0:15], v[80:83], v[152:155], v[0:15]
  ds_read_b128 v[64:67], v240 offset:0
  buffer_load_dwordx4 v[216:219], v255, s[8:11], s84 offen offset:2048 sc1
  v_mfma_f32_32x32x16_bf16 v[16:31], v[84:87], v[152:155], v[16:31]
  ds_read_b128 v[68:71], v240 offset:1024
  v_mfma_f32_32x32x16_bf16 v[32:47], v[88:91], v[152:155], v[32:47]
  ds_read_b128 v[72:75], v240 offset:2048
  v_mfma_f32_32x32x16_bf16 v[48:63], v[92:95], v[152:155], v[48:63]
  ds_read_b128 v[76:79], v240 offset:3072
  s_waitcnt vmcnt(15) lgkmcnt(4)
  v_mfma_f32_32x32x16_bf16 v[0:15], v[96:99], v[156:159], v[0:15]
  ds_read_b128 v[80:83], v240 offset:4096
  buffer_load_dwordx4 v[220:223], v255, s[8:11], s84 offen offset:3072 sc1
  s_add_u32 s84, s84, 4096
  v_mfma_f32_32x32x16_bf16 v[16:31], v[100:103], v[156:159], v[16:31]
  ds_read_b128 v[84:87], v240 offset:5120
  v_mfma_f32_32x32x16_bf16 v[32:47], v[104:107], v[156:159], v[32:47]
  ds_read_b128 v[88:91], v240 offset:6144
  v_mfma_f32_32x32x16_bf16 v[48:63], v[108:111], v[156:159], v[48:63]
  ds_read_b128 v[92:95], v240 offset:7168
  s_waitcnt vmcnt(15) lgkmcnt(4)
  v_mfma_f32_32x32x16_bf16 v[0:15], v[64:67], v[160:163], v[0:15]
  ds_read_b128 v[96:99], v240 offset:8192
  buffer_load_dwordx4 v[224:227], v255, s[8:11], s84 offen offset:0 sc1
  v_mfma_f32_32x32x16_bf16 v[16:31], v[68:71], v[160:163], v[16:31]
  ds_read_b128 v[100:103], v240 offset:9216
  v_mfma_f32_32x32x16_bf16 v[32:47], v[72:75], v[160:163], v[32:47]
  ds_read_b128 v[104:107], v240 offset:10240
  v_mfma_f32_32x32x16_bf16 v[48:63], v[76:79], v[160:163], v[48:63]
  ds_read_b128 v[108:111], v240 offset:11264
  s_waitcnt vmcnt(15) lgkmcnt(4)
  v_mfma_f32_32x32x16_bf16 v[0:15], v[80:83], v[164:167], v[0:15]
  ds_read_b128 v[64:67], v240 offset:12288
  buffer_load_dwordx4 v[228:231], v255, s[8:11], s84 offen offset:1024 sc1
  v_mfma_f32_32x32x16_bf16 v[16:31], v[84:87], v[164:167], v[16:31]
  ds_read_b128 v[68:71], v240 offset:13312
  v_mfma_f32_32x32x16_bf16 v[32:47], v[88:91], v[164:167], v[32:47]
  ds_read_b128 v[72:75], v240 offset:14336
  v_mfma_f32_32x32x16_bf16 v[48:63], v[92:95], v[164:167], v[48:63]
  ds_read_b128 v[76:79], v240 offset:15360
  s_barrier
  v_add_u32 v240, 32768, v255
  s_waitcnt vmcnt(15) lgkmcnt(4)
  v_mfma_f32_32x32x16_bf16 v[0:15], v[96:99], v[168:171], v[0:15]
  ds_read_b128 v[80:83], v240 offset:0
  buffer_load_dwordx4 v[232:235], v255, s[8:11], s84 offen offset:2048 sc1
  v_mfma_f32_32x32x16_bf16 v[16:31], v[100:103], v[168:171], v[16:31]
  ds_read_b128 v[84:87], v240 offset:1024
  v_mfma_f32_32x32x16_bf16 v[32:47], v[104:107], v[168:171], v[32:47]
  ds_read_b128 v[88:91], v240 offset:2048
  v_mfma_f32_32x32x16_bf16 v[48:63], v[108:111], v[168:171], v[48:63]
  ds_read_b128 v[92:95], v240 offset:3072
  s_waitcnt vmcnt(15) lgkmcnt(4)
  v_mfma_f32_32x32x16_bf16 v[0:15], v[64:67], v[172:175], v[0:15]
  ds_read_b128 v[96:99], v240 offset:4096
  buffer_load_dwordx4 v[236:239], v255, s[8:11], s84 offen offset:3072 sc1
  s_add_u32 s84, s84, 4096
  v_mfma_f32_32x32x16_bf16 v[16:31], v[68:71], v[172:175], v[16:31]
  ds_read_b128 v[100:103], v240 offset:5120
  v_mfma_f32_32x32x16_bf16 v[32:47], v[72:75], v[172:175], v[32:47]
  ds_read_b128 v[104:107], v240 offset:6144
  v_mfma_f32_32x32x16_bf16 v[48:63], v[76:79], v[172:175], v[48:63]
  ds_read_b128 v[108:111], v240 offset:7168
  s_waitcnt vmcnt(15) lgkmcnt(4)
  v_mfma_f32_32x32x16_bf16 v[0:15], v[80:83], v[176:179], v[0:15]
  ds_read_b128 v[64:67], v240 offset:8192
  buffer_load_dwordx4 v[112:115], v255, s[8:11], s84 offen offset:0 sc1
  v_mfma_f32_32x32x16_bf16 v[16:31], v[84:87], v[176:179], v[16:31]
  ds_read_b128 v[68:71], v240 offset:9216
  v_mfma_f32_32x32x16_bf16 v[32:47], v[88:91], v[176:179], v[32:47]
  ds_read_b128 v[72:75], v240 offset:10240
  v_mfma_f32_32x32x16_bf16 v[48:63], v[92:95], v[176:179], v[48:63]
  ds_read_b128 v[76:79], v240 offset:11264
  s_waitcnt vmcnt(15) lgkmcnt(4)
  v_mfma_f32_32x32x16_bf16 v[0:15], v[96:99], v[180:183], v[0:15]
  ds_read_b128 v[80:83], v240 offset:12288
  buffer_load_dwordx4 v[116:119], v255, s[8:11], s84 offen offset:1024 sc1
  v_mfma_f32_32x32x16_bf16 v[16:31], v[100:103], v[180:183], v[16:31]
  ds_read_b128 v[84:87], v240 offset:13312
  v_mfma_f32_32x32x16_bf16 v[32:47], v[104:107], v[180:183], v[32:47]
  ds_read_b128 v[88:91], v240 offset:14336
  v_mfma_f32_32x32x16_bf16 v[48:63], v[108:111], v[180:183], v[48:63]
  ds_read_b128 v[92:95], v240 offset:15360
  s_barrier
  v_add_u32 v240, 0, v255
  s_waitcnt vmcnt(15) lgkmcnt(4)
  v_mfma_f32_32x32x16_bf16 v[0:15], v[64:67], v[184:187], v[0:15]
  ds_read_b128 v[96:99], v240 offset:0
  buffer_load_dwordx4 v[120:123], v255, s[8:11], s84 offen offset:2048 sc1
  v_mfma_f32_32x32x16_bf16 v[16:31], v[68:71], v[184:187], v[16:31]
  ds_read_b128 v[100:103], v240 offset:1024
  v_mfma_f32_32x32x16_bf16 v[32:47], v[72:75], v[184:187], v[32:47]
  ds_read_b128 v[104:107], v240 offset:2048
  v_mfma_f32_32x32x16_bf16 v[48:63], v[76:79], v[184:187], v[48:63]
  ds_read_b128 v[108:111], v240 offset:3072
  s_waitcnt vmcnt(15) lgkmcnt(4)
  v_mfma_f32_32x32x16_bf16 v[0:15], v[80:83], v[188:191], v[0:15]
  ds_read_b128 v[64:67], v240 offset:4096
  buffer_load_dwordx4 v[124:127], v255, s[8:11], s84 offen offset:3072 sc1
  s_add_u32 s84, s84, 4096
  v_mfma_f32_32x32x16_bf16 v[16:31], v[84:87], v[188:191], v[16:31]
  ds_read_b128 v[68:71], v240 offset:5120
  v_mfma_f32_32x32x16_bf16 v[32:47], v[88:91], v[188:191], v[32:47]
  ds_read_b128 v[72:75], v240 offset:6144
  v_mfma_f32_32x32x16_bf16 v[48:63], v[92:95], v[188:191], v[48:63]
  ds_read_b128 v[76:79], v240 offset:7168
  s_waitcnt vmcnt(15) lgkmcnt(4)
  v_mfma_f32_32x32x16_bf16 v[0:15], v[96:99], v[192:195], v[0:15]
  ds_read_b128 v[80:83], v240 offset:8192
  buffer_load_dwordx4 v[128:131], v255, s[8:11], s84 offen offset:0 sc1
  v_mfma_f32_32x32x16_bf16 v[16:31], v[100:103], v[192:195], v[16:31]
  ds_read_b128 v[84:87], v240 offset:9216
  v_mfma_f32_32x32x16_bf16 v[32:47], v[104:107], v[192:195], v[32:47]
  ds_read_b128 v[88:91], v240 offset:10240
  v_mfma_f32_32x32x16_bf16 v[48:63], v[108:111], v[192:195], v[48:63]
  ds_read_b128 v[92:95], v240 offset:11264
  s_waitcnt vmcnt(15) lgkmcnt(4)
  v_mfma_f32_32x32x16_bf16 v[0:15], v[64:67], v[196:199], v[0:15]
  ds_read_b128 v[96:99], v240 offset:12288
  buffer_load_dwordx4 v[132:135], v255, s[8:11], s84 offen offset:1024 sc1
  v_mfma_f32_32x32x16_bf16 v[16:31], v[68:71], v[196:199], v[16:31]
  ds_read_b128 v[100:103], v240 offset:13312
  v_mfma_f32_32x32x16_bf16 v[32:47], v[72:75], v[196:199], v[32:47]
  ds_read_b128 v[104:107], v240 offset:14336
  v_mfma_f32_32x32x16_bf16 v[48:63], v[76:79], v[196:199], v[48:63]
  ds_read_b128 v[108:111], v240 offset:15360
  s_barrier
  v_add_u32 v240, 16384, v255
  s_waitcnt vmcnt(15) lgkmcnt(4)
  v_mfma_f32_32x32x16_bf16 v[0:15], v[80:83], v[200:203], v[0:15]
  ds_read_b128 v[64:67], v240 offset:0
  buffer_load_dwordx4 v[136:139], v255, s[8:11], s84 offen offset:2048 sc1
  v_mfma_f32_32x32x16_bf16 v[16:31], v[84:87], v[200:203], v[16:31]
  ds_read_b128 v[68:71], v240 offset:1024
  v_mfma_f32_32x32x16_bf16 v[32:47], v[88:91], v[200:203], v[32:47]
  ds_read_b128 v[72:75], v240 offset:2048
  v_mfma_f32_32x32x16_bf16 v[48:63], v[92:95], v[200:203], v[48:63]
  ds_read_b128 v[76:79], v240 offset:3072
  s_waitcnt vmcnt(15) lgkmcnt(4)
  v_mfma_f32_32x32x16_bf16 v[0:15], v[96:99], v[204:207], v[0:15]
  ds_read_b128 v[80:83], v240 offset:4096
  buffer_load_dwordx4 v[140:143], v255, s[8:11], s84 offen offset:3072 sc1
  s_add_u32 s84, s84, 4096
  v_mfma_f32_32x32x16_bf16 v[16:31], v[100:103], v[204:207], v[16:31]
  ds_read_b128 v[84:87], v240 offset:5120
  v_mfma_f32_32x32x16_bf16 v[32:47], v[104:107], v[204:207], v[32:47]
  ds_read_b128 v[88:91], v240 offset:6144
  v_mfma_f32_32x32x16_bf16 v[48:63], v[108:111], v[204:207], v[48:63]
  ds_read_b128 v[92:95], v240 offset:7168
  s_waitcnt vmcnt(15) lgkmcnt(4)
  v_mfma_f32_32x32x16_bf16 v[0:15], v[64:67], v[208:211], v[0:15]
  ds_read_b128 v[96:99], v240 offset:8192
  v_mfma_f32_32x32x16_bf16 v[16:31], v[68:71], v[208:211], v[16:31]
  ds_read_b128 v[100:103], v240 offset:9216
  v_mfma_f32_32x32x16_bf16 v[32:47], v[72:75], v[208:211], v[32:47]
  ds_read_b128 v[104:107], v240 offset:10240
  v_mfma_f32_32x32x16_bf16 v[48:63], v[76:79], v[208:211], v[48:63]
  ds_read_b128 v[108:111], v240 offset:11264
  s_waitcnt vmcnt(14) lgkmcnt(4)
  v_mfma_f32_32x32x16_bf16 v[0:15], v[80:83], v[212:215], v[0:15]
  ds_read_b128 v[64:67], v240 offset:12288
  v_mfma_f32_32x32x16_bf16 v[16:31], v[84:87], v[212:215], v[16:31]
  ds_read_b128 v[68:71], v240 offset:13312
  v_mfma_f32_32x32x16_bf16 v[32:47], v[88:91], v[212:215], v[32:47]
  ds_read_b128 v[72:75], v240 offset:14336
  v_mfma_f32_32x32x16_bf16 v[48:63], v[92:95], v[212:215], v[48:63]
  ds_read_b128 v[76:79], v240 offset:15360
  s_barrier
  v_add_u32 v240, 49152, v255
  s_waitcnt vmcnt(13) lgkmcnt(4)
  v_mfma_f32_32x32x16_bf16 v[0:15], v[96:99], v[216:219], v[0:15]
  ds_read_b128 v[80:83], v240 offset:0
  v_mfma_f32_32x32x16_bf16 v[16:31], v[100:103], v[216:219], v[16:31]
  ds_read_b128 v[84:87], v240 offset:1024
  v_mfma_f32_32x32x16_bf16 v[32:47], v[104:107], v[216:219], v[32:47]
  ds_read_b128 v[88:91], v240 offset:2048
  v_mfma_f32_32x32x16_bf16 v[48:63], v[108:111], v[216:219], v[48:63]
  ds_read_b128 v[92:95], v240 offset:3072
  s_waitcnt vmcnt(12) lgkmcnt(4)
  v_mfma_f32_32x32x16_bf16 v[0:15], v[64:67], v[220:223], v[0:15]
  ds_read_b128 v[96:99], v240 offset:4096
  v_mfma_f32_32x32x16_bf16 v[16:31], v[68:71], v[220:223], v[16:31]
  ds_read_b128 v[100:103], v240 offset:5120
  v_mfma_f32_32x32x16_bf16 v[32:47], v[72:75], v[220:223], v[32:47]
  ds_read_b128 v[104:107], v240 offset:6144
  v_mfma_f32_32x32x16_bf16 v[48:63], v[76:79], v[220:223], v[48:63]
  ds_read_b128 v[108:111], v240 offset:7168
  s_waitcnt vmcnt(11) lgkmcnt(4)
  v_mfma_f32_32x32x16_bf16 v[0:15], v[80:83], v[224:227], v[0:15]
  ds_read_b128 v[64:67], v240 offset:8192
  v_mfma_f32_32x32x16_bf16 v[16:31], v[84:87], v[224:227], v[16:31]
  ds_read_b128 v[68:71], v240 offset:9216
  v_mfma_f32_32x32x16_bf16 v[32:47], v[88:91], v[224:227], v[32:47]
  ds_read_b128 v[72:75], v240 offset:10240
  v_mfma_f32_32x32x16_bf16 v[48:63], v[92:95], v[224:227], v[48:63]
  ds_read_b128 v[76:79], v240 offset:11264
  s_waitcnt vmcnt(10) lgkmcnt(4)
  v_mfma_f32_32x32x16_bf16 v[0:15], v[96:99], v[228:231], v[0:15]
  ds_read_b128 v[80:83], v240 offset:12288
  v_mfma_f32_32x32x16_bf16 v[16:31], v[100:103], v[228:231], v[16:31]
  ds_read_b128 v[84:87], v240 offset:13312
  v_mfma_f32_32x32x16_bf16 v[32:47], v[104:107], v[228:231], v[32:47]
  ds_read_b128 v[88:91], v240 offset:14336
  v_mfma_f32_32x32x16_bf16 v[48:63], v[108:111], v[228:231], v[48:63]
  ds_read_b128 v[92:95], v240 offset:15360
  s_barrier
  v_add_u32 v240, 90112, v255
  s_waitcnt vmcnt(9) lgkmcnt(4)
  v_mfma_f32_32x32x16_bf16 v[0:15], v[64:67], v[232:235], v[0:15]
  ds_read_b128 v[96:99], v240 offset:0
  v_mfma_f32_32x32x16_bf16 v[16:31], v[68:71], v[232:235], v[16:31]
  ds_read_b128 v[100:103], v240 offset:1024
  v_mfma_f32_32x32x16_bf16 v[32:47], v[72:75], v[232:235], v[32:47]
  ds_read_b128 v[104:107], v240 offset:2048
  v_mfma_f32_32x32x16_bf16 v[48:63], v[76:79], v[232:235], v[48:63]
  ds_read_b128 v[108:111], v240 offset:3072
  v_mov_b32 v194, 0
  v_mov_b32 v195, 0
  v_mov_b32 v198, 0
  v_mov_b32 v199, 0
  v_mov_b32 v202, 0
  v_mov_b32 v203, 0
  v_mov_b32 v206, 0
  v_mov_b32 v207, 0
  v_mov_b32 v210, 0
  v_mov_b32 v211, 0
  s_waitcnt vmcnt(8) lgkmcnt(4)
  v_mfma_f32_32x32x16_bf16 v[0:15], v[80:83], v[236:239], v[0:15]
  ds_read_b128 v[64:67], v240 offset:4096
  v_mfma_f32_32x32x16_bf16 v[16:31], v[84:87], v[236:239], v[16:31]
  ds_read_b128 v[68:71], v240 offset:5120
  v_mfma_f32_32x32x16_bf16 v[32:47], v[88:91], v[236:239], v[32:47]
  ds_read_b128 v[72:75], v240 offset:6144
  v_mfma_f32_32x32x16_bf16 v[48:63], v[92:95], v[236:239], v[48:63]
  ds_read_b128 v[76:79], v240 offset:7168
  v_and_b32 v243, 31, v254
  v_lshlrev_b32 v243, 3, v243
  v_add_u32 v243, 157696, v243
  s_mul_i32 s78, s5, 768
  s_add_u32 s78, s78, 160768
  v_lshlrev_b32 v244, 3, v254
  v_add_u32 v244, s78, v244
  v_lshlrev_b32 v245, 2, v254
  v_add_u32 v245, s78, v245
  s_waitcnt vmcnt(7) lgkmcnt(4)
  v_mfma_f32_32x32x16_bf16 v[0:15], v[96:99], v[112:115], v[0:15]
  ds_read_b128 v[80:83], v240 offset:8192
  v_mfma_f32_32x32x16_bf16 v[16:31], v[100:103], v[112:115], v[16:31]
  ds_read_b128 v[84:87], v240 offset:9216
  v_mfma_f32_32x32x16_bf16 v[32:47], v[104:107], v[112:115], v[32:47]
  ds_read_b128 v[88:91], v240 offset:10240
  v_mfma_f32_32x32x16_bf16 v[48:63], v[108:111], v[112:115], v[48:63]
  ds_read_b128 v[92:95], v240 offset:11264
  s_waitcnt vmcnt(6) lgkmcnt(4)
  v_mfma_f32_32x32x16_bf16 v[0:15], v[64:67], v[116:119], v[0:15]
  ds_read_b128 v[96:99], v240 offset:12288
  v_mfma_f32_32x32x16_bf16 v[16:31], v[68:71], v[116:119], v[16:31]
  ds_read_b128 v[100:103], v240 offset:13312
  v_mfma_f32_32x32x16_bf16 v[32:47], v[72:75], v[116:119], v[32:47]
  ds_read_b128 v[104:107], v240 offset:14336
  v_mfma_f32_32x32x16_bf16 v[48:63], v[76:79], v[116:119], v[48:63]
  ds_read_b128 v[108:111], v240 offset:15360
  s_barrier
  v_add_u32 v240, 73728, v255
  s_waitcnt vmcnt(5) lgkmcnt(4)
  v_mfma_f32_32x32x16_bf16 v[0:15], v[80:83], v[120:123], v[0:15]
  ds_read_b128 v[64:67], v240 offset:0
  v_mfma_f32_32x32x16_bf16 v[16:31], v[84:87], v[120:123], v[16:31]
  ds_read_b128 v[68:71], v240 offset:1024
  v_mfma_f32_32x32x16_bf16 v[32:47], v[88:91], v[120:123], v[32:47]
  ds_read_b128 v[72:75], v240 offset:2048
  v_mfma_f32_32x32x16_bf16 v[48:63], v[92:95], v[120:123], v[48:63]
  ds_read_b128 v[76:79], v240 offset:3072
  s_waitcnt vmcnt(4) lgkmcnt(4)
  v_mfma_f32_32x32x16_bf16 v[0:15], v[96:99], v[124:127], v[0:15]
  ds_read_b128 v[80:83], v240 offset:4096
  v_mfma_f32_32x32x16_bf16 v[16:31], v[100:103], v[124:127], v[16:31]
  ds_read_b128 v[84:87], v240 offset:5120
  v_mfma_f32_32x32x16_bf16 v[32:47], v[104:107], v[124:127], v[32:47]
  ds_read_b128 v[88:91], v240 offset:6144
  v_mfma_f32_32x32x16_bf16 v[48:63], v[108:111], v[124:127], v[48:63]
  ds_read_b128 v[92:95], v240 offset:7168
  s_waitcnt vmcnt(3) lgkmcnt(4)
  v_mfma_f32_32x32x16_bf16 v[0:15], v[64:67], v[128:131], v[0:15]
  ds_read_b128 v[96:99], v240 offset:8192
  v_mfma_f32_32x32x16_bf16 v[16:31], v[68:71], v[128:131], v[16:31]
  ds_read_b128 v[100:103], v240 offset:9216
  v_mfma_f32_32x32x16_bf16 v[32:47], v[72:75], v[128:131], v[32:47]
  ds_read_b128 v[104:107], v240 offset:10240
  v_mfma_f32_32x32x16_bf16 v[48:63], v[76:79], v[128:131], v[48:63]
  ds_read_b128 v[108:111], v240 offset:11264
  s_waitcnt vmcnt(2) lgkmcnt(4)
  v_mfma_f32_32x32x16_bf16 v[0:15], v[80:83], v[132:135], v[0:15]
  ds_read_b128 v[64:67], v240 offset:12288
  v_mfma_f32_32x32x16_bf16 v[16:31], v[84:87], v[132:135], v[16:31]
  ds_read_b128 v[68:71], v240 offset:13312
  v_mfma_f32_32x32x16_bf16 v[32:47], v[88:91], v[132:135], v[32:47]
  ds_read_b128 v[72:75], v240 offset:14336
  v_mfma_f32_32x32x16_bf16 v[48:63], v[92:95], v[132:135], v[48:63]
  ds_read_b128 v[76:79], v240 offset:15360
  s_barrier
  s_waitcnt vmcnt(1) lgkmcnt(4)
  v_mfma_f32_32x32x16_bf16 v[0:15], v[96:99], v[136:139], v[0:15]
  v_mfma_f32_32x32x16_bf16 v[16:31], v[100:103], v[136:139], v[16:31]
  v_mfma_f32_32x32x16_bf16 v[32:47], v[104:107], v[136:139], v[32:47]
  v_mfma_f32_32x32x16_bf16 v[48:63], v[108:111], v[136:139], v[48:63]
  ds_read_b64 v[192:193], v243 offset:0
  ds_read_b64 v[196:197], v243 offset:256
  ds_read_b64 v[200:201], v243 offset:512
  ds_read_b64 v[204:205], v243 offset:768
  ds_read_b64 v[208:209], v244
  ds_read_b32 v212, v245 offset:512
  s_waitcnt vmcnt(0) lgkmcnt(6)
  v_mfma_f32_32x32x16_bf16 v[0:15], v[64:67], v[140:143], v[0:15]
  v_mfma_f32_32x32x16_bf16 v[16:31], v[68:71], v[140:143], v[16:31]
  v_mfma_f32_32x32x16_bf16 v[32:47], v[72:75], v[140:143], v[32:47]
  v_mfma_f32_32x32x16_bf16 v[48:63], v[76:79], v[140:143], v[48:63]
  s_waitcnt lgkmcnt(0)
  v_mfma_f32_32x32x16_bf16 v[0:15], v[192:195], v[208:211], v[0:15]
  v_mfma_f32_32x32x16_bf16 v[16:31], v[196:199], v[208:211], v[16:31]
  v_mfma_f32_32x32x16_bf16 v[32:47], v[200:203], v[208:211], v[32:47]
  v_mfma_f32_32x32x16_bf16 v[48:63], v[204:207], v[208:211], v[48:63]
  v_mul_f32 v213, 0x3ea52b5c, v212
  s_add_u32 s78, s5, 8
  s_mul_i32 s78, s78, 2560
  s_add_u32 s78, s78, 0
  v_add_u32 v240, s78, v255
  v_lshlrev_b32 v241, 3, v254
  v_add_u32 v241, s78, v241
  s_lshl_b32 s86, s6, 8
  s_lshl_b32 s78, s3, 4
  s_add_u32 s86, s86, s78
  s_add_u32 s86, s86, s4
  s_mul_i32 s86, s86, 24576
  s_add_u32 s87, s86, 2107392
  s_mul_i32 s78, s5, 2560
  s_add_u32 s86, s86, s78
  s_add_u32 s86, s86, 2097152
  s_mul_i32 s78, s5, 1536
  s_add_u32 s87, s87, s78
  v_lshlrev_b32 v252, 3, v254
  v_pk_mul_f32 v[0:1], v[0:1], v[212:213] op_sel:[0,0] op_sel_hi:[1,0]
  v_pk_mul_f32 v[2:3], v[2:3], v[212:213] op_sel:[0,0] op_sel_hi:[1,0]
  v_pk_mul_f32 v[4:5], v[4:5], v[212:213] op_sel:[0,0] op_sel_hi:[1,0]
  v_pk_mul_f32 v[6:7], v[6:7], v[212:213] op_sel:[0,0] op_sel_hi:[1,0]
  v_pk_mul_f32 v[8:9], v[8:9], v[212:213] op_sel:[0,0] op_sel_hi:[1,0]
  v_pk_mul_f32 v[10:11], v[10:11], v[212:213] op_sel:[0,0] op_sel_hi:[1,0]
  v_pk_mul_f32 v[12:13], v[12:13], v[212:213] op_sel:[0,0] op_sel_hi:[1,0]
  v_pk_mul_f32 v[14:15], v[14:15], v[212:213] op_sel:[0,0] op_sel_hi:[1,0]
  v_cvt_pk_bf16_f32 v152, v0, v1
  v_cvt_pk_bf16_f32 v153, v2, v3
  v_cvt_pk_bf16_f32 v154, v4, v5
  v_cvt_pk_bf16_f32 v155, v6, v7
  v_cvt_pk_bf16_f32 v164, v8, v9
  v_cvt_pk_bf16_f32 v165, v10, v11
  v_cvt_pk_bf16_f32 v166, v12, v13
  v_cvt_pk_bf16_f32 v167, v14, v15
  buffer_store_dwordx4 v[152:155], v255, s[8:11], s86 offen sc1
  v_pk_mul_f32 v[16:17], v[16:17], v[212:213] op_sel:[0,0] op_sel_hi:[1,0]
  v_pk_mul_f32 v[18:19], v[18:19], v[212:213] op_sel:[0,0] op_sel_hi:[1,0]
  v_cvt_pk_bf16_f32 v168, v16, v17
  v_cvt_pk_bf16_f32 v169, v18, v19
  v_cndmask_b32 v156, v166, v164, s[64:65]
  v_cndmask_b32 v157, v167, v165, s[64:65]
  v_cndmask_b32 v158, v168, v166, s[64:65]
  v_cndmask_b32 v159, v169, v167, s[64:65]
  v_cndmask_b32 v160, v164, v168, s[64:65]
  v_cndmask_b32 v161, v165, v169, s[64:65]
  buffer_store_dwordx4 v[156:159], v255, s[8:11], s86 offen offset:1024 sc1
  buffer_store_dwordx2 v[160:161], v252, s[8:11], s86 offen offset:2048 sc1
  v_and_b32 v243, 31, v254
  v_lshrrev_b32 v244, 5, v254
  s_lshl_b32 s78, s5, 5
  s_add_u32 s78, s78, 256
  v_add_u32 v243, s78, v243
  v_mul_u32_u24 v243, 48, v243
  v_add_u32 v243, 30720, v243
  v_lshl_add_u32 v245, v244, 3, v243
  v_mul_u32_u24 v246, 18400, v244
  v_add_u32 v246, v243, v246
  v_add_u32 v246, 32, v246
  v_add_u32 v248, 18440, v245
  v_mul_u32_u24 v249, 18432, v244
  v_add_u32 v249, v243, v249
  v_pk_mul_f32 v[20:21], v[20:21], v[212:213] op_sel:[0,0] op_sel_hi:[1,0]
  v_pk_mul_f32 v[22:23], v[22:23], v[212:213] op_sel:[0,0] op_sel_hi:[1,0]
  v_pk_mul_f32 v[24:25], v[24:25], v[212:213] op_sel:[0,0] op_sel_hi:[1,0]
  v_pk_mul_f32 v[26:27], v[26:27], v[212:213] op_sel:[0,0] op_sel_hi:[1,0]
  v_pk_mul_f32 v[28:29], v[28:29], v[212:213] op_sel:[0,0] op_sel_hi:[1,0]
  v_pk_mul_f32 v[30:31], v[30:31], v[212:213] op_sel:[0,0] op_sel_hi:[1,0]
  v_cvt_pk_bf16_f32 v170, v20, v21
  v_cvt_pk_bf16_f32 v171, v22, v23
  v_cvt_pk_bf16_f32 v172, v24, v25
  v_cvt_pk_bf16_f32 v173, v26, v27
  v_cvt_pk_bf16_f32 v174, v28, v29
  v_cvt_pk_bf16_f32 v175, v30, v31
  ds_write_b64 v245, v[170:171]
  ds_write_b64 v245, v[172:173] offset:16
  ds_write_b64 v246, v[174:175]
  v_pk_mul_f32 v[32:33], v[32:33], v[212:213] op_sel:[0,0] op_sel_hi:[1,0]
  v_pk_mul_f32 v[34:35], v[34:35], v[212:213] op_sel:[0,0] op_sel_hi:[1,0]
  v_pk_mul_f32 v[36:37], v[36:37], v[212:213] op_sel:[0,0] op_sel_hi:[1,0]
  v_pk_mul_f32 v[38:39], v[38:39], v[212:213] op_sel:[0,0] op_sel_hi:[1,0]
  v_cvt_pk_bf16_f32 v176, v32, v33
  v_cvt_pk_bf16_f32 v177, v34, v35
  v_cvt_pk_bf16_f32 v178, v36, v37
  v_cvt_pk_bf16_f32 v179, v38, v39
  ds_write_b64 v248, v[176:177]
  ds_write_b64 v248, v[178:179] offset:16
  v_mov_b32 v180, 0x3f80
  v_mov_b32 v181, 0
  ds_write_b64 v249, v[180:181] offset:40
  s_lshl_b32 s78, s5, 5
  s_add_u32 s78, s78, 256
  s_mul_i32 s78, s78, 48
  s_add_u32 s78, s78, 30720
  v_add_u32 v246, s78, v255
  v_and_b32 v247, 31, v254
  v_lshlrev_b32 v247, 4, v247
  v_mul_u32_u24 v248, 18432, v244
  v_add_u32 v248, v248, v247
  v_add_u32 v248, s78, v248
  v_mul_u32_u24 v249, 6144, v244
  v_add_u32 v249, v249, v247
  s_waitcnt lgkmcnt(0)
  ds_read_b128 v[196:199], v246
  ds_read_b128 v[200:203], v246 offset:18432
  ds_read_b128 v[204:207], v248 offset:1024
  ds_write_b128 v240, v[152:155]
  ds_write_b128 v240, v[156:159] offset:1024
  ds_write_b64 v241, v[160:161] offset:2048
  v_pk_mul_f32 v[40:41], v[40:41], v[212:213] op_sel:[0,1] op_sel_hi:[1,1]
  v_pk_mul_f32 v[42:43], v[42:43], v[212:213] op_sel:[0,1] op_sel_hi:[1,1]
  v_pk_mul_f32 v[44:45], v[44:45], v[212:213] op_sel:[0,1] op_sel_hi:[1,1]
  v_pk_mul_f32 v[46:47], v[46:47], v[212:213] op_sel:[0,1] op_sel_hi:[1,1]
  v_cvt_pk_bf16_f32 v144, v40, v41
  v_cvt_pk_bf16_f32 v145, v42, v43
  v_cvt_pk_bf16_f32 v146, v44, v45
  v_cvt_pk_bf16_f32 v147, v46, v47
  s_waitcnt lgkmcnt(3)
  s_add_u32 s88, s87, 6144
  buffer_store_dwordx4 v[196:199], v255, s[8:11], s87 offen sc1
  buffer_store_dwordx4 v[200:203], v255, s[8:11], s88 offen sc1
  buffer_store_dwordx4 v[204:207], v249, s[8:11], s87 offen offset:1024 sc1
  v_pk_mul_f32 v[48:49], v[48:49], v[212:213] op_sel:[0,1] op_sel_hi:[1,1]
  v_pk_mul_f32 v[50:51], v[50:51], v[212:213] op_sel:[0,1] op_sel_hi:[1,1]
  v_pk_mul_f32 v[52:53], v[52:53], v[212:213] op_sel:[0,1] op_sel_hi:[1,1]
  v_pk_mul_f32 v[54:55], v[54:55], v[212:213] op_sel:[0,1] op_sel_hi:[1,1]
  v_pk_mul_f32 v[56:57], v[56:57], v[212:213] op_sel:[0,1] op_sel_hi:[1,1]
  v_pk_mul_f32 v[58:59], v[58:59], v[212:213] op_sel:[0,1] op_sel_hi:[1,1]
  v_cvt_pk_bf16_f32 v182, v48, v49
  v_cvt_pk_bf16_f32 v183, v50, v51
  v_cvt_pk_bf16_f32 v184, v52, v53
  v_cvt_pk_bf16_f32 v185, v54, v55
  v_cvt_pk_bf16_f32 v186, v56, v57
  v_cvt_pk_bf16_f32 v187, v58, v59
  s_mul_i32 s78, s5, 1536
  s_add_u32 s78, s78, 67584
  v_add_u32 v250, s78, v255
  v_lshlrev_b32 v251, 3, v254
  v_add_u32 v251, s78, v251
  v_cndmask_b32 v188, v184, v182, s[64:65]
  v_cndmask_b32 v189, v185, v183, s[64:65]
  v_cndmask_b32 v190, v186, v184, s[64:65]
  v_cndmask_b32 v191, v187, v185, s[64:65]
  v_cndmask_b32 v192, 0, v186, s[64:65]
  v_cndmask_b32 v193, 0, v187, s[64:65]
  ds_write_b128 v250, v[188:191]
  ds_write_b64 v251, v[192:193] offset:1024
  v_cndmask_b32 v148, v182, 0, s[64:65]
  v_cndmask_b32 v149, v183, 0, s[64:65]
  s_lshl_b32 s78, s3, 4
  s_add_u32 s78, s78, s4
  s_lshl_b32 s78, s78, 7
  s_lshl_b32 s79, s5, 2
  s_add_u32 s78, s78, s79
  s_add_u32 s78, s78, 4128
  s_add_u32 s79, s6, 1
  v_mov_b32 v243, s79
  v_mov_b32 v244, 0
  s_waitcnt vmcnt(3)
  s_mov_b64 exec, 1
  buffer_store_dword v243, v244, s[8:11], s78 offen sc1
  s_mov_b64 exec, -1
  s_barrier
  s_and_b32 s78, s5, 3
  s_lshr_b32 s79, s5, 2
  s_mul_i32 s80, s78, 2560
  s_add_u32 s80, s80, 0
  v_lshlrev_b32 v221, 3, v254
  v_add_u32 v221, s80, v221
  s_lshl_b32 s81, s79, 10
  s_add_u32 s80, s80, s81
  v_add_u32 v220, s80, v255
  v_bfe_u32 v224, v254, 2, 2
  v_and_b32 v225, 3, v254
  v_bfe_u32 v226, v254, 4, 1
  v_lshrrev_b32 v227, 5, v254
  v_lshl_add_u32 v224, v227, 2, v224
  s_lshl_b32 s80, s78, 5
  v_add_u32 v224, s80, v224
  v_mul_u32_u24 v224, 48, v224
  v_lshl_add_u32 v224, v226, 5, v224
  v_lshl_add_u32 v224, v225, 3, v224
  s_mul_i32 s80, s79, 18432
  s_add_u32 s80, s80, 30720
  v_add_u32 v222, s80, v224
  v_mov_b32 v224, 0xffff
  v_mov_b32 v225, 0xffff0000
  v_cndmask_b32 v226, 0, v224, s[32:33]
  v_cndmask_b32 v227, 0, v225, s[34:35]
  v_or_b32 v208, v226, v227
  v_cndmask_b32 v226, 0, v224, s[36:37]
  v_cndmask_b32 v227, 0, v225, s[38:39]
  v_or_b32 v209, v226, v227
  v_cndmask_b32 v226, 0, v224, s[40:41]
  v_cndmask_b32 v227, 0, v225, s[42:43]
  v_or_b32 v210, v226, v227
  v_cndmask_b32 v226, 0, v224, s[44:45]
  v_cndmask_b32 v227, 0, v225, s[46:47]
  v_or_b32 v211, v226, v227
  v_cndmask_b32 v226, 0, v224, s[48:49]
  v_cndmask_b32 v227, 0, v225, s[50:51]
  v_or_b32 v212, v226, v227
  v_cndmask_b32 v226, 0, v224, s[52:53]
  v_cndmask_b32 v227, 0, v225, s[54:55]
  v_or_b32 v213, v226, v227
  v_cndmask_b32 v226, 0, v224, s[56:57]
  v_cndmask_b32 v227, 0, v225, s[58:59]
  v_or_b32 v214, v226, v227
  v_cndmask_b32 v226, 0, v224, s[60:61]
  v_cndmask_b32 v227, 0, v225, s[62:63]
  v_or_b32 v215, v226, v227
  v_mov_b32 v224, 0x3f80
  v_cndmask_b32 v150, v224, 0, s[64:65]
  v_mov_b32 v151, 0
  v_mov_b32 v159, 0
  v_mov_b32 v167, 0
  v_mov_b32 v175, 0
  s_mul_i32 s87, s5, 10240
  v_add_u32 v228, s87, v255
  s_mul_i32 s85, s67, 102400
  s_add_u32 s85, s85, 60817408
  s_mul_i32 s86, s4, 286720
  s_add_u32 s86, s86, 55574528
  s_lshl_b32 s78, s6, 4
  s_add_u32 s78, s78, s3
  s_mul_i32 s78, s78, 163840
  s_add_u32 s78, s78, 16777216
  s_and_b32 s79, s5, 3
  s_mul_i32 s79, s79, 40960
  s_add_u32 s78, s78, s79
  s_lshr_b32 s80, s5, 2
  s_lshl_b32 s81, s4, 1
  s_add_u32 s81, s81, s80
  s_add_u32 s82, s81, 4
  s_cmp_lt_u32 s81, 16
  s_cselect_b32 s81, s81, s82
  s_lshl_b32 s81, s81, 10
  s_add_u32 s90, s81, s78
  s_lshr_b32 s82, s4, 1
  s_add_u32 s83, s82, 16
  s_add_u32 s81, s82, 32
  s_cmp_lt_u32 s82, 4
  s_cselect_b32 s82, s83, s81
  s_lshl_b32 s82, s82, 10
  s_and_b32 s83, s4, 1
  s_lshl_b32 s83, s83, 9
  s_add_u32 s82, s82, s83
  s_lshl_b32 s83, s80, 3
  s_add_u32 s82, s82, s83
  s_add_u32 s91, s82, s78
  v_and_b32 v223, 31, v254
  v_lshlrev_b32 v223, 4, v223
  s_waitcnt vmcnt(1)
  s_lshl_b32 s78, s3, 4
  s_add_u32 s78, s78, s4
  s_lshl_b32 s78, s78, 7
  s_lshl_b32 s79, s5, 2
  s_add_u32 s78, s78, s79
  s_add_u32 s78, s78, 4144
  s_mov_b64 exec, 1
  buffer_store_dword v243, v244, s[8:11], s78 offen sc1
  s_mov_b64 exec, -1
  s_lshr_b32 s78, s5, 1
  s_and_b32 s79, s5, 1
  s_lshl_b32 s79, s79, 10
  s_mul_i32 s92, s78, 6144
  s_add_u32 s92, s92, s79
  s_add_u32 s92, s92, 30720
  s_add_u32 s94, s3, s78
  s_sub_u32 s94, s94, 2
  s_cmp_ge_i32 s94, 0
  s_cselect_b32 s93, 1, 0
  s_max_i32 s94, s94, 0
  s_lshl_b32 s78, s94, 4
  s_add_u32 s78, s78, s4
  s_lshl_b32 s89, s78, 7
  s_add_u32 s89, s89, 4144
  s_lshl_b32 s94, s6, 8
  s_add_u32 s94, s94, s78
  s_mul_i32 s94, s94, 24576
  s_add_u32 s94, s94, s79
  s_add_u32 s94, s94, 2107392
  v_mov_b32 v239, 0
  s_waitcnt lgkmcnt(0)
  s_barrier
  buffer_load_dwordx4 v[232:235], v239, s[8:11], s89 offen sc1
  s_setprio 0
  ds_read_b128 v[152:155], v220 offset:0
  ds_read_b64 v[156:157], v221 offset:2048
  v_mov_b32 v158, s70
  ds_read_b128 v[160:163], v220 offset:20480
  ds_read_b64 v[164:165], v221 offset:22528
  v_mov_b32 v166, 0
  ds_read_b128 v[168:171], v220 offset:2560
  ds_read_b64 v[172:173], v221 offset:4608
  v_mov_b32 v174, s71
  s_waitcnt lgkmcnt(4)
  v_mfma_f32_32x32x16_bf16 v[0:15], v[152:155], v[144:147], 0
  v_mfma_f32_32x32x16_bf16 v[0:15], v[156:159], v[148:151], v[0:15]
  s_add_u32 s88, s6, 1
  s_waitcnt vmcnt(0)
  s_cmp_eq_u32 s93, 0
  s_cbranch_scc1 L_hz_30
  s_mov_b32 s96, 0
  buffer_load_dwordx4 v[244:247], v239, s[8:11], s89 offen sc1
  s_branch L_hc_34
  buffer_load_dwordx4 v[232:235], v239, s[8:11], s89 offen sc1
L_hp_32:
  buffer_load_dwordx4 v[244:247], v239, s[8:11], s89 offen sc1
  s_add_u32 s96, s96, 1
  s_cmp_gt_u32 s96, 200000
  s_cbranch_scc1 L_hq_33
  s_waitcnt vmcnt(1)
L_hc_34:
  v_min_u32 v232, v232, v233
  v_min3_u32 v232, v232, v234, v235
  v_cmp_gt_u32 vcc, s88, v232
  s_cbranch_vccz L_hq_33
  buffer_load_dwordx4 v[232:235], v239, s[8:11], s89 offen sc1
  s_waitcnt vmcnt(1)
  v_min_u32 v244, v244, v245
  v_min3_u32 v244, v244, v246, v247
  v_cmp_gt_u32 vcc, s88, v244
  s_cbranch_vccnz L_hp_32
L_hq_33:
  s_add_u32 m0, s92, 0
  s_nop 0
  buffer_load_dwordx4 v255, s[8:11], s94 offen sc1 lds
  s_add_u32 s94, s94, 2048
  s_add_u32 m0, s92, 2048
  s_nop 0
  buffer_load_dwordx4 v255, s[8:11], s94 offen sc1 lds
  s_add_u32 s94, s94, 2048
  s_add_u32 m0, s92, 4096
  s_nop 0
  buffer_load_dwordx4 v255, s[8:11], s94 offen sc1 lds
  s_add_u32 s94, s94, 2048
  s_add_u32 m0, s92, 18432
  s_nop 0
  buffer_load_dwordx4 v255, s[8:11], s94 offen sc1 lds
  s_add_u32 s94, s94, 2048
  s_add_u32 m0, s92, 20480
  s_nop 0
  buffer_load_dwordx4 v255, s[8:11], s94 offen sc1 lds
  s_add_u32 s94, s94, 2048
  s_add_u32 m0, s92, 22528
  s_nop 0
  buffer_load_dwordx4 v255, s[8:11], s94 offen sc1 lds
  s_add_u32 s94, s94, 2048
  s_branch L_hd_31
L_hz_30:
  v_mov_b32 v232, 0
  v_mov_b32 v233, 0
  v_mov_b32 v234, 0
  v_mov_b32 v235, 0
  s_add_u32 s88, s92, 0
  v_add_u32 v239, s88, v255
  ds_write_b128 v239, v[232:235]
  s_add_u32 s88, s92, 2048
  v_add_u32 v239, s88, v255
  ds_write_b128 v239, v[232:235]
  s_add_u32 s88, s92, 4096
  v_add_u32 v239, s88, v255
  ds_write_b128 v239, v[232:235]
  s_add_u32 s88, s92, 18432
  v_add_u32 v239, s88, v255
  ds_write_b128 v239, v[232:235]
  s_add_u32 s88, s92, 20480
  v_add_u32 v239, s88, v255
  ds_write_b128 v239, v[232:235]
  s_add_u32 s88, s92, 22528
  v_add_u32 v239, s88, v255
  ds_write_b128 v239, v[232:235]
L_hd_31:
  ds_read_b128 v[152:155], v220 offset:5120
  ds_read_b64 v[156:157], v221 offset:7168
  v_mov_b32 v158, s72
  s_waitcnt lgkmcnt(4)
  v_mfma_f32_32x32x16_bf16 v[128:143], v[160:163], v[144:147], 0
  v_mfma_f32_32x32x16_bf16 v[128:143], v[164:167], v[148:151], v[128:143]
  ds_read_b128 v[160:163], v220 offset:7680
  ds_read_b64 v[164:165], v221 offset:9728
  v_mov_b32 v166, s73
  s_waitcnt lgkmcnt(4)
  v_mfma_f32_32x32x16_bf16 v[16:31], v[168:171], v[144:147], 0
  v_mfma_f32_32x32x16_bf16 v[16:31], v[172:175], v[148:151], v[16:31]
  ds_read_b128 v[168:171], v220 offset:10240
  ds_read_b64 v[172:173], v221 offset:12288
  v_mov_b32 v174, s74
  s_waitcnt lgkmcnt(4)
  v_mfma_f32_32x32x16_bf16 v[32:47], v[152:155], v[144:147], 0
  v_cndmask_b32 v128, v0, v128, s[32:33]
  v_cndmask_b32 v129, v1, v129, s[34:35]
  v_cndmask_b32 v130, v2, v130, s[36:37]
  v_mfma_f32_32x32x16_bf16 v[32:47], v[156:159], v[148:151], v[32:47]
  v_cndmask_b32 v131, v3, v131, s[38:39]
  v_cndmask_b32 v132, v4, v132, s[40:41]
  v_cndmask_b32 v133, v5, v133, s[42:43]
  ds_read_b128 v[152:155], v220 offset:12800
  ds_read_b64 v[156:157], v221 offset:14848
  v_mov_b32 v158, s75
  s_waitcnt lgkmcnt(4)
  v_mfma_f32_32x32x16_bf16 v[48:63], v[160:163], v[144:147], 0
  v_cndmask_b32 v134, v6, v134, s[44:45]
  v_cndmask_b32 v135, v7, v135, s[46:47]
  v_cndmask_b32 v136, v8, v136, s[48:49]
  v_mfma_f32_32x32x16_bf16 v[48:63], v[164:167], v[148:151], v[48:63]
  v_cndmask_b32 v137, v9, v137, s[50:51]
  v_cndmask_b32 v138, v10, v138, s[52:53]
  v_cndmask_b32 v139, v11, v139, s[54:55]
  ds_read_b128 v[160:163], v220 offset:15360
  ds_read_b64 v[164:165], v221 offset:17408
  v_mov_b32 v166, s76
  s_waitcnt lgkmcnt(4)
  v_mfma_f32_32x32x16_bf16 v[64:79], v[168:171], v[144:147], 0
  v_cndmask_b32 v140, v12, v140, s[56:57]
  v_cndmask_b32 v141, v13, v141, s[58:59]
  v_cndmask_b32 v142, v14, v142, s[60:61]
  v_mfma_f32_32x32x16_bf16 v[64:79], v[172:175], v[148:151], v[64:79]
  v_cndmask_b32 v143, v15, v143, s[62:63]
  v_exp_f32 v16, v16
  v_exp_f32 v17, v17
  ds_read_b128 v[168:171], v220 offset:17920
  ds_read_b64 v[172:173], v221 offset:19968
  v_mov_b32 v174, s77
  s_waitcnt lgkmcnt(4)
  v_mfma_f32_32x32x16_bf16 v[80:95], v[152:155], v[144:147], 0
  v_exp_f32 v18, v18
  v_exp_f32 v19, v19
  v_exp_f32 v20, v20
  v_mfma_f32_32x32x16_bf16 v[80:95], v[156:159], v[148:151], v[80:95]
  v_exp_f32 v21, v21
  v_exp_f32 v22, v22
  v_exp_f32 v23, v23
  s_waitcnt lgkmcnt(2)
  v_mfma_f32_32x32x16_bf16 v[96:111], v[160:163], v[144:147], 0
  v_cvt_pk_bf16_f32 v16, v16, v17
  v_cvt_pk_bf16_f32 v17, v18, v19
  v_exp_f32 v24, v24
  v_mfma_f32_32x32x16_bf16 v[96:111], v[164:167], v[148:151], v[96:111]
  v_exp_f32 v25, v25
  v_exp_f32 v26, v26
  v_exp_f32 v27, v27
  s_waitcnt lgkmcnt(0)
  v_mfma_f32_32x32x16_bf16 v[112:127], v[168:171], v[144:147], 0
  v_cvt_pk_bf16_f32 v18, v20, v21
  v_cvt_pk_bf16_f32 v19, v22, v23
  v_exp_f32 v28, v28
  v_mfma_f32_32x32x16_bf16 v[112:127], v[172:175], v[148:151], v[112:127]
  v_exp_f32 v29, v29
  v_exp_f32 v30, v30
  v_exp_f32 v31, v31
  s_waitcnt vmcnt(0)
  s_waitcnt lgkmcnt(0)
  s_barrier
  ds_read_b64_tr_b16 v[176:177], v222 offset:1536
  ds_read_b64_tr_b16 v[178:179], v222 offset:1920
  ds_read_b64_tr_b16 v[180:181], v222 offset:2304
  ds_read_b64_tr_b16 v[182:183], v222 offset:2688
  ds_read_b64_tr_b16 v[184:185], v222 offset:3072
  ds_read_b64_tr_b16 v[186:187], v222 offset:3456
  ds_read_b64_tr_b16 v[188:189], v222 offset:3840
  ds_read_b64_tr_b16 v[190:191], v222 offset:4224
  v_cvt_pk_bf16_f32 v20, v24, v25
  v_cvt_pk_bf16_f32 v21, v26, v27
  v_cvt_pk_bf16_f32 v22, v28, v29
  v_cvt_pk_bf16_f32 v23, v30, v31
  v_exp_f32 v32, v32
  s_waitcnt lgkmcnt(4)
  v_mfma_f32_32x32x16_bf16 v[192:207], v[176:179], v[16:19], 0
  v_exp_f32 v33, v33
  v_exp_f32 v34, v34
  v_exp_f32 v35, v35
  v_exp_f32 v36, v36
  v_mfma_f32_32x32x16_bf16 v[192:207], v[180:183], v[20:23], v[192:207]
  ds_read_b64_tr_b16 v[176:177], v222 offset:4608
  ds_read_b64_tr_b16 v[178:179], v222 offset:4992
  ds_read_b64_tr_b16 v[180:181], v222 offset:5376
  ds_read_b64_tr_b16 v[182:183], v222 offset:5760
  s_add_u32 m0, s87, 73728
  s_add_u32 s84, s85, 0
  buffer_load_dwordx4 v228, s[8:11], s84 offen offset:0 lds
  buffer_load_dwordx4 v228, s[8:11], s84 offen offset:1024 lds
  buffer_load_dwordx4 v228, s[8:11], s84 offen offset:2048 lds
  buffer_load_dwordx4 v228, s[8:11], s84 offen offset:3072 lds
  v_exp_f32 v37, v37
  v_exp_f32 v38, v38
  v_exp_f32 v39, v39
  v_cvt_pk_bf16_f32 v32, v32, v33
  v_cvt_pk_bf16_f32 v33, v34, v35
  v_exp_f32 v40, v40
  v_exp_f32 v41, v41
  v_exp_f32 v42, v42
  v_exp_f32 v43, v43
  v_cvt_pk_bf16_f32 v34, v36, v37
  v_cvt_pk_bf16_f32 v35, v38, v39
  v_exp_f32 v44, v44
  v_exp_f32 v45, v45
  v_exp_f32 v46, v46
  v_exp_f32 v47, v47
  v_cvt_pk_bf16_f32 v36, v40, v41
  v_cvt_pk_bf16_f32 v37, v42, v43
  v_cvt_pk_bf16_f32 v38, v44, v45
  v_cvt_pk_bf16_f32 v39, v46, v47
  v_exp_f32 v48, v48
  s_waitcnt lgkmcnt(4)
  v_mfma_f32_32x32x16_bf16 v[192:207], v[184:187], v[32:35], v[192:207]
  v_exp_f32 v49, v49
  v_exp_f32 v50, v50
  v_exp_f32 v51, v51
  v_exp_f32 v52, v52
  v_mfma_f32_32x32x16_bf16 v[192:207], v[188:191], v[36:39], v[192:207]
  ds_read_b64_tr_b16 v[184:185], v222 offset:6144
  ds_read_b64_tr_b16 v[186:187], v222 offset:6528
  ds_read_b64_tr_b16 v[188:189], v222 offset:6912
  ds_read_b64_tr_b16 v[190:191], v222 offset:7296
  s_add_u32 m0, s87, 77824
  s_add_u32 s84, s85, 4096
  buffer_load_dwordx4 v228, s[8:11], s84 offen offset:0 lds
  buffer_load_dwordx4 v228, s[8:11], s84 offen offset:1024 lds
  buffer_load_dwordx4 v228, s[8:11], s84 offen offset:2048 lds
  buffer_load_dwordx4 v228, s[8:11], s84 offen offset:3072 lds
  v_exp_f32 v53, v53
  v_exp_f32 v54, v54
  v_exp_f32 v55, v55
  v_cvt_pk_bf16_f32 v48, v48, v49
  v_cvt_pk_bf16_f32 v49, v50, v51
  v_exp_f32 v56, v56
  v_exp_f32 v57, v57
  v_exp_f32 v58, v58
  v_exp_f32 v59, v59
  v_cvt_pk_bf16_f32 v50, v52, v53
  v_cvt_pk_bf16_f32 v51, v54, v55
  v_exp_f32 v60, v60
  v_exp_f32 v61, v61
  v_exp_f32 v62, v62
  v_exp_f32 v63, v63
  v_cvt_pk_bf16_f32 v52, v56, v57
  v_cvt_pk_bf16_f32 v53, v58, v59
  v_cvt_pk_bf16_f32 v54, v60, v61
  v_cvt_pk_bf16_f32 v55, v62, v63
  v_exp_f32 v64, v64
  s_waitcnt lgkmcnt(4)
  v_mfma_f32_32x32x16_bf16 v[192:207], v[176:179], v[48:51], v[192:207]
  v_exp_f32 v65, v65
  v_exp_f32 v66, v66
  v_exp_f32 v67, v67
  v_exp_f32 v68, v68
  v_mfma_f32_32x32x16_bf16 v[192:207], v[180:183], v[52:55], v[192:207]
  ds_read_b64_tr_b16 v[176:177], v222 offset:7680
  ds_read_b64_tr_b16 v[178:179], v222 offset:8064
  ds_read_b64_tr_b16 v[180:181], v222 offset:8448
  ds_read_b64_tr_b16 v[182:183], v222 offset:8832
  s_add_u32 m0, s87, 81920
  s_add_u32 s84, s85, 8192
  buffer_load_dwordx4 v228, s[8:11], s84 offen offset:0 lds
  buffer_load_dwordx4 v228, s[8:11], s84 offen offset:1024 lds
  v_exp_f32 v69, v69
  v_exp_f32 v70, v70
  v_exp_f32 v71, v71
  v_cvt_pk_bf16_f32 v64, v64, v65
  v_cvt_pk_bf16_f32 v65, v66, v67
  v_exp_f32 v72, v72
  v_exp_f32 v73, v73
  v_exp_f32 v74, v74
  v_exp_f32 v75, v75
  v_cvt_pk_bf16_f32 v66, v68, v69
  v_cvt_pk_bf16_f32 v67, v70, v71
  v_exp_f32 v76, v76
  v_exp_f32 v77, v77
  v_exp_f32 v78, v78
  v_exp_f32 v79, v79
  v_cvt_pk_bf16_f32 v68, v72, v73
  v_cvt_pk_bf16_f32 v69, v74, v75
  v_cvt_pk_bf16_f32 v70, v76, v77
  v_cvt_pk_bf16_f32 v71, v78, v79
  v_exp_f32 v80, v80
  s_waitcnt lgkmcnt(4)
  v_mfma_f32_32x32x16_bf16 v[192:207], v[184:187], v[64:67], v[192:207]
  v_exp_f32 v81, v81
  v_exp_f32 v82, v82
  v_exp_f32 v83, v83
  v_exp_f32 v84, v84
  v_mfma_f32_32x32x16_bf16 v[192:207], v[188:191], v[68:71], v[192:207]
  ds_read_b64_tr_b16 v[184:185], v222 offset:9216
  ds_read_b64_tr_b16 v[186:187], v222 offset:9600
  ds_read_b64_tr_b16 v[188:189], v222 offset:9984
  ds_read_b64_tr_b16 v[190:191], v222 offset:10368
  s_and_b32 s88, s3, 1
  s_lshl_b32 s88, s88, 1
  s_add_u32 s88, s88, s68
  s_mul_i32 s88, s88, 5120
  s_add_u32 s88, s88, s85
  s_add_u32 s88, s88, 81920
  v_lshlrev_b32 v229, 7, v254
  s_lshl_b32 s89, s5, 13
  s_add_u32 s89, s89, 0
  v_add_u32 v229, s89, v229
  v_min_u32 v229, 4992, v229
  buffer_load_dword v219, v229, s[8:11], s88 offen
  v_exp_f32 v85, v85
  v_exp_f32 v86, v86
  v_exp_f32 v87, v87
  v_cvt_pk_bf16_f32 v80, v80, v81
  v_cvt_pk_bf16_f32 v81, v82, v83
  v_exp_f32 v88, v88
  v_exp_f32 v89, v89
  v_exp_f32 v90, v90
  v_exp_f32 v91, v91
  v_cvt_pk_bf16_f32 v82, v84, v85
  v_cvt_pk_bf16_f32 v83, v86, v87
  v_exp_f32 v92, v92
  v_exp_f32 v93, v93
  v_exp_f32 v94, v94
  v_exp_f32 v95, v95
  v_cvt_pk_bf16_f32 v84, v88, v89
  v_cvt_pk_bf16_f32 v85, v90, v91
  v_cvt_pk_bf16_f32 v86, v92, v93
  v_cvt_pk_bf16_f32 v87, v94, v95
  v_exp_f32 v96, v96
  s_waitcnt lgkmcnt(4)
  v_mfma_f32_32x32x16_bf16 v[192:207], v[176:179], v[80:83], v[192:207]
  v_exp_f32 v97, v97
  v_exp_f32 v98, v98
  v_exp_f32 v99, v99
  v_exp_f32 v100, v100
  v_mfma_f32_32x32x16_bf16 v[192:207], v[180:183], v[84:87], v[192:207]
  ds_read_b64_tr_b16 v[176:177], v222 offset:10752
  ds_read_b64_tr_b16 v[178:179], v222 offset:11136
  ds_read_b64_tr_b16 v[180:181], v222 offset:11520
  ds_read_b64_tr_b16 v[182:183], v222 offset:11904
  v_exp_f32 v101, v101
  v_exp_f32 v102, v102
  v_exp_f32 v103, v103
  v_cvt_pk_bf16_f32 v96, v96, v97
  v_cvt_pk_bf16_f32 v97, v98, v99
  v_exp_f32 v104, v104
  v_exp_f32 v105, v105
  v_exp_f32 v106, v106
  v_exp_f32 v107, v107
  v_cvt_pk_bf16_f32 v98, v100, v101
  v_cvt_pk_bf16_f32 v99, v102, v103
  v_exp_f32 v108, v108
  v_exp_f32 v109, v109
  v_exp_f32 v110, v110
  v_exp_f32 v111, v111
  v_cvt_pk_bf16_f32 v100, v104, v105
  v_cvt_pk_bf16_f32 v101, v106, v107
  v_cvt_pk_bf16_f32 v102, v108, v109
  v_cvt_pk_bf16_f32 v103, v110, v111
  v_exp_f32 v112, v112
  s_waitcnt lgkmcnt(4)
  v_mfma_f32_32x32x16_bf16 v[192:207], v[184:187], v[96:99], v[192:207]
  v_exp_f32 v113, v113
  v_exp_f32 v114, v114
  v_exp_f32 v115, v115
  v_exp_f32 v116, v116
  v_mfma_f32_32x32x16_bf16 v[192:207], v[188:191], v[100:103], v[192:207]
  ds_read_b64_tr_b16 v[184:185], v222 offset:12288
  ds_read_b64_tr_b16 v[186:187], v222 offset:12672
  ds_read_b64_tr_b16 v[188:189], v222 offset:13056
  ds_read_b64_tr_b16 v[190:191], v222 offset:13440
  v_exp_f32 v117, v117
  v_exp_f32 v118, v118
  v_exp_f32 v119, v119
  v_cvt_pk_bf16_f32 v112, v112, v113
  v_cvt_pk_bf16_f32 v113, v114, v115
  v_exp_f32 v120, v120
  v_exp_f32 v121, v121
  v_exp_f32 v122, v122
  v_exp_f32 v123, v123
  v_cvt_pk_bf16_f32 v114, v116, v117
  v_cvt_pk_bf16_f32 v115, v118, v119
  v_exp_f32 v124, v124
  v_exp_f32 v125, v125
  v_exp_f32 v126, v126
  v_exp_f32 v127, v127
  v_cvt_pk_bf16_f32 v116, v120, v121
  v_cvt_pk_bf16_f32 v117, v122, v123
  v_cvt_pk_bf16_f32 v118, v124, v125
  v_cvt_pk_bf16_f32 v119, v126, v127
  v_exp_f32 v128, v128
  s_waitcnt lgkmcnt(4)
  v_mfma_f32_32x32x16_bf16 v[192:207], v[176:179], v[112:115], v[192:207]
  v_exp_f32 v129, v129
  v_exp_f32 v130, v130
  v_exp_f32 v131, v131
  v_exp_f32 v132, v132
  v_mfma_f32_32x32x16_bf16 v[192:207], v[180:183], v[116:119], v[192:207]
  ds_read_b64_tr_b16 v[176:177], v222 offset:0
  ds_read_b64_tr_b16 v[178:179], v222 offset:384
  ds_read_b64_tr_b16 v[180:181], v222 offset:768
  ds_read_b64_tr_b16 v[182:183], v222 offset:1152
  v_exp_f32 v133, v133
  v_exp_f32 v134, v134
  v_exp_f32 v135, v135
  v_cvt_pk_bf16_f32 v128, v128, v129
  v_cvt_pk_bf16_f32 v129, v130, v131
  v_exp_f32 v136, v136
  v_exp_f32 v137, v137
  v_exp_f32 v138, v138
  v_exp_f32 v139, v139
  v_cvt_pk_bf16_f32 v130, v132, v133
  v_cvt_pk_bf16_f32 v131, v134, v135
  v_exp_f32 v140, v140
  v_exp_f32 v141, v141
  v_exp_f32 v142, v142
  v_exp_f32 v143, v143
  v_cvt_pk_bf16_f32 v132, v136, v137
  v_cvt_pk_bf16_f32 v133, v138, v139
  v_cvt_pk_bf16_f32 v134, v140, v141
  v_cvt_pk_bf16_f32 v135, v142, v143
  v_and_b32 v8, v208, v128
  v_and_b32 v9, v209, v129
  v_and_b32 v10, v210, v130
  v_and_b32 v11, v211, v131
  v_and_b32 v12, v212, v132
  v_and_b32 v13, v213, v133
  v_and_b32 v14, v214, v134
  v_and_b32 v15, v215, v135
  v_xor_b32 v0, v128, v8
  v_xor_b32 v1, v129, v9
  v_xor_b32 v2, v130, v10
  v_xor_b32 v3, v131, v11
  v_xor_b32 v4, v132, v12
  v_xor_b32 v5, v133, v13
  v_xor_b32 v6, v134, v14
  v_xor_b32 v7, v135, v15
  s_waitcnt lgkmcnt(4)
  v_mfma_f32_32x32x16_bf16 v[192:207], v[184:187], v[8:11], v[192:207]
  v_mfma_f32_32x32x16_bf16 v[192:207], v[188:191], v[12:15], v[192:207]
  s_waitcnt lgkmcnt(0)
  v_mfma_f32_32x32x16_bf16 v[192:207], v[176:179], v[0:3], v[192:207]
  v_mfma_f32_32x32x16_bf16 v[192:207], v[180:183], v[4:7], v[192:207]
  s_setprio 0
  s_nop 10
  v_mov_b32 v224, v200
  v_mov_b32 v225, v200
  s_nop 1
  v_permlane32_swap_b32 v224, v225
  v_cmp_nle_f32 vcc, 0x30800000, v225
  v_mov_b32 v227, 0x4e800000
  v_cmp_nge_f32 s[78:79], v227, v225
  s_nop 1
  s_or_b64 vcc, vcc, s[78:79]
  s_cbranch_vccnz L_attfb_P
L_attnorm_P:
  v_rcp_f32 v226, v225
  s_nop 0
  v_pk_mul_f32 v[192:193], v[192:193], v[226:227] op_sel_hi:[1,0]
  v_pk_mul_f32 v[194:195], v[194:195], v[226:227] op_sel_hi:[1,0]
  v_pk_mul_f32 v[196:197], v[196:197], v[226:227] op_sel_hi:[1,0]
  v_pk_mul_f32 v[198:199], v[198:199], v[226:227] op_sel_hi:[1,0]
  v_pk_mul_f32 v[200:201], v[200:201], v[226:227] op_sel_hi:[1,0]
  v_pk_mul_f32 v[202:203], v[202:203], v[226:227] op_sel_hi:[1,0]
  v_cvt_pk_bf16_f32 v192, v192, v193
  v_cvt_pk_bf16_f32 v193, v194, v195
  v_cvt_pk_bf16_f32 v194, v196, v197
  v_cvt_pk_bf16_f32 v195, v198, v199
  v_cvt_pk_bf16_f32 v196, v200, v201
  v_cvt_pk_bf16_f32 v197, v202, v203
  s_cmp_eq_u32 s7, 0
  s_cbranch_scc1 L_slow_35
  buffer_store_dwordx4 v[192:195], v255, s[8:11], s90 offen
  s_branch L_join_36
L_slow_35:
  buffer_store_dwordx4 v[192:195], v255, s[8:11], s90 offen sc1
L_join_36:
  s_mov_b32 exec_hi, 0
  s_cmp_eq_u32 s7, 0
  s_cbranch_scc1 L_slow_37
  buffer_store_dwordx2 v[196:197], v223, s[8:11], s91 offen
  s_branch L_join_38
L_slow_37:
  buffer_store_dwordx2 v[196:197], v223, s[8:11], s91 offen sc1
L_join_38:
  s_mov_b32 exec_hi, -1
  s_waitcnt vmcnt(0)
  s_barrier
  s_add_u32 s66, s66, 1
  s_lshl_b32 s91, s3, 8
  s_add_u32 s91, s91, 0
  s_lshl_b32 s79, s4, 2
  s_add_u32 s79, s79, s5
  s_lshl_b32 s79, s79, 2
  v_mov_b32 v243, s66
  v_mov_b32 v244, s79
  v_lshlrev_b32 v250, 2, v254
  s_mov_b64 exec, 1
  s_cmp_eq_u32 s7, 0
  s_cbranch_scc1 L_slow_39
  buffer_store_dword v243, v244, s[8:11], s91 offen
  s_branch L_join_40
L_slow_39:
  buffer_store_dword v243, v244, s[8:11], s91 offen sc1
L_join_40:
  s_mov_b64 exec, -1
  s_and_b32 s92, s5, 1
  s_lshr_b32 s93, s5, 1
  s_mul_i32 s78, s93, 2560
  v_add_u32 v242, s78, v255
  v_and_b32 v243, 15, v254
  v_lshlrev_b32 v243, 4, v243
  v_lshrrev_b32 v244, 5, v254
  v_lshl_add_u32 v243, v244, 8, v243
  s_add_u32 s78, s78, 2048
  v_add_u32 v238, s78, v243
  s_lshl_b32 s94, s68, 1
  s_add_u32 s94, s94, s92
  s_lshl_b32 s84, s6, 4
  s_add_u32 s84, s84, s3
  s_mul_i32 s84, s84, 163840
  s_mul_i32 s78, s94, 40960
  s_add_u32 s84, s84, s78
  s_mul_i32 s78, s93, 20480
  s_add_u32 s84, s84, s78
  s_add_u32 s84, s84, 16777216
  s_mul_i32 s81, s3, 163840
  s_mul_i32 s82, s94, 40960
  s_add_u32 s81, s81, s82
  s_mul_i32 s82, s67, 5120
  s_add_u32 s81, s81, s82
  s_mul_i32 s82, s93, 3072
  s_add_u32 s81, s81, s82
  s_add_u32 s81, s81, 25165824
  s_mul_i32 s86, s6, 5242880
  s_add_u32 s86, s86, s81
  s_add_u32 s88, s86, 2621440
  s_mov_b32 s89, 1024
  v_mov_b32 v239, v255
  s_mov_b32 s20, s8
  s_mov_b32 s21, s9
  s_mov_b32 s22, s10
  s_lshl_b32 s90, s6, 1
  s_add_u32 s90, s90, 1
  s_lshl_b32 s90, s90, 18
  s_lshl_b32 s78, s3, 14
  s_add_u32 s90, s90, s78
  s_lshl_b32 s78, s94, 12
  s_add_u32 s90, s90, s78
  s_lshl_b32 s78, s67, 9
  s_add_u32 s90, s90, s78
  s_lshl_b32 s78, s93, 3
  s_add_u32 s90, s90, s78
  s_add_u32 s90, s90, 65536
  s_mov_b32 s96, 0
L_poll_o_41:
  buffer_load_dword v251, v250, s[8:11], s91 offen sc1
  s_add_u32 s96, s96, 1
  s_cmp_gt_u32 s96, 200000
  s_cbranch_scc1 L_done_o_42
  s_waitcnt vmcnt(0)
  v_cmp_gt_u32 vcc, s66, v251
  s_cbranch_vccnz L_poll_o_41
L_done_o_42:
  s_waitcnt vmcnt(0)
  buffer_load_dwordx4 v[84:87], v255, s[8:11], s84 offen offset:0 sc1
  buffer_load_dwordx4 v[88:91], v255, s[8:11], s84 offen offset:1024 sc1
  buffer_load_dwordx4 v[92:95], v255, s[8:11], s84 offen offset:2048 sc1
  buffer_load_dwordx4 v[96:99], v255, s[8:11], s84 offen offset:3072 sc1
  s_add_u32 s84, s84, 4096
  buffer_load_dwordx4 v[100:103], v255, s[8:11], s84 offen offset:0 sc1
  buffer_load_dwordx4 v[104:107], v255, s[8:11], s84 offen offset:1024 sc1
  s_barrier
  v_add_u32 v240, 73728, v242
  v_add_u32 v237, 73728, v238
  ds_read_b128 v[48:51], v240 offset:0
  ds_read_b128 v[52:55], v240 offset:1024
  ds_read_b128 v[56:59], v237 offset:0
  ds_read_b128 v[60:63], v240 offset:5120
  ds_read_b128 v[64:67], v240 offset:6144
  ds_read_b128 v[68:71], v237 offset:5120
  s_waitcnt vmcnt(5) lgkmcnt(3)
  v_mfma_f32_32x32x16_bf16 v[0:15], v[48:51], v[84:87], 0
  ds_read_b128 v[72:75], v240 offset:10240
  buffer_load_dwordx4 v[108:111], v255, s[8:11], s84 offen offset:2048 sc1
  buffer_load_dwordx4 v[112:115], v255, s[8:11], s84 offen offset:3072 sc1
  s_add_u32 s84, s84, 4096
  v_mfma_f32_32x32x16_bf16 v[16:31], v[52:55], v[84:87], 0
  ds_read_b128 v[76:79], v240 offset:11264
  v_mfma_f32_32x32x16_bf16 v[32:47], v[56:59], v[84:87], 0
  ds_read_b128 v[80:83], v237 offset:10240
  s_waitcnt vmcnt(6) lgkmcnt(3)
  v_mfma_f32_32x32x16_bf16 v[0:15], v[60:63], v[88:91], v[0:15]
  ds_read_b128 v[48:51], v240 offset:15360
  buffer_load_dwordx4 v[116:119], v255, s[8:11], s84 offen offset:0 sc1
  buffer_load_dwordx4 v[120:123], v255, s[8:11], s84 offen offset:1024 sc1
  v_mfma_f32_32x32x16_bf16 v[16:31], v[64:67], v[88:91], v[16:31]
  ds_read_b128 v[52:55], v240 offset:16384
  v_mfma_f32_32x32x16_bf16 v[32:47], v[68:71], v[88:91], v[32:47]
  ds_read_b128 v[56:59], v237 offset:15360
  s_barrier
  v_add_u32 v240, 94208, v242
  v_add_u32 v237, 94208, v238
  s_waitcnt vmcnt(7) lgkmcnt(3)
  v_mfma_f32_32x32x16_bf16 v[0:15], v[72:75], v[92:95], v[0:15]
  ds_read_b128 v[60:63], v240 offset:0
  buffer_load_dwordx4 v[124:127], v255, s[8:11], s84 offen offset:2048 sc1
  buffer_load_dwordx4 v[128:131], v255, s[8:11], s84 offen offset:3072 sc1
  s_add_u32 s84, s84, 4096
  v_mfma_f32_32x32x16_bf16 v[16:31], v[76:79], v[92:95], v[16:31]
  ds_read_b128 v[64:67], v240 offset:1024
  v_mfma_f32_32x32x16_bf16 v[32:47], v[80:83], v[92:95], v[32:47]
  ds_read_b128 v[68:71], v237 offset:0
  s_waitcnt vmcnt(8) lgkmcnt(3)
  v_mfma_f32_32x32x16_bf16 v[0:15], v[48:51], v[96:99], v[0:15]
  ds_read_b128 v[72:75], v240 offset:5120
  buffer_load_dwordx4 v[132:135], v255, s[8:11], s84 offen offset:0 sc1
  buffer_load_dwordx4 v[136:139], v255, s[8:11], s84 offen offset:1024 sc1
  v_mfma_f32_32x32x16_bf16 v[16:31], v[52:55], v[96:99], v[16:31]
  ds_read_b128 v[76:79], v240 offset:6144
  v_mfma_f32_32x32x16_bf16 v[32:47], v[56:59], v[96:99], v[32:47]
  ds_read_b128 v[80:83], v237 offset:5120
  s_waitcnt vmcnt(9) lgkmcnt(3)
  v_mfma_f32_32x32x16_bf16 v[0:15], v[60:63], v[100:103], v[0:15]
  ds_read_b128 v[48:51], v240 offset:10240
  buffer_load_dwordx4 v[140:143], v255, s[8:11], s84 offen offset:2048 sc1
  buffer_load_dwordx4 v[144:147], v255, s[8:11], s84 offen offset:3072 sc1
  s_add_u32 s84, s84, 4096
  v_mfma_f32_32x32x16_bf16 v[16:31], v[64:67], v[100:103], v[16:31]
  ds_read_b128 v[52:55], v240 offset:11264
  v_mfma_f32_32x32x16_bf16 v[32:47], v[68:71], v[100:103], v[32:47]
  ds_read_b128 v[56:59], v237 offset:10240
  s_waitcnt vmcnt(10) lgkmcnt(3)
  v_mfma_f32_32x32x16_bf16 v[0:15], v[72:75], v[104:107], v[0:15]
  ds_read_b128 v[60:63], v240 offset:15360
  buffer_load_dwordx4 v[148:151], v255, s[8:11], s84 offen offset:0 sc1
  buffer_load_dwordx4 v[152:155], v255, s[8:11], s84 offen offset:1024 sc1
  v_mfma_f32_32x32x16_bf16 v[16:31], v[76:79], v[104:107], v[16:31]
  ds_read_b128 v[64:67], v240 offset:16384
  v_mfma_f32_32x32x16_bf16 v[32:47], v[80:83], v[104:107], v[32:47]
  ds_read_b128 v[68:71], v237 offset:15360
  s_barrier
  v_add_u32 v240, 114688, v242
  v_add_u32 v237, 114688, v238
  s_waitcnt vmcnt(11) lgkmcnt(3)
  v_mfma_f32_32x32x16_bf16 v[0:15], v[48:51], v[108:111], v[0:15]
  ds_read_b128 v[72:75], v240 offset:0
  buffer_load_dwordx4 v[156:159], v255, s[8:11], s84 offen offset:2048 sc1
  buffer_load_dwordx4 v[160:163], v255, s[8:11], s84 offen offset:3072 sc1
  s_add_u32 s84, s84, 4096
  v_mfma_f32_32x32x16_bf16 v[16:31], v[52:55], v[108:111], v[16:31]
  ds_read_b128 v[76:79], v240 offset:1024
  v_mfma_f32_32x32x16_bf16 v[32:47], v[56:59], v[108:111], v[32:47]
  ds_read_b128 v[80:83], v237 offset:0
  s_waitcnt vmcnt(12) lgkmcnt(3)
  v_mfma_f32_32x32x16_bf16 v[0:15], v[60:63], v[112:115], v[0:15]
  ds_read_b128 v[48:51], v240 offset:5120
  v_mfma_f32_32x32x16_bf16 v[16:31], v[64:67], v[112:115], v[16:31]
  ds_read_b128 v[52:55], v240 offset:6144
  v_mfma_f32_32x32x16_bf16 v[32:47], v[68:71], v[112:115], v[32:47]
  ds_read_b128 v[56:59], v237 offset:5120
  s_waitcnt vmcnt(11) lgkmcnt(3)
  v_mfma_f32_32x32x16_bf16 v[0:15], v[72:75], v[116:119], v[0:15]
  ds_read_b128 v[60:63], v240 offset:10240
  v_mfma_f32_32x32x16_bf16 v[16:31], v[76:79], v[116:119], v[16:31]
  ds_read_b128 v[64:67], v240 offset:11264
  v_mfma_f32_32x32x16_bf16 v[32:47], v[80:83], v[116:119], v[32:47]
  ds_read_b128 v[68:71], v237 offset:10240
  s_waitcnt vmcnt(10) lgkmcnt(3)
  v_mfma_f32_32x32x16_bf16 v[0:15], v[48:51], v[120:123], v[0:15]
  ds_read_b128 v[72:75], v240 offset:15360
  v_mfma_f32_32x32x16_bf16 v[16:31], v[52:55], v[120:123], v[16:31]
  ds_read_b128 v[76:79], v240 offset:16384
  v_mfma_f32_32x32x16_bf16 v[32:47], v[56:59], v[120:123], v[32:47]
  ds_read_b128 v[80:83], v237 offset:15360
  s_barrier
  v_add_u32 v240, 135168, v242
  v_add_u32 v237, 135168, v238
  s_waitcnt vmcnt(9) lgkmcnt(3)
  v_mfma_f32_32x32x16_bf16 v[0:15], v[60:63], v[124:127], v[0:15]
  ds_read_b128 v[48:51], v240 offset:0
  v_mfma_f32_32x32x16_bf16 v[16:31], v[64:67], v[124:127], v[16:31]
  ds_read_b128 v[52:55], v240 offset:1024
  v_mfma_f32_32x32x16_bf16 v[32:47], v[68:71], v[124:127], v[32:47]
  ds_read_b128 v[56:59], v237 offset:0
  s_waitcnt vmcnt(8) lgkmcnt(3)
  v_mfma_f32_32x32x16_bf16 v[0:15], v[72:75], v[128:131], v[0:15]
  ds_read_b128 v[60:63], v240 offset:5120
  v_mfma_f32_32x32x16_bf16 v[16:31], v[76:79], v[128:131], v[16:31]
  ds_read_b128 v[64:67], v240 offset:6144
  v_mfma_f32_32x32x16_bf16 v[32:47], v[80:83], v[128:131], v[32:47]
  ds_read_b128 v[68:71], v237 offset:5120
  s_waitcnt vmcnt(7) lgkmcnt(3)
  v_mfma_f32_32x32x16_bf16 v[0:15], v[48:51], v[132:135], v[0:15]
  ds_read_b128 v[72:75], v240 offset:10240
  v_mfma_f32_32x32x16_bf16 v[16:31], v[52:55], v[132:135], v[16:31]
  ds_read_b128 v[76:79], v240 offset:11264
  v_mfma_f32_32x32x16_bf16 v[32:47], v[56:59], v[132:135], v[32:47]
  ds_read_b128 v[80:83], v237 offset:10240
  buffer_load_dwordx4 v[164:167], v255, s[8:11], s86 offen sc1
  s_add_u32 s86, s86, 1024
  buffer_load_dwordx4 v[168:171], v255, s[8:11], s86 offen sc1
  s_cmp_eq_u32 s93, 0
  s_cselect_b32 s78, 1024, 0
  s_add_u32 s86, s86, s78
  buffer_load_dwordx4 v[172:175], v255, s[8:11], s86 offen sc1
  s_waitcnt vmcnt(9) lgkmcnt(3)
  v_mfma_f32_32x32x16_bf16 v[0:15], v[60:63], v[136:139], v[0:15]
  ds_read_b128 v[48:51], v240 offset:15360
  v_mfma_f32_32x32x16_bf16 v[16:31], v[64:67], v[136:139], v[16:31]
  ds_read_b128 v[52:55], v240 offset:16384
  v_mfma_f32_32x32x16_bf16 v[32:47], v[68:71], v[136:139], v[32:47]
  ds_read_b128 v[56:59], v237 offset:15360
  s_barrier
  v_add_u32 v240, 0, v242
  v_add_u32 v237, 0, v238
  s_waitcnt vmcnt(8) lgkmcnt(3)
  v_mfma_f32_32x32x16_bf16 v[0:15], v[72:75], v[140:143], v[0:15]
  ds_read_b128 v[60:63], v240 offset:0
  v_mfma_f32_32x32x16_bf16 v[16:31], v[76:79], v[140:143], v[16:31]
  ds_read_b128 v[64:67], v240 offset:1024
  v_mfma_f32_32x32x16_bf16 v[32:47], v[80:83], v[140:143], v[32:47]
  ds_read_b128 v[68:71], v237 offset:0
  s_waitcnt vmcnt(7) lgkmcnt(3)
  v_mfma_f32_32x32x16_bf16 v[0:15], v[48:51], v[144:147], v[0:15]
  ds_read_b128 v[72:75], v240 offset:5120
  v_mfma_f32_32x32x16_bf16 v[16:31], v[52:55], v[144:147], v[16:31]
  ds_read_b128 v[76:79], v240 offset:6144
  v_mfma_f32_32x32x16_bf16 v[32:47], v[56:59], v[144:147], v[32:47]
  ds_read_b128 v[80:83], v237 offset:5120
  s_waitcnt vmcnt(6) lgkmcnt(3)
  v_mfma_f32_32x32x16_bf16 v[0:15], v[60:63], v[148:151], v[0:15]
  ds_read_b128 v[48:51], v240 offset:10240
  v_mfma_f32_32x32x16_bf16 v[16:31], v[64:67], v[148:151], v[16:31]
  ds_read_b128 v[52:55], v240 offset:11264
  v_mfma_f32_32x32x16_bf16 v[32:47], v[68:71], v[148:151], v[32:47]
  ds_read_b128 v[56:59], v237 offset:10240
  s_waitcnt vmcnt(5) lgkmcnt(3)
  v_mfma_f32_32x32x16_bf16 v[0:15], v[72:75], v[152:155], v[0:15]
  ds_read_b128 v[60:63], v240 offset:15360
  v_mfma_f32_32x32x16_bf16 v[16:31], v[76:79], v[152:155], v[16:31]
  ds_read_b128 v[64:67], v240 offset:16384
  v_mfma_f32_32x32x16_bf16 v[32:47], v[80:83], v[152:155], v[32:47]
  ds_read_b128 v[68:71], v237 offset:15360
  s_barrier
  s_waitcnt vmcnt(4) lgkmcnt(3)
  v_mfma_f32_32x32x16_bf16 v[0:15], v[48:51], v[156:159], v[0:15]
  v_mfma_f32_32x32x16_bf16 v[16:31], v[52:55], v[156:159], v[16:31]
  v_mfma_f32_32x32x16_bf16 v[32:47], v[56:59], v[156:159], v[32:47]
  s_waitcnt vmcnt(3) lgkmcnt(0)
  v_mfma_f32_32x32x16_bf16 v[0:15], v[60:63], v[160:163], v[0:15]
  v_mfma_f32_32x32x16_bf16 v[16:31], v[64:67], v[160:163], v[16:31]
  v_mfma_f32_32x32x16_bf16 v[32:47], v[68:71], v[160:163], v[32:47]
  s_mul_i32 s78, s92, 10240
  s_add_u32 s78, s78, 63488
  v_add_u32 v243, s78, v255
  s_cmp_eq_u32 s93, 0
  s_cbranch_scc0 L_kh1_43
  s_nop 7
  ds_write_b128 v243, v[24:27] offset:6144
  ds_write_b128 v243, v[28:31] offset:7168
  ds_write_b128 v243, v[32:35] offset:8192
  ds_write_b128 v243, v[36:39] offset:9216
  s_branch L_khj_44
L_kh1_43:
  s_nop 7
  ds_write_b128 v243, v[0:3] offset:0
  ds_write_b128 v243, v[4:7] offset:1024
  ds_write_b128 v243, v[8:11] offset:2048
  ds_write_b128 v243, v[12:15] offset:3072
  ds_write_b128 v243, v[16:19] offset:4096
  ds_write_b128 v243, v[20:23] offset:5120
L_khj_44:
  s_waitcnt lgkmcnt(0)
  s_barrier
  v_mov_b32 v204, 0
  v_mov_b32 v205, 0
  s_add_u32 s78, s88, s89
  s_add_u32 s79, s78, s89
  s_cmp_eq_u32 s7, 0
  s_cbranch_scc1 L_eslow_45
  s_cmp_eq_u32 s93, 0
  s_cbranch_scc0 L_kh1_47
  ds_read_b128 v[176:179], v243 offset:0
  ds_read_b128 v[180:183], v243 offset:1024
  ds_read_b128 v[184:187], v243 offset:2048
  ds_read_b128 v[188:191], v243 offset:3072
  ds_read_b128 v[192:195], v243 offset:4096
  ds_read_b128 v[196:199], v243 offset:5120
  s_waitcnt vmcnt(0)
  s_waitcnt lgkmcnt(4)
  v_pk_add_f32 v[0:1], v[0:1], v[176:177]
  v_pk_add_f32 v[2:3], v[2:3], v[178:179]
  v_pk_add_f32 v[4:5], v[4:5], v[180:181]
  v_pk_add_f32 v[6:7], v[6:7], v[182:183]
  v_lshlrev_b32 v176, 16, v164
  v_and_b32 v177, 0xffff0000, v164
  v_lshlrev_b32 v178, 16, v165
  v_and_b32 v179, 0xffff0000, v165
  v_lshlrev_b32 v180, 16, v166
  v_and_b32 v181, 0xffff0000, v166
  v_lshlrev_b32 v182, 16, v167
  v_and_b32 v183, 0xffff0000, v167
  v_permlane32_swap_b32 v0, v4
  v_permlane32_swap_b32 v1, v5
  v_permlane32_swap_b32 v2, v6
  v_permlane32_swap_b32 v3, v7
  v_pk_add_f32 v[0:1], v[0:1], v[176:177]
  v_pk_add_f32 v[2:3], v[2:3], v[178:179]
  v_pk_add_f32 v[4:5], v[4:5], v[180:181]
  v_pk_add_f32 v[6:7], v[6:7], v[182:183]
  v_cvt_pk_bf16_f32 v164, v0, v1
  v_cvt_pk_bf16_f32 v165, v2, v3
  v_cvt_pk_bf16_f32 v166, v4, v5
  v_cvt_pk_bf16_f32 v167, v6, v7
  buffer_store_dwordx4 v[164:167], v239, s[20:23], s88 offen
  v_pk_mul_f32 v[202:203], v[0:1], v[0:1]
  v_pk_add_f32 v[200:201], v[0:1], v[204:205]
  v_pk_fma_f32 v[202:203], v[2:3], v[2:3], v[202:203]
  v_pk_add_f32 v[200:201], v[2:3], v[200:201]
  v_pk_fma_f32 v[202:203], v[4:5], v[4:5], v[202:203]
  v_pk_add_f32 v[200:201], v[4:5], v[200:201]
  v_pk_fma_f32 v[202:203], v[6:7], v[6:7], v[202:203]
  v_pk_add_f32 v[200:201], v[6:7], v[200:201]
  s_waitcnt lgkmcnt(2)
  v_pk_add_f32 v[8:9], v[8:9], v[184:185]
  v_pk_add_f32 v[10:11], v[10:11], v[186:187]
  v_pk_add_f32 v[12:13], v[12:13], v[188:189]
  v_pk_add_f32 v[14:15], v[14:15], v[190:191]
  v_lshlrev_b32 v184, 16, v168
  v_and_b32 v185, 0xffff0000, v168
  v_lshlrev_b32 v186, 16, v169
  v_and_b32 v187, 0xffff0000, v169
  v_lshlrev_b32 v188, 16, v170
  v_and_b32 v189, 0xffff0000, v170
  v_lshlrev_b32 v190, 16, v171
  v_and_b32 v191, 0xffff0000, v171
  v_permlane32_swap_b32 v8, v12
  v_permlane32_swap_b32 v9, v13
  v_permlane32_swap_b32 v10, v14
  v_permlane32_swap_b32 v11, v15
  v_pk_add_f32 v[8:9], v[8:9], v[184:185]
  v_pk_add_f32 v[10:11], v[10:11], v[186:187]
  v_pk_add_f32 v[12:13], v[12:13], v[188:189]
  v_pk_add_f32 v[14:15], v[14:15], v[190:191]
  v_cvt_pk_bf16_f32 v168, v8, v9
  v_cvt_pk_bf16_f32 v169, v10, v11
  v_cvt_pk_bf16_f32 v170, v12, v13
  v_cvt_pk_bf16_f32 v171, v14, v15
  buffer_store_dwordx4 v[168:171], v239, s[20:23], s78 offen
  v_pk_fma_f32 v[202:203], v[8:9], v[8:9], v[202:203]
  v_pk_add_f32 v[200:201], v[8:9], v[200:201]
  v_pk_fma_f32 v[202:203], v[10:11], v[10:11], v[202:203]
  v_pk_add_f32 v[200:201], v[10:11], v[200:201]
  v_pk_fma_f32 v[202:203], v[12:13], v[12:13], v[202:203]
  v_pk_add_f32 v[200:201], v[12:13], v[200:201]
  v_pk_fma_f32 v[202:203], v[14:15], v[14:15], v[202:203]
  v_pk_add_f32 v[200:201], v[14:15], v[200:201]
  s_waitcnt lgkmcnt(0)
  v_pk_add_f32 v[16:17], v[16:17], v[192:193]
  v_pk_add_f32 v[18:19], v[18:19], v[194:195]
  v_pk_add_f32 v[20:21], v[20:21], v[196:197]
  v_pk_add_f32 v[22:23], v[22:23], v[198:199]
  v_lshlrev_b32 v192, 16, v172
  v_and_b32 v193, 0xffff0000, v172
  v_lshlrev_b32 v194, 16, v173
  v_and_b32 v195, 0xffff0000, v173
  v_lshlrev_b32 v196, 16, v174
  v_and_b32 v197, 0xffff0000, v174
  v_lshlrev_b32 v198, 16, v175
  v_and_b32 v199, 0xffff0000, v175
  v_permlane32_swap_b32 v16, v20
  v_permlane32_swap_b32 v17, v21
  v_permlane32_swap_b32 v18, v22
  v_permlane32_swap_b32 v19, v23
  v_pk_add_f32 v[16:17], v[16:17], v[192:193]
  v_pk_add_f32 v[18:19], v[18:19], v[194:195]
  v_pk_add_f32 v[20:21], v[20:21], v[196:197]
  v_pk_add_f32 v[22:23], v[22:23], v[198:199]
  v_cvt_pk_bf16_f32 v172, v16, v17
  v_cvt_pk_bf16_f32 v173, v18, v19
  v_cvt_pk_bf16_f32 v174, v20, v21
  v_cvt_pk_bf16_f32 v175, v22, v23
  buffer_store_dwordx4 v[172:175], v239, s[20:23], s79 offen
  v_pk_fma_f32 v[202:203], v[16:17], v[16:17], v[202:203]
  v_pk_add_f32 v[200:201], v[16:17], v[200:201]
  v_pk_fma_f32 v[202:203], v[18:19], v[18:19], v[202:203]
  v_pk_add_f32 v[200:201], v[18:19], v[200:201]
  v_pk_fma_f32 v[202:203], v[20:21], v[20:21], v[202:203]
  v_pk_add_f32 v[200:201], v[20:21], v[200:201]
  v_pk_fma_f32 v[202:203], v[22:23], v[22:23], v[202:203]
  v_pk_add_f32 v[200:201], v[22:23], v[200:201]
  s_branch L_khj_48
L_kh1_47:
  ds_read_b128 v[176:179], v243 offset:6144
  ds_read_b128 v[180:183], v243 offset:7168
  ds_read_b128 v[184:187], v243 offset:8192
  ds_read_b128 v[188:191], v243 offset:9216
  s_waitcnt vmcnt(0)
  s_waitcnt lgkmcnt(2)
  v_pk_add_f32 v[24:25], v[24:25], v[176:177]
  v_pk_add_f32 v[26:27], v[26:27], v[178:179]
  v_pk_add_f32 v[28:29], v[28:29], v[180:181]
  v_pk_add_f32 v[30:31], v[30:31], v[182:183]
  v_lshlrev_b32 v176, 16, v164
  v_and_b32 v177, 0xffff0000, v164
  v_lshlrev_b32 v178, 16, v165
  v_and_b32 v179, 0xffff0000, v165
  v_lshlrev_b32 v180, 16, v166
  v_and_b32 v181, 0xffff0000, v166
  v_lshlrev_b32 v182, 16, v167
  v_and_b32 v183, 0xffff0000, v167
  v_permlane32_swap_b32 v24, v28
  v_permlane32_swap_b32 v25, v29
  v_permlane32_swap_b32 v26, v30
  v_permlane32_swap_b32 v27, v31
  v_pk_add_f32 v[24:25], v[24:25], v[176:177]
  v_pk_add_f32 v[26:27], v[26:27], v[178:179]
  v_pk_add_f32 v[28:29], v[28:29], v[180:181]
  v_pk_add_f32 v[30:31], v[30:31], v[182:183]
  v_cvt_pk_bf16_f32 v164, v24, v25
  v_cvt_pk_bf16_f32 v165, v26, v27
  v_cvt_pk_bf16_f32 v166, v28, v29
  v_cvt_pk_bf16_f32 v167, v30, v31
  buffer_store_dwordx4 v[164:167], v239, s[20:23], s88 offen
  v_pk_mul_f32 v[202:203], v[24:25], v[24:25]
  v_pk_add_f32 v[200:201], v[24:25], v[204:205]
  v_pk_fma_f32 v[202:203], v[26:27], v[26:27], v[202:203]
  v_pk_add_f32 v[200:201], v[26:27], v[200:201]
  v_pk_fma_f32 v[202:203], v[28:29], v[28:29], v[202:203]
  v_pk_add_f32 v[200:201], v[28:29], v[200:201]
  v_pk_fma_f32 v[202:203], v[30:31], v[30:31], v[202:203]
  v_pk_add_f32 v[200:201], v[30:31], v[200:201]
  s_waitcnt lgkmcnt(0)
  v_pk_add_f32 v[32:33], v[32:33], v[184:185]
  v_pk_add_f32 v[34:35], v[34:35], v[186:187]
  v_pk_add_f32 v[36:37], v[36:37], v[188:189]
  v_pk_add_f32 v[38:39], v[38:39], v[190:191]
  v_lshlrev_b32 v184, 16, v168
  v_and_b32 v185, 0xffff0000, v168
  v_lshlrev_b32 v186, 16, v169
  v_and_b32 v187, 0xffff0000, v169
  v_lshlrev_b32 v188, 16, v170
  v_and_b32 v189, 0xffff0000, v170
  v_lshlrev_b32 v190, 16, v171
  v_and_b32 v191, 0xffff0000, v171
  v_permlane32_swap_b32 v32, v36
  v_permlane32_swap_b32 v33, v37
  v_permlane32_swap_b32 v34, v38
  v_permlane32_swap_b32 v35, v39
  v_pk_add_f32 v[32:33], v[32:33], v[184:185]
  v_pk_add_f32 v[34:35], v[34:35], v[186:187]
  v_pk_add_f32 v[36:37], v[36:37], v[188:189]
  v_pk_add_f32 v[38:39], v[38:39], v[190:191]
  v_cvt_pk_bf16_f32 v168, v32, v33
  v_cvt_pk_bf16_f32 v169, v34, v35
  v_cvt_pk_bf16_f32 v170, v36, v37
  v_cvt_pk_bf16_f32 v171, v38, v39
  buffer_store_dwordx4 v[168:171], v239, s[20:23], s78 offen
  v_pk_fma_f32 v[202:203], v[32:33], v[32:33], v[202:203]
  v_pk_add_f32 v[200:201], v[32:33], v[200:201]
  v_pk_fma_f32 v[202:203], v[34:35], v[34:35], v[202:203]
  v_pk_add_f32 v[200:201], v[34:35], v[200:201]
  v_pk_fma_f32 v[202:203], v[36:37], v[36:37], v[202:203]
  v_pk_add_f32 v[200:201], v[36:37], v[200:201]
  v_pk_fma_f32 v[202:203], v[38:39], v[38:39], v[202:203]
  v_pk_add_f32 v[200:201], v[38:39], v[200:201]
L_khj_48:
  s_branch L_ejoin_46
L_eslow_45:
  s_cmp_eq_u32 s93, 0
  s_cbranch_scc0 L_kh1_49
  ds_read_b128 v[176:179], v243 offset:0
  ds_read_b128 v[180:183], v243 offset:1024
  ds_read_b128 v[184:187], v243 offset:2048
  ds_read_b128 v[188:191], v243 offset:3072
  ds_read_b128 v[192:195], v243 offset:4096
  ds_read_b128 v[196:199], v243 offset:5120
  s_waitcnt vmcnt(0)
  s_waitcnt lgkmcnt(4)
  v_pk_add_f32 v[0:1], v[0:1], v[176:177]
  v_pk_add_f32 v[2:3], v[2:3], v[178:179]
  v_pk_add_f32 v[4:5], v[4:5], v[180:181]
  v_pk_add_f32 v[6:7], v[6:7], v[182:183]
  v_lshlrev_b32 v176, 16, v164
  v_and_b32 v177, 0xffff0000, v164
  v_lshlrev_b32 v178, 16, v165
  v_and_b32 v179, 0xffff0000, v165
  v_lshlrev_b32 v180, 16, v166
  v_and_b32 v181, 0xffff0000, v166
  v_lshlrev_b32 v182, 16, v167
  v_and_b32 v183, 0xffff0000, v167
  v_permlane32_swap_b32 v0, v4
  v_permlane32_swap_b32 v1, v5
  v_permlane32_swap_b32 v2, v6
  v_permlane32_swap_b32 v3, v7
  v_pk_add_f32 v[0:1], v[0:1], v[176:177]
  v_pk_add_f32 v[2:3], v[2:3], v[178:179]
  v_pk_add_f32 v[4:5], v[4:5], v[180:181]
  v_pk_add_f32 v[6:7], v[6:7], v[182:183]
  v_cvt_pk_bf16_f32 v164, v0, v1
  v_cvt_pk_bf16_f32 v165, v2, v3
  v_cvt_pk_bf16_f32 v166, v4, v5
  v_cvt_pk_bf16_f32 v167, v6, v7
  buffer_store_dwordx4 v[164:167], v239, s[20:23], s88 offen sc1
  v_pk_mul_f32 v[202:203], v[0:1], v[0:1]
  v_pk_add_f32 v[200:201], v[0:1], v[204:205]
  v_pk_fma_f32 v[202:203], v[2:3], v[2:3], v[202:203]
  v_pk_add_f32 v[200:201], v[2:3], v[200:201]
  v_pk_fma_f32 v[202:203], v[4:5], v[4:5], v[202:203]
  v_pk_add_f32 v[200:201], v[4:5], v[200:201]
  v_pk_fma_f32 v[202:203], v[6:7], v[6:7], v[202:203]
  v_pk_add_f32 v[200:201], v[6:7], v[200:201]
  s_waitcnt lgkmcnt(2)
  v_pk_add_f32 v[8:9], v[8:9], v[184:185]
  v_pk_add_f32 v[10:11], v[10:11], v[186:187]
  v_pk_add_f32 v[12:13], v[12:13], v[188:189]
  v_pk_add_f32 v[14:15], v[14:15], v[190:191]
  v_lshlrev_b32 v184, 16, v168
  v_and_b32 v185, 0xffff0000, v168
  v_lshlrev_b32 v186, 16, v169
  v_and_b32 v187, 0xffff0000, v169
  v_lshlrev_b32 v188, 16, v170
  v_and_b32 v189, 0xffff0000, v170
  v_lshlrev_b32 v190, 16, v171
  v_and_b32 v191, 0xffff0000, v171
  v_permlane32_swap_b32 v8, v12
  v_permlane32_swap_b32 v9, v13
  v_permlane32_swap_b32 v10, v14
  v_permlane32_swap_b32 v11, v15
  v_pk_add_f32 v[8:9], v[8:9], v[184:185]
  v_pk_add_f32 v[10:11], v[10:11], v[186:187]
  v_pk_add_f32 v[12:13], v[12:13], v[188:189]
  v_pk_add_f32 v[14:15], v[14:15], v[190:191]
  v_cvt_pk_bf16_f32 v168, v8, v9
  v_cvt_pk_bf16_f32 v169, v10, v11
  v_cvt_pk_bf16_f32 v170, v12, v13
  v_cvt_pk_bf16_f32 v171, v14, v15
  buffer_store_dwordx4 v[168:171], v239, s[20:23], s78 offen sc1
  v_pk_fma_f32 v[202:203], v[8:9], v[8:9], v[202:203]
  v_pk_add_f32 v[200:201], v[8:9], v[200:201]
  v_pk_fma_f32 v[202:203], v[10:11], v[10:11], v[202:203]
  v_pk_add_f32 v[200:201], v[10:11], v[200:201]
  v_pk_fma_f32 v[202:203], v[12:13], v[12:13], v[202:203]
  v_pk_add_f32 v[200:201], v[12:13], v[200:201]
  v_pk_fma_f32 v[202:203], v[14:15], v[14:15], v[202:203]
  v_pk_add_f32 v[200:201], v[14:15], v[200:201]
  s_waitcnt lgkmcnt(0)
  v_pk_add_f32 v[16:17], v[16:17], v[192:193]
  v_pk_add_f32 v[18:19], v[18:19], v[194:195]
  v_pk_add_f32 v[20:21], v[20:21], v[196:197]
  v_pk_add_f32 v[22:23], v[22:23], v[198:199]
  v_lshlrev_b32 v192, 16, v172
  v_and_b32 v193, 0xffff0000, v172
  v_lshlrev_b32 v194, 16, v173
  v_and_b32 v195, 0xffff0000, v173
  v_lshlrev_b32 v196, 16, v174
  v_and_b32 v197, 0xffff0000, v174
  v_lshlrev_b32 v198, 16, v175
  v_and_b32 v199, 0xffff0000, v175
  v_permlane32_swap_b32 v16, v20
  v_permlane32_swap_b32 v17, v21
  v_permlane32_swap_b32 v18, v22
  v_permlane32_swap_b32 v19, v23
  v_pk_add_f32 v[16:17], v[16:17], v[192:193]
  v_pk_add_f32 v[18:19], v[18:19], v[194:195]
  v_pk_add_f32 v[20:21], v[20:21], v[196:197]
  v_pk_add_f32 v[22:23], v[22:23], v[198:199]
  v_cvt_pk_bf16_f32 v172, v16, v17
  v_cvt_pk_bf16_f32 v173, v18, v19
  v_cvt_pk_bf16_f32 v174, v20, v21
  v_cvt_pk_bf16_f32 v175, v22, v23
  buffer_store_dwordx4 v[172:175], v239, s[20:23], s79 offen sc1
  v_pk_fma_f32 v[202:203], v[16:17], v[16:17], v[202:203]
  v_pk_add_f32 v[200:201], v[16:17], v[200:201]
  v_pk_fma_f32 v[202:203], v[18:19], v[18:19], v[202:203]
  v_pk_add_f32 v[200:201], v[18:19], v[200:201]
  v_pk_fma_f32 v[202:203], v[20:21], v[20:21], v[202:203]
  v_pk_add_f32 v[200:201], v[20:21], v[200:201]
  v_pk_fma_f32 v[202:203], v[22:23], v[22:23], v[202:203]
  v_pk_add_f32 v[200:201], v[22:23], v[200:201]
  s_branch L_khj_50
L_kh1_49:
  ds_read_b128 v[176:179], v243 offset:6144
  ds_read_b128 v[180:183], v243 offset:7168
  ds_read_b128 v[184:187], v243 offset:8192
  ds_read_b128 v[188:191], v243 offset:9216
  s_waitcnt vmcnt(0)
  s_waitcnt lgkmcnt(2)
  v_pk_add_f32 v[24:25], v[24:25], v[176:177]
  v_pk_add_f32 v[26:27], v[26:27], v[178:179]
  v_pk_add_f32 v[28:29], v[28:29], v[180:181]
  v_pk_add_f32 v[30:31], v[30:31], v[182:183]
  v_lshlrev_b32 v176, 16, v164
  v_and_b32 v177, 0xffff0000, v164
  v_lshlrev_b32 v178, 16, v165
  v_and_b32 v179, 0xffff0000, v165
  v_lshlrev_b32 v180, 16, v166
  v_and_b32 v181, 0xffff0000, v166
  v_lshlrev_b32 v182, 16, v167
  v_and_b32 v183, 0xffff0000, v167
  v_permlane32_swap_b32 v24, v28
  v_permlane32_swap_b32 v25, v29
  v_permlane32_swap_b32 v26, v30
  v_permlane32_swap_b32 v27, v31
  v_pk_add_f32 v[24:25], v[24:25], v[176:177]
  v_pk_add_f32 v[26:27], v[26:27], v[178:179]
  v_pk_add_f32 v[28:29], v[28:29], v[180:181]
  v_pk_add_f32 v[30:31], v[30:31], v[182:183]
  v_cvt_pk_bf16_f32 v164, v24, v25
  v_cvt_pk_bf16_f32 v165, v26, v27
  v_cvt_pk_bf16_f32 v166, v28, v29
  v_cvt_pk_bf16_f32 v167, v30, v31
  buffer_store_dwordx4 v[164:167], v239, s[20:23], s88 offen sc1
  v_pk_mul_f32 v[202:203], v[24:25], v[24:25]
  v_pk_add_f32 v[200:201], v[24:25], v[204:205]
  v_pk_fma_f32 v[202:203], v[26:27], v[26:27], v[202:203]
  v_pk_add_f32 v[200:201], v[26:27], v[200:201]
  v_pk_fma_f32 v[202:203], v[28:29], v[28:29], v[202:203]
  v_pk_add_f32 v[200:201], v[28:29], v[200:201]
  v_pk_fma_f32 v[202:203], v[30:31], v[30:31], v[202:203]
  v_pk_add_f32 v[200:201], v[30:31], v[200:201]
  s_waitcnt lgkmcnt(0)
  v_pk_add_f32 v[32:33], v[32:33], v[184:185]
  v_pk_add_f32 v[34:35], v[34:35], v[186:187]
  v_pk_add_f32 v[36:37], v[36:37], v[188:189]
  v_pk_add_f32 v[38:39], v[38:39], v[190:191]
  v_lshlrev_b32 v184, 16, v168
  v_and_b32 v185, 0xffff0000, v168
  v_lshlrev_b32 v186, 16, v169
  v_and_b32 v187, 0xffff0000, v169
  v_lshlrev_b32 v188, 16, v170
  v_and_b32 v189, 0xffff0000, v170
  v_lshlrev_b32 v190, 16, v171
  v_and_b32 v191, 0xffff0000, v171
  v_permlane32_swap_b32 v32, v36
  v_permlane32_swap_b32 v33, v37
  v_permlane32_swap_b32 v34, v38
  v_permlane32_swap_b32 v35, v39
  v_pk_add_f32 v[32:33], v[32:33], v[184:185]
  v_pk_add_f32 v[34:35], v[34:35], v[186:187]
  v_pk_add_f32 v[36:37], v[36:37], v[188:189]
  v_pk_add_f32 v[38:39], v[38:39], v[190:191]
  v_cvt_pk_bf16_f32 v168, v32, v33
  v_cvt_pk_bf16_f32 v169, v34, v35
  v_cvt_pk_bf16_f32 v170, v36, v37
  v_cvt_pk_bf16_f32 v171, v38, v39
  buffer_store_dwordx4 v[168:171], v239, s[20:23], s78 offen sc1
  v_pk_fma_f32 v[202:203], v[32:33], v[32:33], v[202:203]
  v_pk_add_f32 v[200:201], v[32:33], v[200:201]
  v_pk_fma_f32 v[202:203], v[34:35], v[34:35], v[202:203]
  v_pk_add_f32 v[200:201], v[34:35], v[200:201]
  v_pk_fma_f32 v[202:203], v[36:37], v[36:37], v[202:203]
  v_pk_add_f32 v[200:201], v[36:37], v[200:201]
  v_pk_fma_f32 v[202:203], v[38:39], v[38:39], v[202:203]
  v_pk_add_f32 v[200:201], v[38:39], v[200:201]
L_khj_50:
L_ejoin_46:
  v_add_f32 v200, v200, v201
  v_add_f32 v201, v202, v203
  v_mov_b32 v202, v200
  v_mov_b32 v203, v201
  s_nop 0
  v_permlane32_swap_b32 v200, v202
  v_permlane32_swap_b32 v201, v203
  v_add_f32 v200, v200, v202
  v_add_f32 v201, v201, v203
  v_and_b32 v244, 31, v254
  v_lshlrev_b32 v244, 4, v244
  s_mov_b32 exec_hi, 0
  s_cmp_eq_u32 s7, 0
  s_cbranch_scc1 L_slow_51
  buffer_store_dwordx2 v[200:201], v244, s[8:11], s90 offen
  s_branch L_join_52
L_slow_51:
  buffer_store_dwordx2 v[200:201], v244, s[8:11], s90 offen sc1
L_join_52:
  s_mov_b32 exec_hi, -1
  s_waitcnt vmcnt(0)
  s_add_u32 s66, s66, 1
  s_lshl_b32 s91, s3, 8
  s_add_u32 s91, s91, 0
  s_lshl_b32 s79, s4, 2
  s_add_u32 s79, s79, s5
  s_lshl_b32 s79, s79, 2
  v_mov_b32 v243, s66
  v_mov_b32 v244, s79
  v_lshlrev_b32 v250, 2, v254
  s_mov_b64 exec, 1
  s_cmp_eq_u32 s7, 0
  s_cbranch_scc1 L_slow_53
  buffer_store_dword v243, v244, s[8:11], s91 offen
  s_branch L_join_54
L_slow_53:
  buffer_store_dword v243, v244, s[8:11], s91 offen sc1
L_join_54:
  s_mov_b64 exec, -1
  s_barrier
  s_mul_i32 s84, s6, 5242880
  s_mul_i32 s78, s3, 163840
  s_add_u32 s84, s84, s78
  s_mul_i32 s78, s5, 40960
  s_add_u32 s84, s84, s78
  s_add_u32 s84, s84, 27787264
  s_lshl_b32 s86, s6, 4
  s_add_u32 s86, s86, s3
  s_mul_i32 s86, s86, 442368
  s_mul_i32 s78, s5, 110592
  s_add_u32 s86, s86, s78
  s_lshl_b32 s78, s69, 10
  s_add_u32 s86, s86, s78
  s_add_u32 s86, s86, 37748736
  s_mov_b32 s96, 0
L_poll_x_55:
  buffer_load_dword v251, v250, s[8:11], s91 offen sc1
  s_add_u32 s96, s96, 1
  s_cmp_gt_u32 s96, 200000
  s_cbranch_scc1 L_done_x_56
  s_waitcnt vmcnt(0)
  v_cmp_gt_u32 vcc, s66, v251
  s_cbranch_vccnz L_poll_x_55
L_done_x_56:
  s_waitcnt vmcnt(0)
  buffer_load_dwordx4 v[196:199], v255, s[8:11], s84 offen offset:0 sc1
  buffer_load_dwordx4 v[200:203], v255, s[8:11], s84 offen offset:1024 sc1
  buffer_load_dwordx4 v[204:207], v255, s[8:11], s84 offen offset:2048 sc1
  buffer_load_dwordx4 v[208:211], v255, s[8:11], s84 offen offset:3072 sc1
  s_add_u32 s84, s84, 4096
  s_barrier
  v_add_u32 v240, 20480, v255
  ds_read_b128 v[112:115], v240 offset:0
  ds_read_b128 v[116:119], v240 offset:1024
  ds_read_b128 v[120:123], v240 offset:2048
  ds_read_b128 v[124:127], v240 offset:3072
  ds_read_b128 v[128:131], v240 offset:4096
  ds_read_b128 v[132:135], v240 offset:5120
  ds_read_b128 v[136:139], v240 offset:6144
  ds_read_b128 v[140:143], v240 offset:7168
  ds_read_b128 v[144:147], v240 offset:8192
  ds_read_b128 v[148:151], v240 offset:9216
  ds_read_b128 v[152:155], v240 offset:10240
  ds_read_b128 v[156:159], v240 offset:11264
  ds_read_b128 v[160:163], v240 offset:12288
  ds_read_b128 v[164:167], v240 offset:13312
  s_barrier
  v_add_u32 v240, 34816, v255
  s_waitcnt vmcnt(3) lgkmcnt(7)
  v_mfma_f32_32x32x16_bf16 v[0:15], v[112:115], v[196:199], 0
  ds_read_b128 v[168:171], v240 offset:0
  buffer_load_dwordx4 v[212:215], v255, s[8:11], s84 offen offset:0 sc1
  buffer_load_dwordx4 v[216:219], v255, s[8:11], s84 offen offset:1024 sc1
  v_mfma_f32_32x32x16_bf16 v[16:31], v[116:119], v[196:199], 0
  ds_read_b128 v[172:175], v240 offset:1024
  v_mfma_f32_32x32x16_bf16 v[32:47], v[120:123], v[196:199], 0
  ds_read_b128 v[176:179], v240 offset:2048
  v_mfma_f32_32x32x16_bf16 v[48:63], v[124:127], v[196:199], 0
  ds_read_b128 v[180:183], v240 offset:3072
  v_mfma_f32_32x32x16_bf16 v[64:79], v[128:131], v[196:199], 0
  ds_read_b128 v[184:187], v240 offset:4096
  v_mfma_f32_32x32x16_bf16 v[80:95], v[132:135], v[196:199], 0
  ds_read_b128 v[188:191], v240 offset:5120
  v_mfma_f32_32x32x16_bf16 v[96:111], v[136:139], v[196:199], 0
  ds_read_b128 v[192:195], v240 offset:6144
  s_waitcnt vmcnt(4) lgkmcnt(7)
  v_mfma_f32_32x32x16_bf16 v[0:15], v[140:143], v[200:203], v[0:15]
  ds_read_b128 v[112:115], v240 offset:7168
  buffer_load_dwordx4 v[220:223], v255, s[8:11], s84 offen offset:2048 sc1
  buffer_load_dwordx4 v[224:227], v255, s[8:11], s84 offen offset:3072 sc1
  s_add_u32 s84, s84, 4096
  v_mfma_f32_32x32x16_bf16 v[16:31], v[144:147], v[200:203], v[16:31]
  ds_read_b128 v[116:119], v240 offset:8192
  v_mfma_f32_32x32x16_bf16 v[32:47], v[148:151], v[200:203], v[32:47]
  ds_read_b128 v[120:123], v240 offset:9216
  v_mfma_f32_32x32x16_bf16 v[48:63], v[152:155], v[200:203], v[48:63]
  ds_read_b128 v[124:127], v240 offset:10240
  v_mfma_f32_32x32x16_bf16 v[64:79], v[156:159], v[200:203], v[64:79]
  ds_read_b128 v[128:131], v240 offset:11264
  v_mfma_f32_32x32x16_bf16 v[80:95], v[160:163], v[200:203], v[80:95]
  ds_read_b128 v[132:135], v240 offset:12288
  v_mfma_f32_32x32x16_bf16 v[96:111], v[164:167], v[200:203], v[96:111]
  ds_read_b128 v[136:139], v240 offset:13312
  s_barrier
  v_add_u32 v240, 49152, v255
  s_waitcnt vmcnt(5) lgkmcnt(7)
  v_mfma_f32_32x32x16_bf16 v[0:15], v[168:171], v[204:207], v[0:15]
  ds_read_b128 v[140:143], v240 offset:0
  buffer_load_dwordx4 v[228:231], v255, s[8:11], s84 offen offset:0 sc1
  buffer_load_dwordx4 v[196:199], v255, s[8:11], s84 offen offset:1024 sc1
  v_mfma_f32_32x32x16_bf16 v[16:31], v[172:175], v[204:207], v[16:31]
  ds_read_b128 v[144:147], v240 offset:1024
  v_mfma_f32_32x32x16_bf16 v[32:47], v[176:179], v[204:207], v[32:47]
  ds_read_b128 v[148:151], v240 offset:2048
  v_mfma_f32_32x32x16_bf16 v[48:63], v[180:183], v[204:207], v[48:63]
  ds_read_b128 v[152:155], v240 offset:3072
  v_mfma_f32_32x32x16_bf16 v[64:79], v[184:187], v[204:207], v[64:79]
  ds_read_b128 v[156:159], v240 offset:4096
  v_mfma_f32_32x32x16_bf16 v[80:95], v[188:191], v[204:207], v[80:95]
  ds_read_b128 v[160:163], v240 offset:5120
  v_mfma_f32_32x32x16_bf16 v[96:111], v[192:195], v[204:207], v[96:111]
  ds_read_b128 v[164:167], v240 offset:6144
  s_waitcnt vmcnt(6) lgkmcnt(7)
  v_mfma_f32_32x32x16_bf16 v[0:15], v[112:115], v[208:211], v[0:15]
  ds_read_b128 v[168:171], v240 offset:7168
  buffer_load_dwordx4 v[200:203], v255, s[8:11], s84 offen offset:2048 sc1
  buffer_load_dwordx4 v[204:207], v255, s[8:11], s84 offen offset:3072 sc1
  s_add_u32 s84, s84, 4096
  v_mfma_f32_32x32x16_bf16 v[16:31], v[116:119], v[208:211], v[16:31]
  ds_read_b128 v[172:175], v240 offset:8192
  v_mfma_f32_32x32x16_bf16 v[32:47], v[120:123], v[208:211], v[32:47]
  ds_read_b128 v[176:179], v240 offset:9216
  v_mfma_f32_32x32x16_bf16 v[48:63], v[124:127], v[208:211], v[48:63]
  ds_read_b128 v[180:183], v240 offset:10240
  v_mfma_f32_32x32x16_bf16 v[64:79], v[128:131], v[208:211], v[64:79]
  ds_read_b128 v[184:187], v240 offset:11264
  v_mfma_f32_32x32x16_bf16 v[80:95], v[132:135], v[208:211], v[80:95]
  ds_read_b128 v[188:191], v240 offset:12288
  v_mfma_f32_32x32x16_bf16 v[96:111], v[136:139], v[208:211], v[96:111]
  ds_read_b128 v[192:195], v240 offset:13312
  s_barrier
  v_add_u32 v240, 83968, v255
  s_waitcnt vmcnt(7) lgkmcnt(7)
  v_mfma_f32_32x32x16_bf16 v[0:15], v[140:143], v[212:215], v[0:15]
  ds_read_b128 v[112:115], v240 offset:0
  buffer_load_dwordx4 v[208:211], v255, s[8:11], s84 offen offset:0 sc1
  v_mfma_f32_32x32x16_bf16 v[16:31], v[144:147], v[212:215], v[16:31]
  ds_read_b128 v[116:119], v240 offset:1024
  v_mfma_f32_32x32x16_bf16 v[32:47], v[148:151], v[212:215], v[32:47]
  ds_read_b128 v[120:123], v240 offset:2048
  v_mfma_f32_32x32x16_bf16 v[48:63], v[152:155], v[212:215], v[48:63]
  ds_read_b128 v[124:127], v240 offset:3072
  v_mfma_f32_32x32x16_bf16 v[64:79], v[156:159], v[212:215], v[64:79]
  ds_read_b128 v[128:131], v240 offset:4096
  v_mfma_f32_32x32x16_bf16 v[80:95], v[160:163], v[212:215], v[80:95]
  ds_read_b128 v[132:135], v240 offset:5120
  v_mfma_f32_32x32x16_bf16 v[96:111], v[164:167], v[212:215], v[96:111]
  ds_read_b128 v[136:139], v240 offset:6144
  s_waitcnt vmcnt(7) lgkmcnt(7)
  v_mfma_f32_32x32x16_bf16 v[0:15], v[168:171], v[216:219], v[0:15]
  ds_read_b128 v[140:143], v240 offset:7168
  buffer_load_dwordx4 v[212:215], v255, s[8:11], s84 offen offset:1024 sc1
  v_mfma_f32_32x32x16_bf16 v[16:31], v[172:175], v[216:219], v[16:31]
  ds_read_b128 v[144:147], v240 offset:8192
  v_mfma_f32_32x32x16_bf16 v[32:47], v[176:179], v[216:219], v[32:47]
  ds_read_b128 v[148:151], v240 offset:9216
  v_mfma_f32_32x32x16_bf16 v[48:63], v[180:183], v[216:219], v[48:63]
  ds_read_b128 v[152:155], v240 offset:10240
  v_mfma_f32_32x32x16_bf16 v[64:79], v[184:187], v[216:219], v[64:79]
  ds_read_b128 v[156:159], v240 offset:11264
  v_mfma_f32_32x32x16_bf16 v[80:95], v[188:191], v[216:219], v[80:95]
  ds_read_b128 v[160:163], v240 offset:12288
  v_mfma_f32_32x32x16_bf16 v[96:111], v[192:195], v[216:219], v[96:111]
  ds_read_b128 v[164:167], v240 offset:13312
  s_barrier
  v_add_u32 v240, 0, v255
  s_waitcnt vmcnt(7) lgkmcnt(7)
  v_mfma_f32_32x32x16_bf16 v[0:15], v[112:115], v[220:223], v[0:15]
  ds_read_b128 v[168:171], v240 offset:0
  buffer_load_dwordx4 v[216:219], v255, s[8:11], s84 offen offset:2048 sc1
  v_mfma_f32_32x32x16_bf16 v[16:31], v[116:119], v[220:223], v[16:31]
  ds_read_b128 v[172:175], v240 offset:1024
  v_mfma_f32_32x32x16_bf16 v[32:47], v[120:123], v[220:223], v[32:47]
  ds_read_b128 v[176:179], v240 offset:2048
  v_mfma_f32_32x32x16_bf16 v[48:63], v[124:127], v[220:223], v[48:63]
  ds_read_b128 v[180:183], v240 offset:3072
  v_mfma_f32_32x32x16_bf16 v[64:79], v[128:131], v[220:223], v[64:79]
  ds_read_b128 v[184:187], v240 offset:4096
  v_mfma_f32_32x32x16_bf16 v[80:95], v[132:135], v[220:223], v[80:95]
  ds_read_b128 v[188:191], v240 offset:5120
  v_mfma_f32_32x32x16_bf16 v[96:111], v[136:139], v[220:223], v[96:111]
  ds_read_b128 v[192:195], v240 offset:6144
  s_waitcnt vmcnt(7) lgkmcnt(7)
  v_mfma_f32_32x32x16_bf16 v[0:15], v[140:143], v[224:227], v[0:15]
  ds_read_b128 v[112:115], v240 offset:7168
  buffer_load_dwordx4 v[220:223], v255, s[8:11], s84 offen offset:3072 sc1
  s_add_u32 s84, s84, 4096
  v_mfma_f32_32x32x16_bf16 v[16:31], v[144:147], v[224:227], v[16:31]
  ds_read_b128 v[116:119], v240 offset:8192
  v_mfma_f32_32x32x16_bf16 v[32:47], v[148:151], v[224:227], v[32:47]
  ds_read_b128 v[120:123], v240 offset:9216
  v_mfma_f32_32x32x16_bf16 v[48:63], v[152:155], v[224:227], v[48:63]
  ds_read_b128 v[124:127], v240 offset:10240
  v_mfma_f32_32x32x16_bf16 v[64:79], v[156:159], v[224:227], v[64:79]
  ds_read_b128 v[128:131], v240 offset:11264
  v_mfma_f32_32x32x16_bf16 v[80:95], v[160:163], v[224:227], v[80:95]
  ds_read_b128 v[132:135], v240 offset:12288
  v_mfma_f32_32x32x16_bf16 v[96:111], v[164:167], v[224:227], v[96:111]
  ds_read_b128 v[136:139], v240 offset:13312
  s_barrier
  v_add_u32 v240, 63488, v255
  s_waitcnt vmcnt(7) lgkmcnt(7)
  v_mfma_f32_32x32x16_bf16 v[0:15], v[168:171], v[228:231], v[0:15]
  ds_read_b128 v[140:143], v240 offset:0
  buffer_load_dwordx4 v[224:227], v255, s[8:11], s84 offen offset:0 sc1
  v_mfma_f32_32x32x16_bf16 v[16:31], v[172:175], v[228:231], v[16:31]
  ds_read_b128 v[144:147], v240 offset:1024
  v_mfma_f32_32x32x16_bf16 v[32:47], v[176:179], v[228:231], v[32:47]
  ds_read_b128 v[148:151], v240 offset:2048
  v_mfma_f32_32x32x16_bf16 v[48:63], v[180:183], v[228:231], v[48:63]
  ds_read_b128 v[152:155], v240 offset:3072
  v_mfma_f32_32x32x16_bf16 v[64:79], v[184:187], v[228:231], v[64:79]
  ds_read_b128 v[156:159], v240 offset:4096
  v_mfma_f32_32x32x16_bf16 v[80:95], v[188:191], v[228:231], v[80:95]
  ds_read_b128 v[160:163], v240 offset:5120
  v_mfma_f32_32x32x16_bf16 v[96:111], v[192:195], v[228:231], v[96:111]
  ds_read_b128 v[164:167], v240 offset:6144
  s_waitcnt vmcnt(7) lgkmcnt(7)
  v_mfma_f32_32x32x16_bf16 v[0:15], v[112:115], v[196:199], v[0:15]
  ds_read_b128 v[168:171], v240 offset:7168
  buffer_load_dwordx4 v[228:231], v255, s[8:11], s84 offen offset:1024 sc1
  v_mfma_f32_32x32x16_bf16 v[16:31], v[116:119], v[196:199], v[16:31]
  ds_read_b128 v[172:175], v240 offset:8192
  v_mfma_f32_32x32x16_bf16 v[32:47], v[120:123], v[196:199], v[32:47]
  ds_read_b128 v[176:179], v240 offset:9216
  v_mfma_f32_32x32x16_bf16 v[48:63], v[124:127], v[196:199], v[48:63]
  ds_read_b128 v[180:183], v240 offset:10240
  v_mfma_f32_32x32x16_bf16 v[64:79], v[128:131], v[196:199], v[64:79]
  ds_read_b128 v[184:187], v240 offset:11264
  v_mfma_f32_32x32x16_bf16 v[80:95], v[132:135], v[196:199], v[80:95]
  ds_read_b128 v[188:191], v240 offset:12288
  v_mfma_f32_32x32x16_bf16 v[96:111], v[136:139], v[196:199], v[96:111]
  ds_read_b128 v[192:195], v240 offset:13312
  s_barrier
  v_add_u32 v240, 14336, v255
  s_waitcnt vmcnt(7) lgkmcnt(7)
  v_mfma_f32_32x32x16_bf16 v[0:15], v[140:143], v[200:203], v[0:15]
  ds_read_b128 v[112:115], v240 offset:0
  buffer_load_dwordx4 v[196:199], v255, s[8:11], s84 offen offset:2048 sc1
  v_mfma_f32_32x32x16_bf16 v[16:31], v[144:147], v[200:203], v[16:31]
  ds_read_b128 v[116:119], v240 offset:1024
  v_mfma_f32_32x32x16_bf16 v[32:47], v[148:151], v[200:203], v[32:47]
  ds_read_b128 v[120:123], v240 offset:2048
  v_mfma_f32_32x32x16_bf16 v[48:63], v[152:155], v[200:203], v[48:63]
  ds_read_b128 v[124:127], v240 offset:3072
  v_mfma_f32_32x32x16_bf16 v[64:79], v[156:159], v[200:203], v[64:79]
  ds_read_b128 v[128:131], v240 offset:4096
  v_mfma_f32_32x32x16_bf16 v[80:95], v[160:163], v[200:203], v[80:95]
  ds_read_b128 v[132:135], v240 offset:5120
  v_mfma_f32_32x32x16_bf16 v[96:111], v[164:167], v[200:203], v[96:111]
  ds_read_b128 v[136:139], v240 offset:6144
  s_waitcnt vmcnt(7) lgkmcnt(7)
  v_mfma_f32_32x32x16_bf16 v[0:15], v[168:171], v[204:207], v[0:15]
  ds_read_b128 v[140:143], v240 offset:7168
  buffer_load_dwordx4 v[200:203], v255, s[8:11], s84 offen offset:3072 sc1
  s_add_u32 s84, s84, 4096
  v_mfma_f32_32x32x16_bf16 v[16:31], v[172:175], v[204:207], v[16:31]
  ds_read_b128 v[144:147], v240 offset:8192
  v_mfma_f32_32x32x16_bf16 v[32:47], v[176:179], v[204:207], v[32:47]
  ds_read_b128 v[148:151], v240 offset:9216
  v_mfma_f32_32x32x16_bf16 v[48:63], v[180:183], v[204:207], v[48:63]
  ds_read_b128 v[152:155], v240 offset:10240
  v_mfma_f32_32x32x16_bf16 v[64:79], v[184:187], v[204:207], v[64:79]
  ds_read_b128 v[156:159], v240 offset:11264
  v_mfma_f32_32x32x16_bf16 v[80:95], v[188:191], v[204:207], v[80:95]
  ds_read_b128 v[160:163], v240 offset:12288
  v_mfma_f32_32x32x16_bf16 v[96:111], v[192:195], v[204:207], v[96:111]
  ds_read_b128 v[164:167], v240 offset:13312
  s_barrier
  v_add_u32 v240, 98304, v255
  s_waitcnt vmcnt(7) lgkmcnt(7)
  v_mfma_f32_32x32x16_bf16 v[0:15], v[112:115], v[208:211], v[0:15]
  ds_read_b128 v[168:171], v240 offset:0
  buffer_load_dwordx4 v[204:207], v255, s[8:11], s84 offen offset:0 sc1
  v_mfma_f32_32x32x16_bf16 v[16:31], v[116:119], v[208:211], v[16:31]
  ds_read_b128 v[172:175], v240 offset:1024
  v_mfma_f32_32x32x16_bf16 v[32:47], v[120:123], v[208:211], v[32:47]
  ds_read_b128 v[176:179], v240 offset:2048
  v_mfma_f32_32x32x16_bf16 v[48:63], v[124:127], v[208:211], v[48:63]
  ds_read_b128 v[180:183], v240 offset:3072
  v_mfma_f32_32x32x16_bf16 v[64:79], v[128:131], v[208:211], v[64:79]
  ds_read_b128 v[184:187], v240 offset:4096
  v_mfma_f32_32x32x16_bf16 v[80:95], v[132:135], v[208:211], v[80:95]
  ds_read_b128 v[188:191], v240 offset:5120
  v_mfma_f32_32x32x16_bf16 v[96:111], v[136:139], v[208:211], v[96:111]
  ds_read_b128 v[192:195], v240 offset:6144
  s_waitcnt vmcnt(7) lgkmcnt(7)
  v_mfma_f32_32x32x16_bf16 v[0:15], v[140:143], v[212:215], v[0:15]
  ds_read_b128 v[112:115], v240 offset:7168
  buffer_load_dwordx4 v[208:211], v255, s[8:11], s84 offen offset:1024 sc1
  v_mfma_f32_32x32x16_bf16 v[16:31], v[144:147], v[212:215], v[16:31]
  ds_read_b128 v[116:119], v240 offset:8192
  v_mfma_f32_32x32x16_bf16 v[32:47], v[148:151], v[212:215], v[32:47]
  ds_read_b128 v[120:123], v240 offset:9216
  v_mfma_f32_32x32x16_bf16 v[48:63], v[152:155], v[212:215], v[48:63]
  ds_read_b128 v[124:127], v240 offset:10240
  v_mfma_f32_32x32x16_bf16 v[64:79], v[156:159], v[212:215], v[64:79]
  ds_read_b128 v[128:131], v240 offset:11264
  v_mfma_f32_32x32x16_bf16 v[80:95], v[160:163], v[212:215], v[80:95]
  ds_read_b128 v[132:135], v240 offset:12288
  v_mfma_f32_32x32x16_bf16 v[96:111], v[164:167], v[212:215], v[96:111]
  ds_read_b128 v[136:139], v240 offset:13312
  s_barrier
  v_add_u32 v240, 28672, v255
  s_waitcnt vmcnt(7) lgkmcnt(7)
  v_mfma_f32_32x32x16_bf16 v[0:15], v[168:171], v[216:219], v[0:15]
  ds_read_b128 v[140:143], v240 offset:0
  buffer_load_dwordx4 v[212:215], v255, s[8:11], s84 offen offset:2048 sc1
  v_mfma_f32_32x32x16_bf16 v[16:31], v[172:175], v[216:219], v[16:31]
  ds_read_b128 v[144:147], v240 offset:1024
  v_mfma_f32_32x32x16_bf16 v[32:47], v[176:179], v[216:219], v[32:47]
  ds_read_b128 v[148:151], v240 offset:2048
  v_mfma_f32_32x32x16_bf16 v[48:63], v[180:183], v[216:219], v[48:63]
  ds_read_b128 v[152:155], v240 offset:3072
  v_mfma_f32_32x32x16_bf16 v[64:79], v[184:187], v[216:219], v[64:79]
  ds_read_b128 v[156:159], v240 offset:4096
  v_mfma_f32_32x32x16_bf16 v[80:95], v[188:191], v[216:219], v[80:95]
  ds_read_b128 v[160:163], v240 offset:5120
  v_mfma_f32_32x32x16_bf16 v[96:111], v[192:195], v[216:219], v[96:111]
  ds_read_b128 v[164:167], v240 offset:6144
  s_waitcnt vmcnt(7) lgkmcnt(7)
  v_mfma_f32_32x32x16_bf16 v[0:15], v[112:115], v[220:223], v[0:15]
  ds_read_b128 v[168:171], v240 offset:7168
  buffer_load_dwordx4 v[216:219], v255, s[8:11], s84 offen offset:3072 sc1
  s_add_u32 s84, s84, 4096
  v_mfma_f32_32x32x16_bf16 v[16:31], v[116:119], v[220:223], v[16:31]
  ds_read_b128 v[172:175], v240 offset:8192
  v_mfma_f32_32x32x16_bf16 v[32:47], v[120:123], v[220:223], v[32:47]
  ds_read_b128 v[176:179], v240 offset:9216
  v_mfma_f32_32x32x16_bf16 v[48:63], v[124:127], v[220:223], v[48:63]
  ds_read_b128 v[180:183], v240 offset:10240
  v_mfma_f32_32x32x16_bf16 v[64:79], v[128:131], v[220:223], v[64:79]
  ds_read_b128 v[184:187], v240 offset:11264
  v_mfma_f32_32x32x16_bf16 v[80:95], v[132:135], v[220:223], v[80:95]
  ds_read_b128 v[188:191], v240 offset:12288
  v_mfma_f32_32x32x16_bf16 v[96:111], v[136:139], v[220:223], v[96:111]
  ds_read_b128 v[192:195], v240 offset:13312
  s_barrier
  v_add_u32 v240, 112640, v255
  s_waitcnt vmcnt(7) lgkmcnt(7)
  v_mfma_f32_32x32x16_bf16 v[0:15], v[140:143], v[224:227], v[0:15]
  ds_read_b128 v[112:115], v240 offset:0
  buffer_load_dwordx4 v[220:223], v255, s[8:11], s84 offen offset:0 sc1
  v_mfma_f32_32x32x16_bf16 v[16:31], v[144:147], v[224:227], v[16:31]
  ds_read_b128 v[116:119], v240 offset:1024
  v_mfma_f32_32x32x16_bf16 v[32:47], v[148:151], v[224:227], v[32:47]
  ds_read_b128 v[120:123], v240 offset:2048
  v_mfma_f32_32x32x16_bf16 v[48:63], v[152:155], v[224:227], v[48:63]
  ds_read_b128 v[124:127], v240 offset:3072
  v_mfma_f32_32x32x16_bf16 v[64:79], v[156:159], v[224:227], v[64:79]
  ds_read_b128 v[128:131], v240 offset:4096
  v_mfma_f32_32x32x16_bf16 v[80:95], v[160:163], v[224:227], v[80:95]
  ds_read_b128 v[132:135], v240 offset:5120
  v_mfma_f32_32x32x16_bf16 v[96:111], v[164:167], v[224:227], v[96:111]
  ds_read_b128 v[136:139], v240 offset:6144
  s_waitcnt vmcnt(7) lgkmcnt(7)
  v_mfma_f32_32x32x16_bf16 v[0:15], v[168:171], v[228:231], v[0:15]
  ds_read_b128 v[140:143], v240 offset:7168
  buffer_load_dwordx4 v[224:227], v255, s[8:11], s84 offen offset:1024 sc1
  v_mfma_f32_32x32x16_bf16 v[16:31], v[172:175], v[228:231], v[16:31]
  ds_read_b128 v[144:147], v240 offset:8192
  v_mfma_f32_32x32x16_bf16 v[32:47], v[176:179], v[228:231], v[32:47]
  ds_read_b128 v[148:151], v240 offset:9216
  v_mfma_f32_32x32x16_bf16 v[48:63], v[180:183], v[228:231], v[48:63]
  ds_read_b128 v[152:155], v240 offset:10240
  v_mfma_f32_32x32x16_bf16 v[64:79], v[184:187], v[228:231], v[64:79]
  ds_read_b128 v[156:159], v240 offset:11264
  v_mfma_f32_32x32x16_bf16 v[80:95], v[188:191], v[228:231], v[80:95]
  ds_read_b128 v[160:163], v240 offset:12288
  v_mfma_f32_32x32x16_bf16 v[96:111], v[192:195], v[228:231], v[96:111]
  ds_read_b128 v[164:167], v240 offset:13312
  s_barrier
  v_add_u32 v240, 43008, v255
  s_waitcnt vmcnt(7) lgkmcnt(7)
  v_mfma_f32_32x32x16_bf16 v[0:15], v[112:115], v[196:199], v[0:15]
  ds_read_b128 v[168:171], v240 offset:0
  buffer_load_dwordx4 v[228:231], v255, s[8:11], s84 offen offset:2048 sc1
  v_mfma_f32_32x32x16_bf16 v[16:31], v[116:119], v[196:199], v[16:31]
  ds_read_b128 v[172:175], v240 offset:1024
  v_mfma_f32_32x32x16_bf16 v[32:47], v[120:123], v[196:199], v[32:47]
  ds_read_b128 v[176:179], v240 offset:2048
  v_mfma_f32_32x32x16_bf16 v[48:63], v[124:127], v[196:199], v[48:63]
  ds_read_b128 v[180:183], v240 offset:3072
  v_mfma_f32_32x32x16_bf16 v[64:79], v[128:131], v[196:199], v[64:79]
  ds_read_b128 v[184:187], v240 offset:4096
  v_mfma_f32_32x32x16_bf16 v[80:95], v[132:135], v[196:199], v[80:95]
  ds_read_b128 v[188:191], v240 offset:5120
  v_mfma_f32_32x32x16_bf16 v[96:111], v[136:139], v[196:199], v[96:111]
  ds_read_b128 v[192:195], v240 offset:6144
  s_waitcnt vmcnt(7) lgkmcnt(7)
  v_mfma_f32_32x32x16_bf16 v[0:15], v[140:143], v[200:203], v[0:15]
  ds_read_b128 v[112:115], v240 offset:7168
  buffer_load_dwordx4 v[196:199], v255, s[8:11], s84 offen offset:3072 sc1
  s_add_u32 s84, s84, 4096
  v_mfma_f32_32x32x16_bf16 v[16:31], v[144:147], v[200:203], v[16:31]
  ds_read_b128 v[116:119], v240 offset:8192
  v_mfma_f32_32x32x16_bf16 v[32:47], v[148:151], v[200:203], v[32:47]
  ds_read_b128 v[120:123], v240 offset:9216
  v_mfma_f32_32x32x16_bf16 v[48:63], v[152:155], v[200:203], v[48:63]
  ds_read_b128 v[124:127], v240 offset:10240
  v_mfma_f32_32x32x16_bf16 v[64:79], v[156:159], v[200:203], v[64:79]
  ds_read_b128 v[128:131], v240 offset:11264
  v_mfma_f32_32x32x16_bf16 v[80:95], v[160:163], v[200:203], v[80:95]
  ds_read_b128 v[132:135], v240 offset:12288
  v_mfma_f32_32x32x16_bf16 v[96:111], v[164:167], v[200:203], v[96:111]
  ds_read_b128 v[136:139], v240 offset:13312
  s_barrier
  v_add_u32 v240, 77824, v255
  s_waitcnt vmcnt(7) lgkmcnt(7)
  v_mfma_f32_32x32x16_bf16 v[0:15], v[168:171], v[204:207], v[0:15]
  ds_read_b128 v[140:143], v240 offset:0
  buffer_load_dwordx4 v[200:203], v255, s[8:11], s84 offen offset:0 sc1
  v_mfma_f32_32x32x16_bf16 v[16:31], v[172:175], v[204:207], v[16:31]
  ds_read_b128 v[144:147], v240 offset:1024
  v_mfma_f32_32x32x16_bf16 v[32:47], v[176:179], v[204:207], v[32:47]
  ds_read_b128 v[148:151], v240 offset:2048
  v_mfma_f32_32x32x16_bf16 v[48:63], v[180:183], v[204:207], v[48:63]
  ds_read_b128 v[152:155], v240 offset:3072
  v_mfma_f32_32x32x16_bf16 v[64:79], v[184:187], v[204:207], v[64:79]
  ds_read_b128 v[156:159], v240 offset:4096
  v_mfma_f32_32x32x16_bf16 v[80:95], v[188:191], v[204:207], v[80:95]
  ds_read_b128 v[160:163], v240 offset:5120
  v_mfma_f32_32x32x16_bf16 v[96:111], v[192:195], v[204:207], v[96:111]
  ds_read_b128 v[164:167], v240 offset:6144
  s_waitcnt vmcnt(7) lgkmcnt(7)
  v_mfma_f32_32x32x16_bf16 v[0:15], v[112:115], v[208:211], v[0:15]
  ds_read_b128 v[168:171], v240 offset:7168
  buffer_load_dwordx4 v[204:207], v255, s[8:11], s84 offen offset:1024 sc1
  v_mfma_f32_32x32x16_bf16 v[16:31], v[116:119], v[208:211], v[16:31]
  ds_read_b128 v[172:175], v240 offset:8192
  v_mfma_f32_32x32x16_bf16 v[32:47], v[120:123], v[208:211], v[32:47]
  ds_read_b128 v[176:179], v240 offset:9216
  v_mfma_f32_32x32x16_bf16 v[48:63], v[124:127], v[208:211], v[48:63]
  ds_read_b128 v[180:183], v240 offset:10240
  v_mfma_f32_32x32x16_bf16 v[64:79], v[128:131], v[208:211], v[64:79]
  ds_read_b128 v[184:187], v240 offset:11264
  v_mfma_f32_32x32x16_bf16 v[80:95], v[132:135], v[208:211], v[80:95]
  ds_read_b128 v[188:191], v240 offset:12288
  v_mfma_f32_32x32x16_bf16 v[96:111], v[136:139], v[208:211], v[96:111]
  ds_read_b128 v[192:195], v240 offset:13312
  s_barrier
  v_add_u32 v240, 0, v255
  s_waitcnt vmcnt(7) lgkmcnt(7)
  v_mfma_f32_32x32x16_bf16 v[0:15], v[140:143], v[212:215], v[0:15]
  ds_read_b128 v[112:115], v240 offset:0
  buffer_load_dwordx4 v[208:211], v255, s[8:11], s84 offen offset:2048 sc1
  v_mfma_f32_32x32x16_bf16 v[16:31], v[144:147], v[212:215], v[16:31]
  ds_read_b128 v[116:119], v240 offset:1024
  v_mfma_f32_32x32x16_bf16 v[32:47], v[148:151], v[212:215], v[32:47]
  ds_read_b128 v[120:123], v240 offset:2048
  v_mfma_f32_32x32x16_bf16 v[48:63], v[152:155], v[212:215], v[48:63]
  ds_read_b128 v[124:127], v240 offset:3072
  v_mfma_f32_32x32x16_bf16 v[64:79], v[156:159], v[212:215], v[64:79]
  ds_read_b128 v[128:131], v240 offset:4096
  v_mfma_f32_32x32x16_bf16 v[80:95], v[160:163], v[212:215], v[80:95]
  ds_read_b128 v[132:135], v240 offset:5120
  v_mfma_f32_32x32x16_bf16 v[96:111], v[164:167], v[212:215], v[96:111]
  ds_read_b128 v[136:139], v240 offset:6144
  s_waitcnt vmcnt(7) lgkmcnt(7)
  v_mfma_f32_32x32x16_bf16 v[0:15], v[168:171], v[216:219], v[0:15]
  ds_read_b128 v[140:143], v240 offset:7168
  buffer_load_dwordx4 v[212:215], v255, s[8:11], s84 offen offset:3072 sc1
  s_add_u32 s84, s84, 4096
  v_mfma_f32_32x32x16_bf16 v[16:31], v[172:175], v[216:219], v[16:31]
  ds_read_b128 v[144:147], v240 offset:8192
  v_mfma_f32_32x32x16_bf16 v[32:47], v[176:179], v[216:219], v[32:47]
  ds_read_b128 v[148:151], v240 offset:9216
  v_mfma_f32_32x32x16_bf16 v[48:63], v[180:183], v[216:219], v[48:63]
  ds_read_b128 v[152:155], v240 offset:10240
  v_mfma_f32_32x32x16_bf16 v[64:79], v[184:187], v[216:219], v[64:79]
  ds_read_b128 v[156:159], v240 offset:11264
  v_mfma_f32_32x32x16_bf16 v[80:95], v[188:191], v[216:219], v[80:95]
  ds_read_b128 v[160:163], v240 offset:12288
  v_mfma_f32_32x32x16_bf16 v[96:111], v[192:195], v[216:219], v[96:111]
  ds_read_b128 v[164:167], v240 offset:13312
  s_barrier
  v_add_u32 v240, 57344, v255
  s_waitcnt vmcnt(7) lgkmcnt(7)
  v_mfma_f32_32x32x16_bf16 v[0:15], v[112:115], v[220:223], v[0:15]
  ds_read_b128 v[168:171], v240 offset:0
  buffer_load_dwordx4 v[216:219], v255, s[8:11], s84 offen offset:0 sc1
  v_mfma_f32_32x32x16_bf16 v[16:31], v[116:119], v[220:223], v[16:31]
  ds_read_b128 v[172:175], v240 offset:1024
  v_mfma_f32_32x32x16_bf16 v[32:47], v[120:123], v[220:223], v[32:47]
  ds_read_b128 v[176:179], v240 offset:2048
  v_mfma_f32_32x32x16_bf16 v[48:63], v[124:127], v[220:223], v[48:63]
  ds_read_b128 v[180:183], v240 offset:3072
  v_mfma_f32_32x32x16_bf16 v[64:79], v[128:131], v[220:223], v[64:79]
  ds_read_b128 v[184:187], v240 offset:4096
  v_mfma_f32_32x32x16_bf16 v[80:95], v[132:135], v[220:223], v[80:95]
  ds_read_b128 v[188:191], v240 offset:5120
  v_mfma_f32_32x32x16_bf16 v[96:111], v[136:139], v[220:223], v[96:111]
  ds_read_b128 v[192:195], v240 offset:6144
  s_waitcnt vmcnt(7) lgkmcnt(7)
  v_mfma_f32_32x32x16_bf16 v[0:15], v[140:143], v[224:227], v[0:15]
  ds_read_b128 v[112:115], v240 offset:7168
  buffer_load_dwordx4 v[220:223], v255, s[8:11], s84 offen offset:1024 sc1
  v_mfma_f32_32x32x16_bf16 v[16:31], v[144:147], v[224:227], v[16:31]
  ds_read_b128 v[116:119], v240 offset:8192
  v_mfma_f32_32x32x16_bf16 v[32:47], v[148:151], v[224:227], v[32:47]
  ds_read_b128 v[120:123], v240 offset:9216
  v_mfma_f32_32x32x16_bf16 v[48:63], v[152:155], v[224:227], v[48:63]
  ds_read_b128 v[124:127], v240 offset:10240
  v_mfma_f32_32x32x16_bf16 v[64:79], v[156:159], v[224:227], v[64:79]
  ds_read_b128 v[128:131], v240 offset:11264
  v_mfma_f32_32x32x16_bf16 v[80:95], v[160:163], v[224:227], v[80:95]
  ds_read_b128 v[132:135], v240 offset:12288
  v_mfma_f32_32x32x16_bf16 v[96:111], v[164:167], v[224:227], v[96:111]
  ds_read_b128 v[136:139], v240 offset:13312
  s_barrier
  v_add_u32 v240, 14336, v255
  s_waitcnt vmcnt(7) lgkmcnt(7)
  v_mfma_f32_32x32x16_bf16 v[0:15], v[168:171], v[228:231], v[0:15]
  ds_read_b128 v[140:143], v240 offset:0
  buffer_load_dwordx4 v[224:227], v255, s[8:11], s84 offen offset:2048 sc1
  v_mfma_f32_32x32x16_bf16 v[16:31], v[172:175], v[228:231], v[16:31]
  ds_read_b128 v[144:147], v240 offset:1024
  v_mfma_f32_32x32x16_bf16 v[32:47], v[176:179], v[228:231], v[32:47]
  ds_read_b128 v[148:151], v240 offset:2048
  v_mfma_f32_32x32x16_bf16 v[48:63], v[180:183], v[228:231], v[48:63]
  ds_read_b128 v[152:155], v240 offset:3072
  v_mfma_f32_32x32x16_bf16 v[64:79], v[184:187], v[228:231], v[64:79]
  ds_read_b128 v[156:159], v240 offset:4096
  v_mfma_f32_32x32x16_bf16 v[80:95], v[188:191], v[228:231], v[80:95]
  ds_read_b128 v[160:163], v240 offset:5120
  v_mfma_f32_32x32x16_bf16 v[96:111], v[192:195], v[228:231], v[96:111]
  ds_read_b128 v[164:167], v240 offset:6144
  s_waitcnt vmcnt(7) lgkmcnt(7)
  v_mfma_f32_32x32x16_bf16 v[0:15], v[112:115], v[196:199], v[0:15]
  ds_read_b128 v[168:171], v240 offset:7168
  buffer_load_dwordx4 v[228:231], v255, s[8:11], s84 offen offset:3072 sc1
  s_add_u32 s84, s84, 4096
  v_mfma_f32_32x32x16_bf16 v[16:31], v[116:119], v[196:199], v[16:31]
  ds_read_b128 v[172:175], v240 offset:8192
  v_mfma_f32_32x32x16_bf16 v[32:47], v[120:123], v[196:199], v[32:47]
  ds_read_b128 v[176:179], v240 offset:9216
  v_mfma_f32_32x32x16_bf16 v[48:63], v[124:127], v[196:199], v[48:63]
  ds_read_b128 v[180:183], v240 offset:10240
  v_mfma_f32_32x32x16_bf16 v[64:79], v[128:131], v[196:199], v[64:79]
  ds_read_b128 v[184:187], v240 offset:11264
  v_mfma_f32_32x32x16_bf16 v[80:95], v[132:135], v[196:199], v[80:95]
  ds_read_b128 v[188:191], v240 offset:12288
  v_mfma_f32_32x32x16_bf16 v[96:111], v[136:139], v[196:199], v[96:111]
  ds_read_b128 v[192:195], v240 offset:13312
  s_barrier
  v_add_u32 v240, 92160, v255
  s_waitcnt vmcnt(7) lgkmcnt(7)
  v_mfma_f32_32x32x16_bf16 v[0:15], v[140:143], v[200:203], v[0:15]
  ds_read_b128 v[112:115], v240 offset:0
  buffer_load_dwordx4 v[196:199], v255, s[8:11], s84 offen offset:0 sc1
  v_mfma_f32_32x32x16_bf16 v[16:31], v[144:147], v[200:203], v[16:31]
  ds_read_b128 v[116:119], v240 offset:1024
  v_mfma_f32_32x32x16_bf16 v[32:47], v[148:151], v[200:203], v[32:47]
  ds_read_b128 v[120:123], v240 offset:2048
  v_mfma_f32_32x32x16_bf16 v[48:63], v[152:155], v[200:203], v[48:63]
  ds_read_b128 v[124:127], v240 offset:3072
  v_mfma_f32_32x32x16_bf16 v[64:79], v[156:159], v[200:203], v[64:79]
  ds_read_b128 v[128:131], v240 offset:4096
  v_mfma_f32_32x32x16_bf16 v[80:95], v[160:163], v[200:203], v[80:95]
  ds_read_b128 v[132:135], v240 offset:5120
  v_mfma_f32_32x32x16_bf16 v[96:111], v[164:167], v[200:203], v[96:111]
  ds_read_b128 v[136:139], v240 offset:6144
  s_waitcnt vmcnt(7) lgkmcnt(7)
  v_mfma_f32_32x32x16_bf16 v[0:15], v[168:171], v[204:207], v[0:15]
  ds_read_b128 v[140:143], v240 offset:7168
  buffer_load_dwordx4 v[200:203], v255, s[8:11], s84 offen offset:1024 sc1
  v_mfma_f32_32x32x16_bf16 v[16:31], v[172:175], v[204:207], v[16:31]
  ds_read_b128 v[144:147], v240 offset:8192
  v_mfma_f32_32x32x16_bf16 v[32:47], v[176:179], v[204:207], v[32:47]
  ds_read_b128 v[148:151], v240 offset:9216
  v_mfma_f32_32x32x16_bf16 v[48:63], v[180:183], v[204:207], v[48:63]
  ds_read_b128 v[152:155], v240 offset:10240
  v_mfma_f32_32x32x16_bf16 v[64:79], v[184:187], v[204:207], v[64:79]
  ds_read_b128 v[156:159], v240 offset:11264
  v_mfma_f32_32x32x16_bf16 v[80:95], v[188:191], v[204:207], v[80:95]
  ds_read_b128 v[160:163], v240 offset:12288
  v_mfma_f32_32x32x16_bf16 v[96:111], v[192:195], v[204:207], v[96:111]
  ds_read_b128 v[164:167], v240 offset:13312
  s_barrier
  v_add_u32 v240, 28672, v255
  s_waitcnt vmcnt(7) lgkmcnt(7)
  v_mfma_f32_32x32x16_bf16 v[0:15], v[112:115], v[208:211], v[0:15]
  ds_read_b128 v[168:171], v240 offset:0
  buffer_load_dwordx4 v[204:207], v255, s[8:11], s84 offen offset:2048 sc1
  v_mfma_f32_32x32x16_bf16 v[16:31], v[116:119], v[208:211], v[16:31]
  ds_read_b128 v[172:175], v240 offset:1024
  v_mfma_f32_32x32x16_bf16 v[32:47], v[120:123], v[208:211], v[32:47]
  ds_read_b128 v[176:179], v240 offset:2048
  v_mfma_f32_32x32x16_bf16 v[48:63], v[124:127], v[208:211], v[48:63]
  ds_read_b128 v[180:183], v240 offset:3072
  v_mfma_f32_32x32x16_bf16 v[64:79], v[128:131], v[208:211], v[64:79]
  ds_read_b128 v[184:187], v240 offset:4096
  v_mfma_f32_32x32x16_bf16 v[80:95], v[132:135], v[208:211], v[80:95]
  ds_read_b128 v[188:191], v240 offset:5120
  v_mfma_f32_32x32x16_bf16 v[96:111], v[136:139], v[208:211], v[96:111]
  ds_read_b128 v[192:195], v240 offset:6144
  v_mov_b32 v234, 0
  v_mov_b32 v235, 0
  v_and_b32 v243, 31, v254
  v_lshlrev_b32 v243, 3, v243
  v_add_u32 v243, 158720, v243
  s_mul_i32 s78, s5, 768
  s_add_u32 s78, s78, 160768
  v_lshlrev_b32 v244, 3, v254
  v_add_u32 v244, s78, v244
  v_lshlrev_b32 v245, 2, v254
  v_add_u32 v245, s78, v245
  s_waitcnt vmcnt(7) lgkmcnt(7)
  v_mfma_f32_32x32x16_bf16 v[0:15], v[140:143], v[212:215], v[0:15]
  ds_read_b128 v[112:115], v240 offset:7168
  buffer_load_dwordx4 v[208:211], v255, s[8:11], s84 offen offset:3072 sc1
  s_add_u32 s84, s84, 4096
  v_mfma_f32_32x32x16_bf16 v[16:31], v[144:147], v[212:215], v[16:31]
  ds_read_b128 v[116:119], v240 offset:8192
  v_mfma_f32_32x32x16_bf16 v[32:47], v[148:151], v[212:215], v[32:47]
  ds_read_b128 v[120:123], v240 offset:9216
  v_mfma_f32_32x32x16_bf16 v[48:63], v[152:155], v[212:215], v[48:63]
  ds_read_b128 v[124:127], v240 offset:10240
  v_mfma_f32_32x32x16_bf16 v[64:79], v[156:159], v[212:215], v[64:79]
  ds_read_b128 v[128:131], v240 offset:11264
  v_mfma_f32_32x32x16_bf16 v[80:95], v[160:163], v[212:215], v[80:95]
  ds_read_b128 v[132:135], v240 offset:12288
  v_mfma_f32_32x32x16_bf16 v[96:111], v[164:167], v[212:215], v[96:111]
  ds_read_b128 v[136:139], v240 offset:13312
  s_barrier
  v_add_u32 v240, 106496, v255
  s_waitcnt vmcnt(7) lgkmcnt(7)
  v_mfma_f32_32x32x16_bf16 v[0:15], v[168:171], v[216:219], v[0:15]
  ds_read_b128 v[140:143], v240 offset:0
  v_mfma_f32_32x32x16_bf16 v[16:31], v[172:175], v[216:219], v[16:31]
  ds_read_b128 v[144:147], v240 offset:1024
  v_mfma_f32_32x32x16_bf16 v[32:47], v[176:179], v[216:219], v[32:47]
  ds_read_b128 v[148:151], v240 offset:2048
  v_mfma_f32_32x32x16_bf16 v[48:63], v[180:183], v[216:219], v[48:63]
  ds_read_b128 v[152:155], v240 offset:3072
  v_mfma_f32_32x32x16_bf16 v[64:79], v[184:187], v[216:219], v[64:79]
  ds_read_b128 v[156:159], v240 offset:4096
  v_mfma_f32_32x32x16_bf16 v[80:95], v[188:191], v[216:219], v[80:95]
  ds_read_b128 v[160:163], v240 offset:5120
  v_mfma_f32_32x32x16_bf16 v[96:111], v[192:195], v[216:219], v[96:111]
  ds_read_b128 v[164:167], v240 offset:6144
  s_waitcnt vmcnt(6) lgkmcnt(7)
  v_mfma_f32_32x32x16_bf16 v[0:15], v[112:115], v[220:223], v[0:15]
  ds_read_b128 v[168:171], v240 offset:7168
  v_mfma_f32_32x32x16_bf16 v[16:31], v[116:119], v[220:223], v[16:31]
  ds_read_b128 v[172:175], v240 offset:8192
  v_mfma_f32_32x32x16_bf16 v[32:47], v[120:123], v[220:223], v[32:47]
  ds_read_b128 v[176:179], v240 offset:9216
  v_mfma_f32_32x32x16_bf16 v[48:63], v[124:127], v[220:223], v[48:63]
  ds_read_b128 v[180:183], v240 offset:10240
  v_mfma_f32_32x32x16_bf16 v[64:79], v[128:131], v[220:223], v[64:79]
  ds_read_b128 v[184:187], v240 offset:11264
  v_mfma_f32_32x32x16_bf16 v[80:95], v[132:135], v[220:223], v[80:95]
  ds_read_b128 v[188:191], v240 offset:12288
  v_mfma_f32_32x32x16_bf16 v[96:111], v[136:139], v[220:223], v[96:111]
  ds_read_b128 v[192:195], v240 offset:13312
  s_barrier
  v_add_u32 v240, 43008, v255
  s_waitcnt vmcnt(5) lgkmcnt(7)
  v_mfma_f32_32x32x16_bf16 v[0:15], v[140:143], v[224:227], v[0:15]
  ds_read_b128 v[112:115], v240 offset:0
  v_mfma_f32_32x32x16_bf16 v[16:31], v[144:147], v[224:227], v[16:31]
  ds_read_b128 v[116:119], v240 offset:1024
  v_mfma_f32_32x32x16_bf16 v[32:47], v[148:151], v[224:227], v[32:47]
  ds_read_b128 v[120:123], v240 offset:2048
  v_mfma_f32_32x32x16_bf16 v[48:63], v[152:155], v[224:227], v[48:63]
  ds_read_b128 v[124:127], v240 offset:3072
  v_mfma_f32_32x32x16_bf16 v[64:79], v[156:159], v[224:227], v[64:79]
  ds_read_b128 v[128:131], v240 offset:4096
  v_mfma_f32_32x32x16_bf16 v[80:95], v[160:163], v[224:227], v[80:95]
  ds_read_b128 v[132:135], v240 offset:5120
  v_mfma_f32_32x32x16_bf16 v[96:111], v[164:167], v[224:227], v[96:111]
  ds_read_b128 v[136:139], v240 offset:6144
  s_waitcnt vmcnt(4) lgkmcnt(7)
  v_mfma_f32_32x32x16_bf16 v[0:15], v[168:171], v[228:231], v[0:15]
  ds_read_b128 v[140:143], v240 offset:7168
  v_mfma_f32_32x32x16_bf16 v[16:31], v[172:175], v[228:231], v[16:31]
  ds_read_b128 v[144:147], v240 offset:8192
  v_mfma_f32_32x32x16_bf16 v[32:47], v[176:179], v[228:231], v[32:47]
  ds_read_b128 v[148:151], v240 offset:9216
  v_mfma_f32_32x32x16_bf16 v[48:63], v[180:183], v[228:231], v[48:63]
  ds_read_b128 v[152:155], v240 offset:10240
  v_mfma_f32_32x32x16_bf16 v[64:79], v[184:187], v[228:231], v[64:79]
  ds_read_b128 v[156:159], v240 offset:11264
  v_mfma_f32_32x32x16_bf16 v[80:95], v[188:191], v[228:231], v[80:95]
  ds_read_b128 v[160:163], v240 offset:12288
  v_mfma_f32_32x32x16_bf16 v[96:111], v[192:195], v[228:231], v[96:111]
  ds_read_b128 v[164:167], v240 offset:13312
  s_barrier
  v_add_u32 v240, 120832, v255
  s_waitcnt vmcnt(3) lgkmcnt(7)
  v_mfma_f32_32x32x16_bf16 v[0:15], v[112:115], v[196:199], v[0:15]
  ds_read_b128 v[168:171], v240 offset:0
  v_mfma_f32_32x32x16_bf16 v[16:31], v[116:119], v[196:199], v[16:31]
  ds_read_b128 v[172:175], v240 offset:1024
  v_mfma_f32_32x32x16_bf16 v[32:47], v[120:123], v[196:199], v[32:47]
  ds_read_b128 v[176:179], v240 offset:2048
  v_mfma_f32_32x32x16_bf16 v[48:63], v[124:127], v[196:199], v[48:63]
  ds_read_b128 v[180:183], v240 offset:3072
  v_mfma_f32_32x32x16_bf16 v[64:79], v[128:131], v[196:199], v[64:79]
  ds_read_b128 v[184:187], v240 offset:4096
  v_mfma_f32_32x32x16_bf16 v[80:95], v[132:135], v[196:199], v[80:95]
  ds_read_b128 v[188:191], v240 offset:5120
  v_mfma_f32_32x32x16_bf16 v[96:111], v[136:139], v[196:199], v[96:111]
  ds_read_b128 v[192:195], v240 offset:6144
  s_waitcnt vmcnt(2) lgkmcnt(7)
  v_mfma_f32_32x32x16_bf16 v[0:15], v[140:143], v[200:203], v[0:15]
  ds_read_b128 v[112:115], v240 offset:7168
  v_mfma_f32_32x32x16_bf16 v[16:31], v[144:147], v[200:203], v[16:31]
  ds_read_b128 v[116:119], v240 offset:8192
  v_mfma_f32_32x32x16_bf16 v[32:47], v[148:151], v[200:203], v[32:47]
  ds_read_b128 v[120:123], v240 offset:9216
  v_mfma_f32_32x32x16_bf16 v[48:63], v[152:155], v[200:203], v[48:63]
  ds_read_b128 v[124:127], v240 offset:10240
  v_mfma_f32_32x32x16_bf16 v[64:79], v[156:159], v[200:203], v[64:79]
  ds_read_b128 v[128:131], v240 offset:11264
  v_mfma_f32_32x32x16_bf16 v[80:95], v[160:163], v[200:203], v[80:95]
  ds_read_b128 v[132:135], v240 offset:12288
  v_mfma_f32_32x32x16_bf16 v[96:111], v[164:167], v[200:203], v[96:111]
  ds_read_b128 v[136:139], v240 offset:13312
  s_barrier
  s_waitcnt vmcnt(1) lgkmcnt(7)
  v_mfma_f32_32x32x16_bf16 v[0:15], v[168:171], v[204:207], v[0:15]
  v_mfma_f32_32x32x16_bf16 v[16:31], v[172:175], v[204:207], v[16:31]
  v_mfma_f32_32x32x16_bf16 v[32:47], v[176:179], v[204:207], v[32:47]
  v_mfma_f32_32x32x16_bf16 v[48:63], v[180:183], v[204:207], v[48:63]
  v_mfma_f32_32x32x16_bf16 v[64:79], v[184:187], v[204:207], v[64:79]
  v_mfma_f32_32x32x16_bf16 v[80:95], v[188:191], v[204:207], v[80:95]
  v_mfma_f32_32x32x16_bf16 v[96:111], v[192:195], v[204:207], v[96:111]
  v_mov_b32 v142, 0
  v_mov_b32 v143, 0
  ds_read_b64 v[140:141], v243 offset:0
  v_mov_b32 v146, 0
  v_mov_b32 v147, 0
  ds_read_b64 v[144:145], v243 offset:256
  v_mov_b32 v150, 0
  v_mov_b32 v151, 0
  ds_read_b64 v[148:149], v243 offset:512
  v_mov_b32 v154, 0
  v_mov_b32 v155, 0
  ds_read_b64 v[152:153], v243 offset:768
  v_mov_b32 v158, 0
  v_mov_b32 v159, 0
  ds_read_b64 v[156:157], v243 offset:1024
  v_mov_b32 v162, 0
  v_mov_b32 v163, 0
  ds_read_b64 v[160:161], v243 offset:1280
  v_mov_b32 v166, 0
  v_mov_b32 v167, 0
  ds_read_b64 v[164:165], v243 offset:1536
  ds_read_b64 v[232:233], v244
  ds_read_b32 v236, v245 offset:512
  s_waitcnt vmcnt(0) lgkmcnt(9)
  v_mfma_f32_32x32x16_bf16 v[0:15], v[112:115], v[208:211], v[0:15]
  v_mfma_f32_32x32x16_bf16 v[16:31], v[116:119], v[208:211], v[16:31]
  v_mfma_f32_32x32x16_bf16 v[32:47], v[120:123], v[208:211], v[32:47]
  v_mfma_f32_32x32x16_bf16 v[48:63], v[124:127], v[208:211], v[48:63]
  v_mfma_f32_32x32x16_bf16 v[64:79], v[128:131], v[208:211], v[64:79]
  v_mfma_f32_32x32x16_bf16 v[80:95], v[132:135], v[208:211], v[80:95]
  v_mfma_f32_32x32x16_bf16 v[96:111], v[136:139], v[208:211], v[96:111]
  s_waitcnt lgkmcnt(0)
  v_mfma_f32_32x32x16_bf16 v[0:15], v[140:143], v[232:235], v[0:15]
  v_mfma_f32_32x32x16_bf16 v[16:31], v[144:147], v[232:235], v[16:31]
  v_mfma_f32_32x32x16_bf16 v[32:47], v[148:151], v[232:235], v[32:47]
  v_mul_f32 v236, v236, v236
  s_add_u32 s87, s86, 4096
  s_cmp_eq_u32 s7, 0
  s_cbranch_scc1 L_gslow_57
  v_pk_mul_f32 v[0:1], v[0:1], v[8:9]
  v_pk_mul_f32 v[2:3], v[2:3], v[10:11]
  v_pk_mul_f32 v[4:5], v[4:5], v[12:13]
  v_pk_mul_f32 v[6:7], v[6:7], v[14:15]
  v_mfma_f32_32x32x16_bf16 v[48:63], v[152:155], v[232:235], v[48:63]
  v_pk_mul_f32 v[0:1], v[0:1], v[236:237] op_sel_hi:[1,0]
  v_pk_mul_f32 v[2:3], v[2:3], v[236:237] op_sel_hi:[1,0]
  v_pk_mul_f32 v[4:5], v[4:5], v[236:237] op_sel_hi:[1,0]
  v_pk_mul_f32 v[6:7], v[6:7], v[236:237] op_sel_hi:[1,0]
  v_cvt_pk_bf16_f32 v196, v0, v1
  v_cvt_pk_bf16_f32 v197, v2, v3
  v_cvt_pk_bf16_f32 v198, v4, v5
  v_cvt_pk_bf16_f32 v199, v6, v7
  buffer_store_dwordx4 v[196:199], v255, s[8:11], s86 offen offset:0
  v_pk_mul_f32 v[16:17], v[16:17], v[24:25]
  v_pk_mul_f32 v[18:19], v[18:19], v[26:27]
  v_pk_mul_f32 v[20:21], v[20:21], v[28:29]
  v_pk_mul_f32 v[22:23], v[22:23], v[30:31]
  v_mfma_f32_32x32x16_bf16 v[64:79], v[156:159], v[232:235], v[64:79]
  v_pk_mul_f32 v[16:17], v[16:17], v[236:237] op_sel_hi:[1,0]
  v_pk_mul_f32 v[18:19], v[18:19], v[236:237] op_sel_hi:[1,0]
  v_pk_mul_f32 v[20:21], v[20:21], v[236:237] op_sel_hi:[1,0]
  v_pk_mul_f32 v[22:23], v[22:23], v[236:237] op_sel_hi:[1,0]
  v_cvt_pk_bf16_f32 v200, v16, v17
  v_cvt_pk_bf16_f32 v201, v18, v19
  v_cvt_pk_bf16_f32 v202, v20, v21
  v_cvt_pk_bf16_f32 v203, v22, v23
  buffer_store_dwordx4 v[200:203], v255, s[8:11], s86 offen offset:1024
  v_pk_mul_f32 v[32:33], v[32:33], v[40:41]
  v_pk_mul_f32 v[34:35], v[34:35], v[42:43]
  v_pk_mul_f32 v[36:37], v[36:37], v[44:45]
  v_pk_mul_f32 v[38:39], v[38:39], v[46:47]
  v_mfma_f32_32x32x16_bf16 v[80:95], v[160:163], v[232:235], v[80:95]
  v_pk_mul_f32 v[32:33], v[32:33], v[236:237] op_sel_hi:[1,0]
  v_pk_mul_f32 v[34:35], v[34:35], v[236:237] op_sel_hi:[1,0]
  v_pk_mul_f32 v[36:37], v[36:37], v[236:237] op_sel_hi:[1,0]
  v_pk_mul_f32 v[38:39], v[38:39], v[236:237] op_sel_hi:[1,0]
  v_cvt_pk_bf16_f32 v204, v32, v33
  v_cvt_pk_bf16_f32 v205, v34, v35
  v_cvt_pk_bf16_f32 v206, v36, v37
  v_cvt_pk_bf16_f32 v207, v38, v39
  buffer_store_dwordx4 v[204:207], v255, s[8:11], s86 offen offset:2048
  v_pk_mul_f32 v[48:49], v[48:49], v[56:57]
  v_pk_mul_f32 v[50:51], v[50:51], v[58:59]
  v_pk_mul_f32 v[52:53], v[52:53], v[60:61]
  v_pk_mul_f32 v[54:55], v[54:55], v[62:63]
  v_mfma_f32_32x32x16_bf16 v[96:111], v[164:167], v[232:235], v[96:111]
  v_pk_mul_f32 v[48:49], v[48:49], v[236:237] op_sel_hi:[1,0]
  v_pk_mul_f32 v[50:51], v[50:51], v[236:237] op_sel_hi:[1,0]
  v_pk_mul_f32 v[52:53], v[52:53], v[236:237] op_sel_hi:[1,0]
  v_pk_mul_f32 v[54:55], v[54:55], v[236:237] op_sel_hi:[1,0]
  v_cvt_pk_bf16_f32 v208, v48, v49
  v_cvt_pk_bf16_f32 v209, v50, v51
  v_cvt_pk_bf16_f32 v210, v52, v53
  v_cvt_pk_bf16_f32 v211, v54, v55
  buffer_store_dwordx4 v[208:211], v255, s[8:11], s86 offen offset:3072
  v_pk_mul_f32 v[64:65], v[64:65], v[72:73]
  v_pk_mul_f32 v[66:67], v[66:67], v[74:75]
  v_pk_mul_f32 v[68:69], v[68:69], v[76:77]
  v_pk_mul_f32 v[70:71], v[70:71], v[78:79]
  v_pk_mul_f32 v[64:65], v[64:65], v[236:237] op_sel_hi:[1,0]
  v_pk_mul_f32 v[66:67], v[66:67], v[236:237] op_sel_hi:[1,0]
  v_pk_mul_f32 v[68:69], v[68:69], v[236:237] op_sel_hi:[1,0]
  v_pk_mul_f32 v[70:71], v[70:71], v[236:237] op_sel_hi:[1,0]
  v_cvt_pk_bf16_f32 v212, v64, v65
  v_cvt_pk_bf16_f32 v213, v66, v67
  v_cvt_pk_bf16_f32 v214, v68, v69
  v_cvt_pk_bf16_f32 v215, v70, v71
  buffer_store_dwordx4 v[212:215], v255, s[8:11], s87 offen offset:0
  v_pk_mul_f32 v[80:81], v[80:81], v[88:89]
  v_pk_mul_f32 v[82:83], v[82:83], v[90:91]
  v_pk_mul_f32 v[84:85], v[84:85], v[92:93]
  v_pk_mul_f32 v[86:87], v[86:87], v[94:95]
  v_pk_mul_f32 v[80:81], v[80:81], v[236:237] op_sel_hi:[1,0]
  v_pk_mul_f32 v[82:83], v[82:83], v[236:237] op_sel_hi:[1,0]
  v_pk_mul_f32 v[84:85], v[84:85], v[236:237] op_sel_hi:[1,0]
  v_pk_mul_f32 v[86:87], v[86:87], v[236:237] op_sel_hi:[1,0]
  v_cvt_pk_bf16_f32 v216, v80, v81
  v_cvt_pk_bf16_f32 v217, v82, v83
  v_cvt_pk_bf16_f32 v218, v84, v85
  v_cvt_pk_bf16_f32 v219, v86, v87
  buffer_store_dwordx4 v[216:219], v255, s[8:11], s87 offen offset:1024
  v_pk_mul_f32 v[96:97], v[96:97], v[104:105]
  v_pk_mul_f32 v[98:99], v[98:99], v[106:107]
  v_pk_mul_f32 v[100:101], v[100:101], v[108:109]
  v_pk_mul_f32 v[102:103], v[102:103], v[110:111]
  v_pk_mul_f32 v[96:97], v[96:97], v[236:237] op_sel_hi:[1,0]
  v_pk_mul_f32 v[98:99], v[98:99], v[236:237] op_sel_hi:[1,0]
  v_pk_mul_f32 v[100:101], v[100:101], v[236:237] op_sel_hi:[1,0]
  v_pk_mul_f32 v[102:103], v[102:103], v[236:237] op_sel_hi:[1,0]
  v_cvt_pk_bf16_f32 v220, v96, v97
  v_cvt_pk_bf16_f32 v221, v98, v99
  v_cvt_pk_bf16_f32 v222, v100, v101
  v_cvt_pk_bf16_f32 v223, v102, v103
  buffer_store_dwordx4 v[220:223], v255, s[8:11], s87 offen offset:2048
  s_branch L_gjoin_58
L_gslow_57:
  s_nop 7
  s_nop 3
  v_pk_mul_f32 v[0:1], v[0:1], v[8:9]
  v_pk_mul_f32 v[2:3], v[2:3], v[10:11]
  v_pk_mul_f32 v[4:5], v[4:5], v[12:13]
  v_pk_mul_f32 v[6:7], v[6:7], v[14:15]
  v_mfma_f32_32x32x16_bf16 v[48:63], v[152:155], v[232:235], v[48:63]
  v_pk_mul_f32 v[0:1], v[0:1], v[236:237] op_sel_hi:[1,0]
  v_pk_mul_f32 v[2:3], v[2:3], v[236:237] op_sel_hi:[1,0]
  v_pk_mul_f32 v[4:5], v[4:5], v[236:237] op_sel_hi:[1,0]
  v_pk_mul_f32 v[6:7], v[6:7], v[236:237] op_sel_hi:[1,0]
  v_cvt_pk_bf16_f32 v196, v0, v1
  v_cvt_pk_bf16_f32 v197, v2, v3
  v_cvt_pk_bf16_f32 v198, v4, v5
  v_cvt_pk_bf16_f32 v199, v6, v7
  buffer_store_dwordx4 v[196:199], v255, s[8:11], s86 offen offset:0 sc1
  v_pk_mul_f32 v[16:17], v[16:17], v[24:25]
  v_pk_mul_f32 v[18:19], v[18:19], v[26:27]
  v_pk_mul_f32 v[20:21], v[20:21], v[28:29]
  v_pk_mul_f32 v[22:23], v[22:23], v[30:31]
  v_mfma_f32_32x32x16_bf16 v[64:79], v[156:159], v[232:235], v[64:79]
  v_pk_mul_f32 v[16:17], v[16:17], v[236:237] op_sel_hi:[1,0]
  v_pk_mul_f32 v[18:19], v[18:19], v[236:237] op_sel_hi:[1,0]
  v_pk_mul_f32 v[20:21], v[20:21], v[236:237] op_sel_hi:[1,0]
  v_pk_mul_f32 v[22:23], v[22:23], v[236:237] op_sel_hi:[1,0]
  v_cvt_pk_bf16_f32 v200, v16, v17
  v_cvt_pk_bf16_f32 v201, v18, v19
  v_cvt_pk_bf16_f32 v202, v20, v21
  v_cvt_pk_bf16_f32 v203, v22, v23
  buffer_store_dwordx4 v[200:203], v255, s[8:11], s86 offen offset:1024 sc1
  v_pk_mul_f32 v[32:33], v[32:33], v[40:41]
  v_pk_mul_f32 v[34:35], v[34:35], v[42:43]
  v_pk_mul_f32 v[36:37], v[36:37], v[44:45]
  v_pk_mul_f32 v[38:39], v[38:39], v[46:47]
  v_mfma_f32_32x32x16_bf16 v[80:95], v[160:163], v[232:235], v[80:95]
  v_pk_mul_f32 v[32:33], v[32:33], v[236:237] op_sel_hi:[1,0]
  v_pk_mul_f32 v[34:35], v[34:35], v[236:237] op_sel_hi:[1,0]
  v_pk_mul_f32 v[36:37], v[36:37], v[236:237] op_sel_hi:[1,0]
  v_pk_mul_f32 v[38:39], v[38:39], v[236:237] op_sel_hi:[1,0]
  v_cvt_pk_bf16_f32 v204, v32, v33
  v_cvt_pk_bf16_f32 v205, v34, v35
  v_cvt_pk_bf16_f32 v206, v36, v37
  v_cvt_pk_bf16_f32 v207, v38, v39
  buffer_store_dwordx4 v[204:207], v255, s[8:11], s86 offen offset:2048 sc1
  v_pk_mul_f32 v[48:49], v[48:49], v[56:57]
  v_pk_mul_f32 v[50:51], v[50:51], v[58:59]
  v_pk_mul_f32 v[52:53], v[52:53], v[60:61]
  v_pk_mul_f32 v[54:55], v[54:55], v[62:63]
  v_mfma_f32_32x32x16_bf16 v[96:111], v[164:167], v[232:235], v[96:111]
  v_pk_mul_f32 v[48:49], v[48:49], v[236:237] op_sel_hi:[1,0]
  v_pk_mul_f32 v[50:51], v[50:51], v[236:237] op_sel_hi:[1,0]
  v_pk_mul_f32 v[52:53], v[52:53], v[236:237] op_sel_hi:[1,0]
  v_pk_mul_f32 v[54:55], v[54:55], v[236:237] op_sel_hi:[1,0]
  v_cvt_pk_bf16_f32 v208, v48, v49
  v_cvt_pk_bf16_f32 v209, v50, v51
  v_cvt_pk_bf16_f32 v210, v52, v53
  v_cvt_pk_bf16_f32 v211, v54, v55
  buffer_store_dwordx4 v[208:211], v255, s[8:11], s86 offen offset:3072 sc1
  v_pk_mul_f32 v[64:65], v[64:65], v[72:73]
  v_pk_mul_f32 v[66:67], v[66:67], v[74:75]
  v_pk_mul_f32 v[68:69], v[68:69], v[76:77]
  v_pk_mul_f32 v[70:71], v[70:71], v[78:79]
  v_pk_mul_f32 v[64:65], v[64:65], v[236:237] op_sel_hi:[1,0]
  v_pk_mul_f32 v[66:67], v[66:67], v[236:237] op_sel_hi:[1,0]
  v_pk_mul_f32 v[68:69], v[68:69], v[236:237] op_sel_hi:[1,0]
  v_pk_mul_f32 v[70:71], v[70:71], v[236:237] op_sel_hi:[1,0]
  v_cvt_pk_bf16_f32 v212, v64, v65
  v_cvt_pk_bf16_f32 v213, v66, v67
  v_cvt_pk_bf16_f32 v214, v68, v69
  v_cvt_pk_bf16_f32 v215, v70, v71
  buffer_store_dwordx4 v[212:215], v255, s[8:11], s87 offen offset:0 sc1
  v_pk_mul_f32 v[80:81], v[80:81], v[88:89]
  v_pk_mul_f32 v[82:83], v[82:83], v[90:91]
  v_pk_mul_f32 v[84:85], v[84:85], v[92:93]
  v_pk_mul_f32 v[86:87], v[86:87], v[94:95]
  v_pk_mul_f32 v[80:81], v[80:81], v[236:237] op_sel_hi:[1,0]
  v_pk_mul_f32 v[82:83], v[82:83], v[236:237] op_sel_hi:[1,0]
  v_pk_mul_f32 v[84:85], v[84:85], v[236:237] op_sel_hi:[1,0]
  v_pk_mul_f32 v[86:87], v[86:87], v[236:237] op_sel_hi:[1,0]
  v_cvt_pk_bf16_f32 v216, v80, v81
  v_cvt_pk_bf16_f32 v217, v82, v83
  v_cvt_pk_bf16_f32 v218, v84, v85
  v_cvt_pk_bf16_f32 v219, v86, v87
  buffer_store_dwordx4 v[216:219], v255, s[8:11], s87 offen offset:1024 sc1
  v_pk_mul_f32 v[96:97], v[96:97], v[104:105]
  v_pk_mul_f32 v[98:99], v[98:99], v[106:107]
  v_pk_mul_f32 v[100:101], v[100:101], v[108:109]
  v_pk_mul_f32 v[102:103], v[102:103], v[110:111]
  v_pk_mul_f32 v[96:97], v[96:97], v[236:237] op_sel_hi:[1,0]
  v_pk_mul_f32 v[98:99], v[98:99], v[236:237] op_sel_hi:[1,0]
  v_pk_mul_f32 v[100:101], v[100:101], v[236:237] op_sel_hi:[1,0]
  v_pk_mul_f32 v[102:103], v[102:103], v[236:237] op_sel_hi:[1,0]
  v_cvt_pk_bf16_f32 v220, v96, v97
  v_cvt_pk_bf16_f32 v221, v98, v99
  v_cvt_pk_bf16_f32 v222, v100, v101
  v_cvt_pk_bf16_f32 v223, v102, v103
  buffer_store_dwordx4 v[220:223], v255, s[8:11], s87 offen offset:2048 sc1
L_gjoin_58:
  s_waitcnt vmcnt(0)
  s_add_u32 s66, s66, 1
  s_lshl_b32 s91, s3, 8
  s_add_u32 s91, s91, 0
  s_lshl_b32 s79, s4, 2
  s_add_u32 s79, s79, s5
  s_lshl_b32 s79, s79, 2
  v_mov_b32 v243, s66
  v_mov_b32 v244, s79
  v_lshlrev_b32 v250, 2, v254
  s_mov_b64 exec, 1
  s_cmp_eq_u32 s7, 0
  s_cbranch_scc1 L_slow_59
  buffer_store_dword v243, v244, s[8:11], s91 offen
  s_branch L_join_60
L_slow_59:
  buffer_store_dword v243, v244, s[8:11], s91 offen sc1
L_join_60:
  s_mov_b64 exec, -1
  s_barrier
  s_and_b32 s92, s5, 1
  s_lshr_b32 s93, s5, 1
  s_mul_i32 s78, s93, 2560
  v_add_u32 v242, s78, v255
  v_and_b32 v243, 15, v254
  v_lshlrev_b32 v243, 4, v243
  v_lshrrev_b32 v244, 5, v254
  v_lshl_add_u32 v243, v244, 8, v243
  s_add_u32 s78, s78, 2048
  v_add_u32 v238, s78, v243
  s_lshl_b32 s94, s68, 1
  s_add_u32 s94, s94, s92
  s_lshl_b32 s84, s6, 4
  s_add_u32 s84, s84, s3
  s_mul_i32 s84, s84, 442368
  s_mul_i32 s78, s94, 110592
  s_add_u32 s84, s84, s78
  s_mul_i32 s78, s93, 55296
  s_add_u32 s84, s84, s78
  s_add_u32 s84, s84, 37748736
  s_mul_i32 s81, s3, 163840
  s_mul_i32 s82, s94, 40960
  s_add_u32 s81, s81, s82
  s_mul_i32 s82, s67, 5120
  s_add_u32 s81, s81, s82
  s_mul_i32 s82, s93, 3072
  s_add_u32 s81, s81, s82
  s_add_u32 s81, s81, 25165824
  s_mul_i32 s86, s6, 5242880
  s_add_u32 s86, s86, s81
  s_add_u32 s86, s86, 2621440
  v_and_b32 v243, 31, v254
  v_lshrrev_b32 v244, 5, v254
  s_lshl_b32 s78, s3, 7
  s_lshl_b32 s79, s94, 5
  s_add_u32 s78, s78, s79
  v_add_u32 v243, s78, v243
  v_mul_u32_u24 v243, 1280, v243
  v_lshl_add_u32 v243, v244, 4, v243
  s_mul_i32 s80, s67, 160
  s_mul_i32 s82, s93, 96
  s_add_u32 s80, s80, s82
  s_add_u32 s82, s81, 5242880
  s_cmp_eq_u32 s6, 0
  s_cselect_b32 s20, s8, s24
  s_cselect_b32 s21, s9, s25
  s_cselect_b32 s22, s10, s26
  s_cselect_b32 s88, s82, s80
  s_cselect_b32 s89, 1024, 32
  v_mov_b32 v239, v255
  s_cbranch_scc1 L_dst_61
  v_mov_b32 v239, v243
L_dst_61:
  s_lshl_b32 s90, s6, 1
  s_add_u32 s90, s90, 2
  s_lshl_b32 s90, s90, 18
  s_lshl_b32 s78, s3, 14
  s_add_u32 s90, s90, s78
  s_lshl_b32 s78, s94, 12
  s_add_u32 s90, s90, s78
  s_lshl_b32 s78, s67, 9
  s_add_u32 s90, s90, s78
  s_lshl_b32 s78, s93, 3
  s_add_u32 s90, s90, s78
  s_add_u32 s90, s90, 65536
  s_mov_b32 s96, 0
L_poll_h_62:
  buffer_load_dword v251, v250, s[8:11], s91 offen sc1
  s_add_u32 s96, s96, 1
  s_cmp_gt_u32 s96, 200000
  s_cbranch_scc1 L_done_h_63
  s_waitcnt vmcnt(0)
  v_cmp_gt_u32 vcc, s66, v251
  s_cbranch_vccnz L_poll_h_62
L_done_h_63:
  s_waitcnt vmcnt(0)
  buffer_load_dwordx4 v[84:87], v255, s[8:11], s84 offen offset:0 sc1
  buffer_load_dwordx4 v[88:91], v255, s[8:11], s84 offen offset:1024 sc1
  buffer_load_dwordx4 v[92:95], v255, s[8:11], s84 offen offset:2048 sc1
  buffer_load_dwordx4 v[96:99], v255, s[8:11], s84 offen offset:3072 sc1
  s_add_u32 s84, s84, 4096
  buffer_load_dwordx4 v[100:103], v255, s[8:11], s84 offen offset:0 sc1
  buffer_load_dwordx4 v[104:107], v255, s[8:11], s84 offen offset:1024 sc1
  s_barrier
  v_add_u32 v240, 135168, v242
  v_add_u32 v237, 135168, v238
  ds_read_b128 v[48:51], v240 offset:0
  ds_read_b128 v[52:55], v240 offset:1024
  ds_read_b128 v[56:59], v237 offset:0
  ds_read_b128 v[60:63], v240 offset:5120
  ds_read_b128 v[64:67], v240 offset:6144
  ds_read_b128 v[68:71], v237 offset:5120
  s_waitcnt vmcnt(5) lgkmcnt(3)
  v_mfma_f32_32x32x16_bf16 v[0:15], v[48:51], v[84:87], 0
  ds_read_b128 v[72:75], v240 offset:10240
  buffer_load_dwordx4 v[108:111], v255, s[8:11], s84 offen offset:2048 sc1
  buffer_load_dwordx4 v[112:115], v255, s[8:11], s84 offen offset:3072 sc1
  s_add_u32 s84, s84, 4096
  buffer_load_dwordx4 v[116:119], v255, s[8:11], s84 offen offset:0 sc1
  v_mfma_f32_32x32x16_bf16 v[16:31], v[52:55], v[84:87], 0
  ds_read_b128 v[76:79], v240 offset:11264
  v_mfma_f32_32x32x16_bf16 v[32:47], v[56:59], v[84:87], 0
  ds_read_b128 v[80:83], v237 offset:10240
  s_waitcnt vmcnt(7) lgkmcnt(3)
  v_mfma_f32_32x32x16_bf16 v[0:15], v[60:63], v[88:91], v[0:15]
  ds_read_b128 v[48:51], v240 offset:15360
  buffer_load_dwordx4 v[120:123], v255, s[8:11], s84 offen offset:1024 sc1
  buffer_load_dwordx4 v[124:127], v255, s[8:11], s84 offen offset:2048 sc1
  buffer_load_dwordx4 v[128:131], v255, s[8:11], s84 offen offset:3072 sc1
  s_add_u32 s84, s84, 4096
  v_mfma_f32_32x32x16_bf16 v[16:31], v[64:67], v[88:91], v[16:31]
  ds_read_b128 v[52:55], v240 offset:16384
  v_mfma_f32_32x32x16_bf16 v[32:47], v[68:71], v[88:91], v[32:47]
  ds_read_b128 v[56:59], v237 offset:15360
  s_barrier
  v_add_u32 v240, 57344, v242
  v_add_u32 v237, 57344, v238
  s_waitcnt vmcnt(9) lgkmcnt(3)
  v_mfma_f32_32x32x16_bf16 v[0:15], v[72:75], v[92:95], v[0:15]
  ds_read_b128 v[60:63], v240 offset:0
  buffer_load_dwordx4 v[132:135], v255, s[8:11], s84 offen offset:0 sc1
  buffer_load_dwordx4 v[136:139], v255, s[8:11], s84 offen offset:1024 sc1
  buffer_load_dwordx4 v[140:143], v255, s[8:11], s84 offen offset:2048 sc1
  v_mfma_f32_32x32x16_bf16 v[16:31], v[76:79], v[92:95], v[16:31]
  ds_read_b128 v[64:67], v240 offset:1024
  v_mfma_f32_32x32x16_bf16 v[32:47], v[80:83], v[92:95], v[32:47]
  ds_read_b128 v[68:71], v237 offset:0
  s_waitcnt vmcnt(11) lgkmcnt(3)
  v_mfma_f32_32x32x16_bf16 v[0:15], v[48:51], v[96:99], v[0:15]
  ds_read_b128 v[72:75], v240 offset:5120
  buffer_load_dwordx4 v[144:147], v255, s[8:11], s84 offen offset:3072 sc1
  s_add_u32 s84, s84, 4096
  buffer_load_dwordx4 v[148:151], v255, s[8:11], s84 offen offset:0 sc1
  buffer_load_dwordx4 v[152:155], v255, s[8:11], s84 offen offset:1024 sc1
  v_mfma_f32_32x32x16_bf16 v[16:31], v[52:55], v[96:99], v[16:31]
  ds_read_b128 v[76:79], v240 offset:6144
  v_mfma_f32_32x32x16_bf16 v[32:47], v[56:59], v[96:99], v[32:47]
  ds_read_b128 v[80:83], v237 offset:5120
  s_waitcnt vmcnt(13) lgkmcnt(3)
  v_mfma_f32_32x32x16_bf16 v[0:15], v[60:63], v[100:103], v[0:15]
  ds_read_b128 v[48:51], v240 offset:10240
  buffer_load_dwordx4 v[156:159], v255, s[8:11], s84 offen offset:2048 sc1
  buffer_load_dwordx4 v[160:163], v255, s[8:11], s84 offen offset:3072 sc1
  s_add_u32 s84, s84, 4096
  buffer_load_dwordx4 v[84:87], v255, s[8:11], s84 offen offset:0 sc1
  v_mfma_f32_32x32x16_bf16 v[16:31], v[64:67], v[100:103], v[16:31]
  ds_read_b128 v[52:55], v240 offset:11264
  v_mfma_f32_32x32x16_bf16 v[32:47], v[68:71], v[100:103], v[32:47]
  ds_read_b128 v[56:59], v237 offset:10240
  s_waitcnt vmcnt(15) lgkmcnt(3)
  v_mfma_f32_32x32x16_bf16 v[0:15], v[72:75], v[104:107], v[0:15]
  ds_read_b128 v[60:63], v240 offset:15360
  buffer_load_dwordx4 v[88:91], v255, s[8:11], s84 offen offset:1024 sc1
  buffer_load_dwordx4 v[92:95], v255, s[8:11], s84 offen offset:2048 sc1
  buffer_load_dwordx4 v[96:99], v255, s[8:11], s84 offen offset:3072 sc1
  s_add_u32 s84, s84, 4096
  v_mfma_f32_32x32x16_bf16 v[16:31], v[76:79], v[104:107], v[16:31]
  ds_read_b128 v[64:67], v240 offset:16384
  v_mfma_f32_32x32x16_bf16 v[32:47], v[80:83], v[104:107], v[32:47]
  ds_read_b128 v[68:71], v237 offset:15360
  s_barrier
  v_add_u32 v240, 0, v242
  v_add_u32 v237, 0, v238
  s_waitcnt vmcnt(17) lgkmcnt(3)
  v_mfma_f32_32x32x16_bf16 v[0:15], v[48:51], v[108:111], v[0:15]
  ds_read_b128 v[72:75], v240 offset:0
  buffer_load_dwordx4 v[100:103], v255, s[8:11], s84 offen offset:0 sc1
  buffer_load_dwordx4 v[104:107], v255, s[8:11], s84 offen offset:1024 sc1
  v_mfma_f32_32x32x16_bf16 v[16:31], v[52:55], v[108:111], v[16:31]
  ds_read_b128 v[76:79], v240 offset:1024
  v_mfma_f32_32x32x16_bf16 v[32:47], v[56:59], v[108:111], v[32:47]
  ds_read_b128 v[80:83], v237 offset:0
  s_waitcnt vmcnt(18) lgkmcnt(3)
  v_mfma_f32_32x32x16_bf16 v[0:15], v[60:63], v[112:115], v[0:15]
  ds_read_b128 v[48:51], v240 offset:5120
  buffer_load_dwordx4 v[108:111], v255, s[8:11], s84 offen offset:2048 sc1
  v_mfma_f32_32x32x16_bf16 v[16:31], v[64:67], v[112:115], v[16:31]
  ds_read_b128 v[52:55], v240 offset:6144
  v_mfma_f32_32x32x16_bf16 v[32:47], v[68:71], v[112:115], v[32:47]
  ds_read_b128 v[56:59], v237 offset:5120
  s_waitcnt vmcnt(18) lgkmcnt(3)
  v_mfma_f32_32x32x16_bf16 v[0:15], v[72:75], v[116:119], v[0:15]
  ds_read_b128 v[60:63], v240 offset:10240
  buffer_load_dwordx4 v[112:115], v255, s[8:11], s84 offen offset:3072 sc1
  s_add_u32 s84, s84, 4096
  v_mfma_f32_32x32x16_bf16 v[16:31], v[76:79], v[116:119], v[16:31]
  ds_read_b128 v[64:67], v240 offset:11264
  v_mfma_f32_32x32x16_bf16 v[32:47], v[80:83], v[116:119], v[32:47]
  ds_read_b128 v[68:71], v237 offset:10240
  s_waitcnt vmcnt(18) lgkmcnt(3)
  v_mfma_f32_32x32x16_bf16 v[0:15], v[48:51], v[120:123], v[0:15]
  ds_read_b128 v[72:75], v240 offset:15360
  buffer_load_dwordx4 v[116:119], v255, s[8:11], s84 offen offset:0 sc1
  v_mfma_f32_32x32x16_bf16 v[16:31], v[52:55], v[120:123], v[16:31]
  ds_read_b128 v[76:79], v240 offset:16384
  v_mfma_f32_32x32x16_bf16 v[32:47], v[56:59], v[120:123], v[32:47]
  ds_read_b128 v[80:83], v237 offset:15360
  s_barrier
  v_add_u32 v240, 77824, v242
  v_add_u32 v237, 77824, v238
  s_waitcnt vmcnt(18) lgkmcnt(3)
  v_mfma_f32_32x32x16_bf16 v[0:15], v[60:63], v[124:127], v[0:15]
  ds_read_b128 v[48:51], v240 offset:0
  buffer_load_dwordx4 v[120:123], v255, s[8:11], s84 offen offset:1024 sc1
  v_mfma_f32_32x32x16_bf16 v[16:31], v[64:67], v[124:127], v[16:31]
  ds_read_b128 v[52:55], v240 offset:1024
  v_mfma_f32_32x32x16_bf16 v[32:47], v[68:71], v[124:127], v[32:47]
  ds_read_b128 v[56:59], v237 offset:0
  s_waitcnt vmcnt(18) lgkmcnt(3)
  v_mfma_f32_32x32x16_bf16 v[0:15], v[72:75], v[128:131], v[0:15]
  ds_read_b128 v[60:63], v240 offset:5120
  buffer_load_dwordx4 v[124:127], v255, s[8:11], s84 offen offset:2048 sc1
  v_mfma_f32_32x32x16_bf16 v[16:31], v[76:79], v[128:131], v[16:31]
  ds_read_b128 v[64:67], v240 offset:6144
  v_mfma_f32_32x32x16_bf16 v[32:47], v[80:83], v[128:131], v[32:47]
  ds_read_b128 v[68:71], v237 offset:5120
  s_waitcnt vmcnt(18) lgkmcnt(3)
  v_mfma_f32_32x32x16_bf16 v[0:15], v[48:51], v[132:135], v[0:15]
  ds_read_b128 v[72:75], v240 offset:10240
  buffer_load_dwordx4 v[128:131], v255, s[8:11], s84 offen offset:3072 sc1
  s_add_u32 s84, s84, 4096
  v_mfma_f32_32x32x16_bf16 v[16:31], v[52:55], v[132:135], v[16:31]
  ds_read_b128 v[76:79], v240 offset:11264
  v_mfma_f32_32x32x16_bf16 v[32:47], v[56:59], v[132:135], v[32:47]
  ds_read_b128 v[80:83], v237 offset:10240
  s_waitcnt vmcnt(18) lgkmcnt(3)
  v_mfma_f32_32x32x16_bf16 v[0:15], v[60:63], v[136:139], v[0:15]
  ds_read_b128 v[48:51], v240 offset:15360
  buffer_load_dwordx4 v[132:135], v255, s[8:11], s84 offen offset:0 sc1
  v_mfma_f32_32x32x16_bf16 v[16:31], v[64:67], v[136:139], v[16:31]
  ds_read_b128 v[52:55], v240 offset:16384
  v_mfma_f32_32x32x16_bf16 v[32:47], v[68:71], v[136:139], v[32:47]
  ds_read_b128 v[56:59], v237 offset:15360
  s_barrier
  v_add_u32 v240, 20480, v242
  v_add_u32 v237, 20480, v238
  s_waitcnt vmcnt(18) lgkmcnt(3)
  v_mfma_f32_32x32x16_bf16 v[0:15], v[72:75], v[140:143], v[0:15]
  ds_read_b128 v[60:63], v240 offset:0
  buffer_load_dwordx4 v[136:139], v255, s[8:11], s84 offen offset:1024 sc1
  v_mfma_f32_32x32x16_bf16 v[16:31], v[76:79], v[140:143], v[16:31]
  ds_read_b128 v[64:67], v240 offset:1024
  v_mfma_f32_32x32x16_bf16 v[32:47], v[80:83], v[140:143], v[32:47]
  ds_read_b128 v[68:71], v237 offset:0
  s_waitcnt vmcnt(18) lgkmcnt(3)
  v_mfma_f32_32x32x16_bf16 v[0:15], v[48:51], v[144:147], v[0:15]
  ds_read_b128 v[72:75], v240 offset:5120
  buffer_load_dwordx4 v[140:143], v255, s[8:11], s84 offen offset:2048 sc1
  v_mfma_f32_32x32x16_bf16 v[16:31], v[52:55], v[144:147], v[16:31]
  ds_read_b128 v[76:79], v240 offset:6144
  v_mfma_f32_32x32x16_bf16 v[32:47], v[56:59], v[144:147], v[32:47]
  ds_read_b128 v[80:83], v237 offset:5120
  s_waitcnt vmcnt(18) lgkmcnt(3)
  v_mfma_f32_32x32x16_bf16 v[0:15], v[60:63], v[148:151], v[0:15]
  ds_read_b128 v[48:51], v240 offset:10240
  buffer_load_dwordx4 v[144:147], v255, s[8:11], s84 offen offset:3072 sc1
  s_add_u32 s84, s84, 4096
  v_mfma_f32_32x32x16_bf16 v[16:31], v[64:67], v[148:151], v[16:31]
  ds_read_b128 v[52:55], v240 offset:11264
  v_mfma_f32_32x32x16_bf16 v[32:47], v[68:71], v[148:151], v[32:47]
  ds_read_b128 v[56:59], v237 offset:10240
  s_waitcnt vmcnt(18) lgkmcnt(3)
  v_mfma_f32_32x32x16_bf16 v[0:15], v[72:75], v[152:155], v[0:15]
  ds_read_b128 v[60:63], v240 offset:15360
  buffer_load_dwordx4 v[148:151], v255, s[8:11], s84 offen offset:0 sc1
  v_mfma_f32_32x32x16_bf16 v[16:31], v[76:79], v[152:155], v[16:31]
  ds_read_b128 v[64:67], v240 offset:16384
  v_mfma_f32_32x32x16_bf16 v[32:47], v[80:83], v[152:155], v[32:47]
  ds_read_b128 v[68:71], v237 offset:15360
  s_barrier
  v_add_u32 v240, 98304, v242
  v_add_u32 v237, 98304, v238
  s_waitcnt vmcnt(18) lgkmcnt(3)
  v_mfma_f32_32x32x16_bf16 v[0:15], v[48:51], v[156:159], v[0:15]
  ds_read_b128 v[72:75], v240 offset:0
  buffer_load_dwordx4 v[152:155], v255, s[8:11], s84 offen offset:1024 sc1
  v_mfma_f32_32x32x16_bf16 v[16:31], v[52:55], v[156:159], v[16:31]
  ds_read_b128 v[76:79], v240 offset:1024
  v_mfma_f32_32x32x16_bf16 v[32:47], v[56:59], v[156:159], v[32:47]
  ds_read_b128 v[80:83], v237 offset:0
  s_waitcnt vmcnt(18) lgkmcnt(3)
  v_mfma_f32_32x32x16_bf16 v[0:15], v[60:63], v[160:163], v[0:15]
  ds_read_b128 v[48:51], v240 offset:5120
  buffer_load_dwordx4 v[156:159], v255, s[8:11], s84 offen offset:2048 sc1
  v_mfma_f32_32x32x16_bf16 v[16:31], v[64:67], v[160:163], v[16:31]
  ds_read_b128 v[52:55], v240 offset:6144
  v_mfma_f32_32x32x16_bf16 v[32:47], v[68:71], v[160:163], v[32:47]
  ds_read_b128 v[56:59], v237 offset:5120
  s_waitcnt vmcnt(18) lgkmcnt(3)
  v_mfma_f32_32x32x16_bf16 v[0:15], v[72:75], v[84:87], v[0:15]
  ds_read_b128 v[60:63], v240 offset:10240
  buffer_load_dwordx4 v[160:163], v255, s[8:11], s84 offen offset:3072 sc1
  s_add_u32 s84, s84, 4096
  v_mfma_f32_32x32x16_bf16 v[16:31], v[76:79], v[84:87], v[16:31]
  ds_read_b128 v[64:67], v240 offset:11264
  v_mfma_f32_32x32x16_bf16 v[32:47], v[80:83], v[84:87], v[32:47]
  ds_read_b128 v[68:71], v237 offset:10240
  s_waitcnt vmcnt(18) lgkmcnt(3)
  v_mfma_f32_32x32x16_bf16 v[0:15], v[48:51], v[88:91], v[0:15]
  ds_read_b128 v[72:75], v240 offset:15360
  buffer_load_dwordx4 v[84:87], v255, s[8:11], s84 offen offset:0 sc1
  v_mfma_f32_32x32x16_bf16 v[16:31], v[52:55], v[88:91], v[16:31]
  ds_read_b128 v[76:79], v240 offset:16384
  v_mfma_f32_32x32x16_bf16 v[32:47], v[56:59], v[88:91], v[32:47]
  ds_read_b128 v[80:83], v237 offset:15360
  s_barrier
  v_add_u32 v240, 118784, v242
  v_add_u32 v237, 118784, v238
  s_waitcnt vmcnt(18) lgkmcnt(3)
  v_mfma_f32_32x32x16_bf16 v[0:15], v[60:63], v[92:95], v[0:15]
  ds_read_b128 v[48:51], v240 offset:0
  buffer_load_dwordx4 v[88:91], v255, s[8:11], s84 offen offset:1024 sc1
  v_mfma_f32_32x32x16_bf16 v[16:31], v[64:67], v[92:95], v[16:31]
  ds_read_b128 v[52:55], v240 offset:1024
  v_mfma_f32_32x32x16_bf16 v[32:47], v[68:71], v[92:95], v[32:47]
  ds_read_b128 v[56:59], v237 offset:0
  s_waitcnt vmcnt(18) lgkmcnt(3)
  v_mfma_f32_32x32x16_bf16 v[0:15], v[72:75], v[96:99], v[0:15]
  ds_read_b128 v[60:63], v240 offset:5120
  buffer_load_dwordx4 v[92:95], v255, s[8:11], s84 offen offset:2048 sc1
  v_mfma_f32_32x32x16_bf16 v[16:31], v[76:79], v[96:99], v[16:31]
  ds_read_b128 v[64:67], v240 offset:6144
  v_mfma_f32_32x32x16_bf16 v[32:47], v[80:83], v[96:99], v[32:47]
  ds_read_b128 v[68:71], v237 offset:5120
  s_waitcnt vmcnt(18) lgkmcnt(3)
  v_mfma_f32_32x32x16_bf16 v[0:15], v[48:51], v[100:103], v[0:15]
  ds_read_b128 v[72:75], v240 offset:10240
  buffer_load_dwordx4 v[96:99], v255, s[8:11], s84 offen offset:3072 sc1
  s_add_u32 s84, s84, 4096
  v_mfma_f32_32x32x16_bf16 v[16:31], v[52:55], v[100:103], v[16:31]
  ds_read_b128 v[76:79], v240 offset:11264
  v_mfma_f32_32x32x16_bf16 v[32:47], v[56:59], v[100:103], v[32:47]
  ds_read_b128 v[80:83], v237 offset:10240
  s_waitcnt vmcnt(18) lgkmcnt(3)
  v_mfma_f32_32x32x16_bf16 v[0:15], v[60:63], v[104:107], v[0:15]
  ds_read_b128 v[48:51], v240 offset:15360
  buffer_load_dwordx4 v[100:103], v255, s[8:11], s84 offen offset:0 sc1
  v_mfma_f32_32x32x16_bf16 v[16:31], v[64:67], v[104:107], v[16:31]
  ds_read_b128 v[52:55], v240 offset:16384
  v_mfma_f32_32x32x16_bf16 v[32:47], v[68:71], v[104:107], v[32:47]
  ds_read_b128 v[56:59], v237 offset:15360
  s_barrier
  v_add_u32 v240, 40960, v242
  v_add_u32 v237, 40960, v238
  s_waitcnt vmcnt(18) lgkmcnt(3)
  v_mfma_f32_32x32x16_bf16 v[0:15], v[72:75], v[108:111], v[0:15]
  ds_read_b128 v[60:63], v240 offset:0
  buffer_load_dwordx4 v[104:107], v255, s[8:11], s84 offen offset:1024 sc1
  v_mfma_f32_32x32x16_bf16 v[16:31], v[76:79], v[108:111], v[16:31]
  ds_read_b128 v[64:67], v240 offset:1024
  v_mfma_f32_32x32x16_bf16 v[32:47], v[80:83], v[108:111], v[32:47]
  ds_read_b128 v[68:71], v237 offset:0
  s_waitcnt vmcnt(18) lgkmcnt(3)
  v_mfma_f32_32x32x16_bf16 v[0:15], v[48:51], v[112:115], v[0:15]
  ds_read_b128 v[72:75], v240 offset:5120
  buffer_load_dwordx4 v[108:111], v255, s[8:11], s84 offen offset:2048 sc1
  v_mfma_f32_32x32x16_bf16 v[16:31], v[52:55], v[112:115], v[16:31]
  ds_read_b128 v[76:79], v240 offset:6144
  v_mfma_f32_32x32x16_bf16 v[32:47], v[56:59], v[112:115], v[32:47]
  ds_read_b128 v[80:83], v237 offset:5120
  s_waitcnt vmcnt(18) lgkmcnt(3)
  v_mfma_f32_32x32x16_bf16 v[0:15], v[60:63], v[116:119], v[0:15]
  ds_read_b128 v[48:51], v240 offset:10240
  buffer_load_dwordx4 v[112:115], v255, s[8:11], s84 offen offset:3072 sc1
  s_add_u32 s84, s84, 4096
  v_mfma_f32_32x32x16_bf16 v[16:31], v[64:67], v[116:119], v[16:31]
  ds_read_b128 v[52:55], v240 offset:11264
  v_mfma_f32_32x32x16_bf16 v[32:47], v[68:71], v[116:119], v[32:47]
  ds_read_b128 v[56:59], v237 offset:10240
  s_waitcnt vmcnt(18) lgkmcnt(3)
  v_mfma_f32_32x32x16_bf16 v[0:15], v[72:75], v[120:123], v[0:15]
  ds_read_b128 v[60:63], v240 offset:15360
  buffer_load_dwordx4 v[116:119], v255, s[8:11], s84 offen offset:0 sc1
  v_mfma_f32_32x32x16_bf16 v[16:31], v[76:79], v[120:123], v[16:31]
  ds_read_b128 v[64:67], v240 offset:16384
  v_mfma_f32_32x32x16_bf16 v[32:47], v[80:83], v[120:123], v[32:47]
  ds_read_b128 v[68:71], v237 offset:15360
  s_barrier
  v_add_u32 v240, 0, v242
  v_add_u32 v237, 0, v238
  s_waitcnt vmcnt(18) lgkmcnt(3)
  v_mfma_f32_32x32x16_bf16 v[0:15], v[48:51], v[124:127], v[0:15]
  ds_read_b128 v[72:75], v240 offset:0
  buffer_load_dwordx4 v[120:123], v255, s[8:11], s84 offen offset:1024 sc1
  v_mfma_f32_32x32x16_bf16 v[16:31], v[52:55], v[124:127], v[16:31]
  ds_read_b128 v[76:79], v240 offset:1024
  v_mfma_f32_32x32x16_bf16 v[32:47], v[56:59], v[124:127], v[32:47]
  ds_read_b128 v[80:83], v237 offset:0
  s_waitcnt vmcnt(18) lgkmcnt(3)
  v_mfma_f32_32x32x16_bf16 v[0:15], v[60:63], v[128:131], v[0:15]
  ds_read_b128 v[48:51], v240 offset:5120
  buffer_load_dwordx4 v[124:127], v255, s[8:11], s84 offen offset:2048 sc1
  v_mfma_f32_32x32x16_bf16 v[16:31], v[64:67], v[128:131], v[16:31]
  ds_read_b128 v[52:55], v240 offset:6144
  v_mfma_f32_32x32x16_bf16 v[32:47], v[68:71], v[128:131], v[32:47]
  ds_read_b128 v[56:59], v237 offset:5120
  s_waitcnt vmcnt(18) lgkmcnt(3)
  v_mfma_f32_32x32x16_bf16 v[0:15], v[72:75], v[132:135], v[0:15]
  ds_read_b128 v[60:63], v240 offset:10240
  buffer_load_dwordx4 v[128:131], v255, s[8:11], s84 offen offset:3072 sc1
  s_add_u32 s84, s84, 4096
  v_mfma_f32_32x32x16_bf16 v[16:31], v[76:79], v[132:135], v[16:31]
  ds_read_b128 v[64:67], v240 offset:11264
  v_mfma_f32_32x32x16_bf16 v[32:47], v[80:83], v[132:135], v[32:47]
  ds_read_b128 v[68:71], v237 offset:10240
  s_waitcnt vmcnt(18) lgkmcnt(3)
  v_mfma_f32_32x32x16_bf16 v[0:15], v[48:51], v[136:139], v[0:15]
  ds_read_b128 v[72:75], v240 offset:15360
  buffer_load_dwordx4 v[132:135], v255, s[8:11], s84 offen offset:0 sc1
  v_mfma_f32_32x32x16_bf16 v[16:31], v[52:55], v[136:139], v[16:31]
  ds_read_b128 v[76:79], v240 offset:16384
  v_mfma_f32_32x32x16_bf16 v[32:47], v[56:59], v[136:139], v[32:47]
  ds_read_b128 v[80:83], v237 offset:15360
  s_barrier
  v_add_u32 v240, 61440, v242
  v_add_u32 v237, 61440, v238
  s_waitcnt vmcnt(18) lgkmcnt(3)
  v_mfma_f32_32x32x16_bf16 v[0:15], v[60:63], v[140:143], v[0:15]
  ds_read_b128 v[48:51], v240 offset:0
  buffer_load_dwordx4 v[136:139], v255, s[8:11], s84 offen offset:1024 sc1
  v_mfma_f32_32x32x16_bf16 v[16:31], v[64:67], v[140:143], v[16:31]
  ds_read_b128 v[52:55], v240 offset:1024
  v_mfma_f32_32x32x16_bf16 v[32:47], v[68:71], v[140:143], v[32:47]
  ds_read_b128 v[56:59], v237 offset:0
  s_waitcnt vmcnt(18) lgkmcnt(3)
  v_mfma_f32_32x32x16_bf16 v[0:15], v[72:75], v[144:147], v[0:15]
  ds_read_b128 v[60:63], v240 offset:5120
  v_mfma_f32_32x32x16_bf16 v[16:31], v[76:79], v[144:147], v[16:31]
  ds_read_b128 v[64:67], v240 offset:6144
  v_mfma_f32_32x32x16_bf16 v[32:47], v[80:83], v[144:147], v[32:47]
  ds_read_b128 v[68:71], v237 offset:5120
  s_waitcnt vmcnt(17) lgkmcnt(3)
  v_mfma_f32_32x32x16_bf16 v[0:15], v[48:51], v[148:151], v[0:15]
  ds_read_b128 v[72:75], v240 offset:10240
  v_mfma_f32_32x32x16_bf16 v[16:31], v[52:55], v[148:151], v[16:31]
  ds_read_b128 v[76:79], v240 offset:11264
  v_mfma_f32_32x32x16_bf16 v[32:47], v[56:59], v[148:151], v[32:47]
  ds_read_b128 v[80:83], v237 offset:10240
  s_waitcnt vmcnt(16) lgkmcnt(3)
  v_mfma_f32_32x32x16_bf16 v[0:15], v[60:63], v[152:155], v[0:15]
  ds_read_b128 v[48:51], v240 offset:15360
  v_mfma_f32_32x32x16_bf16 v[16:31], v[64:67], v[152:155], v[16:31]
  ds_read_b128 v[52:55], v240 offset:16384
  v_mfma_f32_32x32x16_bf16 v[32:47], v[68:71], v[152:155], v[32:47]
  ds_read_b128 v[56:59], v237 offset:15360
  s_barrier
  v_add_u32 v240, 20480, v242
  v_add_u32 v237, 20480, v238
  s_waitcnt vmcnt(15) lgkmcnt(3)
  v_mfma_f32_32x32x16_bf16 v[0:15], v[72:75], v[156:159], v[0:15]
  ds_read_b128 v[60:63], v240 offset:0
  v_mfma_f32_32x32x16_bf16 v[16:31], v[76:79], v[156:159], v[16:31]
  ds_read_b128 v[64:67], v240 offset:1024
  v_mfma_f32_32x32x16_bf16 v[32:47], v[80:83], v[156:159], v[32:47]
  ds_read_b128 v[68:71], v237 offset:0
  s_waitcnt vmcnt(14) lgkmcnt(3)
  v_mfma_f32_32x32x16_bf16 v[0:15], v[48:51], v[160:163], v[0:15]
  ds_read_b128 v[72:75], v240 offset:5120
  v_mfma_f32_32x32x16_bf16 v[16:31], v[52:55], v[160:163], v[16:31]
  ds_read_b128 v[76:79], v240 offset:6144
  v_mfma_f32_32x32x16_bf16 v[32:47], v[56:59], v[160:163], v[32:47]
  ds_read_b128 v[80:83], v237 offset:5120
  s_waitcnt vmcnt(13) lgkmcnt(3)
  v_mfma_f32_32x32x16_bf16 v[0:15], v[60:63], v[84:87], v[0:15]
  ds_read_b128 v[48:51], v240 offset:10240
  v_mfma_f32_32x32x16_bf16 v[16:31], v[64:67], v[84:87], v[16:31]
  ds_read_b128 v[52:55], v240 offset:11264
  v_mfma_f32_32x32x16_bf16 v[32:47], v[68:71], v[84:87], v[32:47]
  ds_read_b128 v[56:59], v237 offset:10240
  s_waitcnt vmcnt(12) lgkmcnt(3)
  v_mfma_f32_32x32x16_bf16 v[0:15], v[72:75], v[88:91], v[0:15]
  ds_read_b128 v[60:63], v240 offset:15360
  v_mfma_f32_32x32x16_bf16 v[16:31], v[76:79], v[88:91], v[16:31]
  ds_read_b128 v[64:67], v240 offset:16384
  v_mfma_f32_32x32x16_bf16 v[32:47], v[80:83], v[88:91], v[32:47]
  ds_read_b128 v[68:71], v237 offset:15360
  s_barrier
  v_add_u32 v240, 81920, v242
  v_add_u32 v237, 81920, v238
  s_waitcnt vmcnt(11) lgkmcnt(3)
  v_mfma_f32_32x32x16_bf16 v[0:15], v[48:51], v[92:95], v[0:15]
  ds_read_b128 v[72:75], v240 offset:0
  v_mfma_f32_32x32x16_bf16 v[16:31], v[52:55], v[92:95], v[16:31]
  ds_read_b128 v[76:79], v240 offset:1024
  v_mfma_f32_32x32x16_bf16 v[32:47], v[56:59], v[92:95], v[32:47]
  ds_read_b128 v[80:83], v237 offset:0
  s_waitcnt vmcnt(10) lgkmcnt(3)
  v_mfma_f32_32x32x16_bf16 v[0:15], v[60:63], v[96:99], v[0:15]
  ds_read_b128 v[48:51], v240 offset:5120
  v_mfma_f32_32x32x16_bf16 v[16:31], v[64:67], v[96:99], v[16:31]
  ds_read_b128 v[52:55], v240 offset:6144
  v_mfma_f32_32x32x16_bf16 v[32:47], v[68:71], v[96:99], v[32:47]
  ds_read_b128 v[56:59], v237 offset:5120
  s_waitcnt vmcnt(9) lgkmcnt(3)
  v_mfma_f32_32x32x16_bf16 v[0:15], v[72:75], v[100:103], v[0:15]
  ds_read_b128 v[60:63], v240 offset:10240
  v_mfma_f32_32x32x16_bf16 v[16:31], v[76:79], v[100:103], v[16:31]
  ds_read_b128 v[64:67], v240 offset:11264
  v_mfma_f32_32x32x16_bf16 v[32:47], v[80:83], v[100:103], v[32:47]
  ds_read_b128 v[68:71], v237 offset:10240
  s_waitcnt vmcnt(8) lgkmcnt(3)
  v_mfma_f32_32x32x16_bf16 v[0:15], v[48:51], v[104:107], v[0:15]
  ds_read_b128 v[72:75], v240 offset:15360
  v_mfma_f32_32x32x16_bf16 v[16:31], v[52:55], v[104:107], v[16:31]
  ds_read_b128 v[76:79], v240 offset:16384
  v_mfma_f32_32x32x16_bf16 v[32:47], v[56:59], v[104:107], v[32:47]
  ds_read_b128 v[80:83], v237 offset:15360
  s_barrier
  v_add_u32 v240, 102400, v242
  v_add_u32 v237, 102400, v238
  s_waitcnt vmcnt(7) lgkmcnt(3)
  v_mfma_f32_32x32x16_bf16 v[0:15], v[60:63], v[108:111], v[0:15]
  ds_read_b128 v[48:51], v240 offset:0
  v_mfma_f32_32x32x16_bf16 v[16:31], v[64:67], v[108:111], v[16:31]
  ds_read_b128 v[52:55], v240 offset:1024
  v_mfma_f32_32x32x16_bf16 v[32:47], v[68:71], v[108:111], v[32:47]
  ds_read_b128 v[56:59], v237 offset:0
  buffer_load_dwordx4 v[164:167], v255, s[8:11], s86 offen sc1
  s_add_u32 s86, s86, 1024
  buffer_load_dwordx4 v[168:171], v255, s[8:11], s86 offen sc1
  s_cmp_eq_u32 s93, 0
  s_cselect_b32 s78, 1024, 0
  s_add_u32 s86, s86, s78
  buffer_load_dwordx4 v[172:175], v255, s[8:11], s86 offen sc1
  s_waitcnt vmcnt(9) lgkmcnt(3)
  v_mfma_f32_32x32x16_bf16 v[0:15], v[72:75], v[112:115], v[0:15]
  ds_read_b128 v[60:63], v240 offset:5120
  v_mfma_f32_32x32x16_bf16 v[16:31], v[76:79], v[112:115], v[16:31]
  ds_read_b128 v[64:67], v240 offset:6144
  v_mfma_f32_32x32x16_bf16 v[32:47], v[80:83], v[112:115], v[32:47]
  ds_read_b128 v[68:71], v237 offset:5120
  s_waitcnt vmcnt(8) lgkmcnt(3)
  v_mfma_f32_32x32x16_bf16 v[0:15], v[48:51], v[116:119], v[0:15]
  ds_read_b128 v[72:75], v240 offset:10240
  v_mfma_f32_32x32x16_bf16 v[16:31], v[52:55], v[116:119], v[16:31]
  ds_read_b128 v[76:79], v240 offset:11264
  v_mfma_f32_32x32x16_bf16 v[32:47], v[56:59], v[116:119], v[32:47]
  ds_read_b128 v[80:83], v237 offset:10240
  s_waitcnt vmcnt(7) lgkmcnt(3)
  v_mfma_f32_32x32x16_bf16 v[0:15], v[60:63], v[120:123], v[0:15]
  ds_read_b128 v[48:51], v240 offset:15360
  v_mfma_f32_32x32x16_bf16 v[16:31], v[64:67], v[120:123], v[16:31]
  ds_read_b128 v[52:55], v240 offset:16384
  v_mfma_f32_32x32x16_bf16 v[32:47], v[68:71], v[120:123], v[32:47]
  ds_read_b128 v[56:59], v237 offset:15360
  s_barrier
  v_add_u32 v240, 40960, v242
  v_add_u32 v237, 40960, v238
  s_waitcnt vmcnt(6) lgkmcnt(3)
  v_mfma_f32_32x32x16_bf16 v[0:15], v[72:75], v[124:127], v[0:15]
  ds_read_b128 v[60:63], v240 offset:0
  v_mfma_f32_32x32x16_bf16 v[16:31], v[76:79], v[124:127], v[16:31]
  ds_read_b128 v[64:67], v240 offset:1024
  v_mfma_f32_32x32x16_bf16 v[32:47], v[80:83], v[124:127], v[32:47]
  ds_read_b128 v[68:71], v237 offset:0
  s_waitcnt vmcnt(5) lgkmcnt(3)
  v_mfma_f32_32x32x16_bf16 v[0:15], v[48:51], v[128:131], v[0:15]
  ds_read_b128 v[72:75], v240 offset:5120
  v_mfma_f32_32x32x16_bf16 v[16:31], v[52:55], v[128:131], v[16:31]
  ds_read_b128 v[76:79], v240 offset:6144
  v_mfma_f32_32x32x16_bf16 v[32:47], v[56:59], v[128:131], v[32:47]
  ds_read_b128 v[80:83], v237 offset:5120
  s_barrier
  s_waitcnt vmcnt(4) lgkmcnt(3)
  v_mfma_f32_32x32x16_bf16 v[0:15], v[60:63], v[132:135], v[0:15]
  v_mfma_f32_32x32x16_bf16 v[16:31], v[64:67], v[132:135], v[16:31]
  v_mfma_f32_32x32x16_bf16 v[32:47], v[68:71], v[132:135], v[32:47]
  s_waitcnt vmcnt(3) lgkmcnt(0)
  v_mfma_f32_32x32x16_bf16 v[0:15], v[72:75], v[136:139], v[0:15]
  v_mfma_f32_32x32x16_bf16 v[16:31], v[76:79], v[136:139], v[16:31]
  v_mfma_f32_32x32x16_bf16 v[32:47], v[80:83], v[136:139], v[32:47]
  s_mul_i32 s78, s92, 10240
  s_add_u32 s78, s78, 94208
  v_add_u32 v243, s78, v255
  s_cmp_eq_u32 s93, 0
  s_cbranch_scc0 L_kh1_64
  s_nop 7
  ds_write_b128 v243, v[24:27] offset:6144
  ds_write_b128 v243, v[28:31] offset:7168
  ds_write_b128 v243, v[32:35] offset:8192
  ds_write_b128 v243, v[36:39] offset:9216
  s_branch L_khj_65
L_kh1_64:
  s_nop 7
  ds_write_b128 v243, v[0:3] offset:0
  ds_write_b128 v243, v[4:7] offset:1024
  ds_write_b128 v243, v[8:11] offset:2048
  ds_write_b128 v243, v[12:15] offset:3072
  ds_write_b128 v243, v[16:19] offset:4096
  ds_write_b128 v243, v[20:23] offset:5120
L_khj_65:
  s_waitcnt lgkmcnt(0)
  s_barrier
  v_mov_b32 v204, 0
  v_mov_b32 v205, 0
  s_add_u32 s78, s88, s89
  s_add_u32 s79, s78, s89
  s_cmp_eq_u32 s7, 0
  s_cbranch_scc1 L_eslow_66
  s_cmp_eq_u32 s93, 0
  s_cbranch_scc0 L_kh1_68
  ds_read_b128 v[176:179], v243 offset:0
  ds_read_b128 v[180:183], v243 offset:1024
  ds_read_b128 v[184:187], v243 offset:2048
  ds_read_b128 v[188:191], v243 offset:3072
  ds_read_b128 v[192:195], v243 offset:4096
  ds_read_b128 v[196:199], v243 offset:5120
  s_waitcnt vmcnt(0)
  s_waitcnt lgkmcnt(4)
  v_pk_add_f32 v[0:1], v[0:1], v[176:177]
  v_pk_add_f32 v[2:3], v[2:3], v[178:179]
  v_pk_add_f32 v[4:5], v[4:5], v[180:181]
  v_pk_add_f32 v[6:7], v[6:7], v[182:183]
  v_lshlrev_b32 v176, 16, v164
  v_and_b32 v177, 0xffff0000, v164
  v_lshlrev_b32 v178, 16, v165
  v_and_b32 v179, 0xffff0000, v165
  v_lshlrev_b32 v180, 16, v166
  v_and_b32 v181, 0xffff0000, v166
  v_lshlrev_b32 v182, 16, v167
  v_and_b32 v183, 0xffff0000, v167
  v_permlane32_swap_b32 v0, v4
  v_permlane32_swap_b32 v1, v5
  v_permlane32_swap_b32 v2, v6
  v_permlane32_swap_b32 v3, v7
  v_pk_add_f32 v[0:1], v[0:1], v[176:177]
  v_pk_add_f32 v[2:3], v[2:3], v[178:179]
  v_pk_add_f32 v[4:5], v[4:5], v[180:181]
  v_pk_add_f32 v[6:7], v[6:7], v[182:183]
  v_cvt_pk_bf16_f32 v164, v0, v1
  v_cvt_pk_bf16_f32 v165, v2, v3
  v_cvt_pk_bf16_f32 v166, v4, v5
  v_cvt_pk_bf16_f32 v167, v6, v7
  buffer_store_dwordx4 v[164:167], v239, s[20:23], s88 offen
  v_pk_mul_f32 v[202:203], v[0:1], v[0:1]
  v_pk_add_f32 v[200:201], v[0:1], v[204:205]
  v_pk_fma_f32 v[202:203], v[2:3], v[2:3], v[202:203]
  v_pk_add_f32 v[200:201], v[2:3], v[200:201]
  v_pk_fma_f32 v[202:203], v[4:5], v[4:5], v[202:203]
  v_pk_add_f32 v[200:201], v[4:5], v[200:201]
  v_pk_fma_f32 v[202:203], v[6:7], v[6:7], v[202:203]
  v_pk_add_f32 v[200:201], v[6:7], v[200:201]
  s_waitcnt lgkmcnt(2)
  v_pk_add_f32 v[8:9], v[8:9], v[184:185]
  v_pk_add_f32 v[10:11], v[10:11], v[186:187]
  v_pk_add_f32 v[12:13], v[12:13], v[188:189]
  v_pk_add_f32 v[14:15], v[14:15], v[190:191]
  v_lshlrev_b32 v184, 16, v168
  v_and_b32 v185, 0xffff0000, v168
  v_lshlrev_b32 v186, 16, v169
  v_and_b32 v187, 0xffff0000, v169
  v_lshlrev_b32 v188, 16, v170
  v_and_b32 v189, 0xffff0000, v170
  v_lshlrev_b32 v190, 16, v171
  v_and_b32 v191, 0xffff0000, v171
  v_permlane32_swap_b32 v8, v12
  v_permlane32_swap_b32 v9, v13
  v_permlane32_swap_b32 v10, v14
  v_permlane32_swap_b32 v11, v15
  v_pk_add_f32 v[8:9], v[8:9], v[184:185]
  v_pk_add_f32 v[10:11], v[10:11], v[186:187]
  v_pk_add_f32 v[12:13], v[12:13], v[188:189]
  v_pk_add_f32 v[14:15], v[14:15], v[190:191]
  v_cvt_pk_bf16_f32 v168, v8, v9
  v_cvt_pk_bf16_f32 v169, v10, v11
  v_cvt_pk_bf16_f32 v170, v12, v13
  v_cvt_pk_bf16_f32 v171, v14, v15
  buffer_store_dwordx4 v[168:171], v239, s[20:23], s78 offen
  v_pk_fma_f32 v[202:203], v[8:9], v[8:9], v[202:203]
  v_pk_add_f32 v[200:201], v[8:9], v[200:201]
  v_pk_fma_f32 v[202:203], v[10:11], v[10:11], v[202:203]
  v_pk_add_f32 v[200:201], v[10:11], v[200:201]
  v_pk_fma_f32 v[202:203], v[12:13], v[12:13], v[202:203]
  v_pk_add_f32 v[200:201], v[12:13], v[200:201]
  v_pk_fma_f32 v[202:203], v[14:15], v[14:15], v[202:203]
  v_pk_add_f32 v[200:201], v[14:15], v[200:201]
  s_waitcnt lgkmcnt(0)
  v_pk_add_f32 v[16:17], v[16:17], v[192:193]
  v_pk_add_f32 v[18:19], v[18:19], v[194:195]
  v_pk_add_f32 v[20:21], v[20:21], v[196:197]
  v_pk_add_f32 v[22:23], v[22:23], v[198:199]
  v_lshlrev_b32 v192, 16, v172
  v_and_b32 v193, 0xffff0000, v172
  v_lshlrev_b32 v194, 16, v173
  v_and_b32 v195, 0xffff0000, v173
  v_lshlrev_b32 v196, 16, v174
  v_and_b32 v197, 0xffff0000, v174
  v_lshlrev_b32 v198, 16, v175
  v_and_b32 v199, 0xffff0000, v175
  v_permlane32_swap_b32 v16, v20
  v_permlane32_swap_b32 v17, v21
  v_permlane32_swap_b32 v18, v22
  v_permlane32_swap_b32 v19, v23
  v_pk_add_f32 v[16:17], v[16:17], v[192:193]
  v_pk_add_f32 v[18:19], v[18:19], v[194:195]
  v_pk_add_f32 v[20:21], v[20:21], v[196:197]
  v_pk_add_f32 v[22:23], v[22:23], v[198:199]
  v_cvt_pk_bf16_f32 v172, v16, v17
  v_cvt_pk_bf16_f32 v173, v18, v19
  v_cvt_pk_bf16_f32 v174, v20, v21
  v_cvt_pk_bf16_f32 v175, v22, v23
  buffer_store_dwordx4 v[172:175], v239, s[20:23], s79 offen
  v_pk_fma_f32 v[202:203], v[16:17], v[16:17], v[202:203]
  v_pk_add_f32 v[200:201], v[16:17], v[200:201]
  v_pk_fma_f32 v[202:203], v[18:19], v[18:19], v[202:203]
  v_pk_add_f32 v[200:201], v[18:19], v[200:201]
  v_pk_fma_f32 v[202:203], v[20:21], v[20:21], v[202:203]
  v_pk_add_f32 v[200:201], v[20:21], v[200:201]
  v_pk_fma_f32 v[202:203], v[22:23], v[22:23], v[202:203]
  v_pk_add_f32 v[200:201], v[22:23], v[200:201]
  s_branch L_khj_69
L_kh1_68:
  ds_read_b128 v[176:179], v243 offset:6144
  ds_read_b128 v[180:183], v243 offset:7168
  ds_read_b128 v[184:187], v243 offset:8192
  ds_read_b128 v[188:191], v243 offset:9216
  s_waitcnt vmcnt(0)
  s_waitcnt lgkmcnt(2)
  v_pk_add_f32 v[24:25], v[24:25], v[176:177]
  v_pk_add_f32 v[26:27], v[26:27], v[178:179]
  v_pk_add_f32 v[28:29], v[28:29], v[180:181]
  v_pk_add_f32 v[30:31], v[30:31], v[182:183]
  v_lshlrev_b32 v176, 16, v164
  v_and_b32 v177, 0xffff0000, v164
  v_lshlrev_b32 v178, 16, v165
  v_and_b32 v179, 0xffff0000, v165
  v_lshlrev_b32 v180, 16, v166
  v_and_b32 v181, 0xffff0000, v166
  v_lshlrev_b32 v182, 16, v167
  v_and_b32 v183, 0xffff0000, v167
  v_permlane32_swap_b32 v24, v28
  v_permlane32_swap_b32 v25, v29
  v_permlane32_swap_b32 v26, v30
  v_permlane32_swap_b32 v27, v31
  v_pk_add_f32 v[24:25], v[24:25], v[176:177]
  v_pk_add_f32 v[26:27], v[26:27], v[178:179]
  v_pk_add_f32 v[28:29], v[28:29], v[180:181]
  v_pk_add_f32 v[30:31], v[30:31], v[182:183]
  v_cvt_pk_bf16_f32 v164, v24, v25
  v_cvt_pk_bf16_f32 v165, v26, v27
  v_cvt_pk_bf16_f32 v166, v28, v29
  v_cvt_pk_bf16_f32 v167, v30, v31
  buffer_store_dwordx4 v[164:167], v239, s[20:23], s88 offen
  v_pk_mul_f32 v[202:203], v[24:25], v[24:25]
  v_pk_add_f32 v[200:201], v[24:25], v[204:205]
  v_pk_fma_f32 v[202:203], v[26:27], v[26:27], v[202:203]
  v_pk_add_f32 v[200:201], v[26:27], v[200:201]
  v_pk_fma_f32 v[202:203], v[28:29], v[28:29], v[202:203]
  v_pk_add_f32 v[200:201], v[28:29], v[200:201]
  v_pk_fma_f32 v[202:203], v[30:31], v[30:31], v[202:203]
  v_pk_add_f32 v[200:201], v[30:31], v[200:201]
  s_waitcnt lgkmcnt(0)
  v_pk_add_f32 v[32:33], v[32:33], v[184:185]
  v_pk_add_f32 v[34:35], v[34:35], v[186:187]
  v_pk_add_f32 v[36:37], v[36:37], v[188:189]
  v_pk_add_f32 v[38:39], v[38:39], v[190:191]
  v_lshlrev_b32 v184, 16, v168
  v_and_b32 v185, 0xffff0000, v168
  v_lshlrev_b32 v186, 16, v169
  v_and_b32 v187, 0xffff0000, v169
  v_lshlrev_b32 v188, 16, v170
  v_and_b32 v189, 0xffff0000, v170
  v_lshlrev_b32 v190, 16, v171
  v_and_b32 v191, 0xffff0000, v171
  v_permlane32_swap_b32 v32, v36
  v_permlane32_swap_b32 v33, v37
  v_permlane32_swap_b32 v34, v38
  v_permlane32_swap_b32 v35, v39
  v_pk_add_f32 v[32:33], v[32:33], v[184:185]
  v_pk_add_f32 v[34:35], v[34:35], v[186:187]
  v_pk_add_f32 v[36:37], v[36:37], v[188:189]
  v_pk_add_f32 v[38:39], v[38:39], v[190:191]
  v_cvt_pk_bf16_f32 v168, v32, v33
  v_cvt_pk_bf16_f32 v169, v34, v35
  v_cvt_pk_bf16_f32 v170, v36, v37
  v_cvt_pk_bf16_f32 v171, v38, v39
  buffer_store_dwordx4 v[168:171], v239, s[20:23], s78 offen
  v_pk_fma_f32 v[202:203], v[32:33], v[32:33], v[202:203]
  v_pk_add_f32 v[200:201], v[32:33], v[200:201]
  v_pk_fma_f32 v[202:203], v[34:35], v[34:35], v[202:203]
  v_pk_add_f32 v[200:201], v[34:35], v[200:201]
  v_pk_fma_f32 v[202:203], v[36:37], v[36:37], v[202:203]
  v_pk_add_f32 v[200:201], v[36:37], v[200:201]
  v_pk_fma_f32 v[202:203], v[38:39], v[38:39], v[202:203]
  v_pk_add_f32 v[200:201], v[38:39], v[200:201]
L_khj_69:
  s_branch L_ejoin_67
L_eslow_66:
  s_cmp_eq_u32 s93, 0
  s_cbranch_scc0 L_kh1_70
  ds_read_b128 v[176:179], v243 offset:0
  ds_read_b128 v[180:183], v243 offset:1024
  ds_read_b128 v[184:187], v243 offset:2048
  ds_read_b128 v[188:191], v243 offset:3072
  ds_read_b128 v[192:195], v243 offset:4096
  ds_read_b128 v[196:199], v243 offset:5120
  s_waitcnt vmcnt(0)
  s_waitcnt lgkmcnt(4)
  v_pk_add_f32 v[0:1], v[0:1], v[176:177]
  v_pk_add_f32 v[2:3], v[2:3], v[178:179]
  v_pk_add_f32 v[4:5], v[4:5], v[180:181]
  v_pk_add_f32 v[6:7], v[6:7], v[182:183]
  v_lshlrev_b32 v176, 16, v164
  v_and_b32 v177, 0xffff0000, v164
  v_lshlrev_b32 v178, 16, v165
  v_and_b32 v179, 0xffff0000, v165
  v_lshlrev_b32 v180, 16, v166
  v_and_b32 v181, 0xffff0000, v166
  v_lshlrev_b32 v182, 16, v167
  v_and_b32 v183, 0xffff0000, v167
  v_permlane32_swap_b32 v0, v4
  v_permlane32_swap_b32 v1, v5
  v_permlane32_swap_b32 v2, v6
  v_permlane32_swap_b32 v3, v7
  v_pk_add_f32 v[0:1], v[0:1], v[176:177]
  v_pk_add_f32 v[2:3], v[2:3], v[178:179]
  v_pk_add_f32 v[4:5], v[4:5], v[180:181]
  v_pk_add_f32 v[6:7], v[6:7], v[182:183]
  v_cvt_pk_bf16_f32 v164, v0, v1
  v_cvt_pk_bf16_f32 v165, v2, v3
  v_cvt_pk_bf16_f32 v166, v4, v5
  v_cvt_pk_bf16_f32 v167, v6, v7
  buffer_store_dwordx4 v[164:167], v239, s[20:23], s88 offen sc1
  v_pk_mul_f32 v[202:203], v[0:1], v[0:1]
  v_pk_add_f32 v[200:201], v[0:1], v[204:205]
  v_pk_fma_f32 v[202:203], v[2:3], v[2:3], v[202:203]
  v_pk_add_f32 v[200:201], v[2:3], v[200:201]
  v_pk_fma_f32 v[202:203], v[4:5], v[4:5], v[202:203]
  v_pk_add_f32 v[200:201], v[4:5], v[200:201]
  v_pk_fma_f32 v[202:203], v[6:7], v[6:7], v[202:203]
  v_pk_add_f32 v[200:201], v[6:7], v[200:201]
  s_waitcnt lgkmcnt(2)
  v_pk_add_f32 v[8:9], v[8:9], v[184:185]
  v_pk_add_f32 v[10:11], v[10:11], v[186:187]
  v_pk_add_f32 v[12:13], v[12:13], v[188:189]
  v_pk_add_f32 v[14:15], v[14:15], v[190:191]
  v_lshlrev_b32 v184, 16, v168
  v_and_b32 v185, 0xffff0000, v168
  v_lshlrev_b32 v186, 16, v169
  v_and_b32 v187, 0xffff0000, v169
  v_lshlrev_b32 v188, 16, v170
  v_and_b32 v189, 0xffff0000, v170
  v_lshlrev_b32 v190, 16, v171
  v_and_b32 v191, 0xffff0000, v171
  v_permlane32_swap_b32 v8, v12
  v_permlane32_swap_b32 v9, v13
  v_permlane32_swap_b32 v10, v14
  v_permlane32_swap_b32 v11, v15
  v_pk_add_f32 v[8:9], v[8:9], v[184:185]
  v_pk_add_f32 v[10:11], v[10:11], v[186:187]
  v_pk_add_f32 v[12:13], v[12:13], v[188:189]
  v_pk_add_f32 v[14:15], v[14:15], v[190:191]
  v_cvt_pk_bf16_f32 v168, v8, v9
  v_cvt_pk_bf16_f32 v169, v10, v11
  v_cvt_pk_bf16_f32 v170, v12, v13
  v_cvt_pk_bf16_f32 v171, v14, v15
  buffer_store_dwordx4 v[168:171], v239, s[20:23], s78 offen sc1
  v_pk_fma_f32 v[202:203], v[8:9], v[8:9], v[202:203]
  v_pk_add_f32 v[200:201], v[8:9], v[200:201]
  v_pk_fma_f32 v[202:203], v[10:11], v[10:11], v[202:203]
  v_pk_add_f32 v[200:201], v[10:11], v[200:201]
  v_pk_fma_f32 v[202:203], v[12:13], v[12:13], v[202:203]
  v_pk_add_f32 v[200:201], v[12:13], v[200:201]
  v_pk_fma_f32 v[202:203], v[14:15], v[14:15], v[202:203]
  v_pk_add_f32 v[200:201], v[14:15], v[200:201]
  s_waitcnt lgkmcnt(0)
  v_pk_add_f32 v[16:17], v[16:17], v[192:193]
  v_pk_add_f32 v[18:19], v[18:19], v[194:195]
  v_pk_add_f32 v[20:21], v[20:21], v[196:197]
  v_pk_add_f32 v[22:23], v[22:23], v[198:199]
  v_lshlrev_b32 v192, 16, v172
  v_and_b32 v193, 0xffff0000, v172
  v_lshlrev_b32 v194, 16, v173
  v_and_b32 v195, 0xffff0000, v173
  v_lshlrev_b32 v196, 16, v174
  v_and_b32 v197, 0xffff0000, v174
  v_lshlrev_b32 v198, 16, v175
  v_and_b32 v199, 0xffff0000, v175
  v_permlane32_swap_b32 v16, v20
  v_permlane32_swap_b32 v17, v21
  v_permlane32_swap_b32 v18, v22
  v_permlane32_swap_b32 v19, v23
  v_pk_add_f32 v[16:17], v[16:17], v[192:193]
  v_pk_add_f32 v[18:19], v[18:19], v[194:195]
  v_pk_add_f32 v[20:21], v[20:21], v[196:197]
  v_pk_add_f32 v[22:23], v[22:23], v[198:199]
  v_cvt_pk_bf16_f32 v172, v16, v17
  v_cvt_pk_bf16_f32 v173, v18, v19
  v_cvt_pk_bf16_f32 v174, v20, v21
  v_cvt_pk_bf16_f32 v175, v22, v23
  buffer_store_dwordx4 v[172:175], v239, s[20:23], s79 offen sc1
  v_pk_fma_f32 v[202:203], v[16:17], v[16:17], v[202:203]
  v_pk_add_f32 v[200:201], v[16:17], v[200:201]
  v_pk_fma_f32 v[202:203], v[18:19], v[18:19], v[202:203]
  v_pk_add_f32 v[200:201], v[18:19], v[200:201]
  v_pk_fma_f32 v[202:203], v[20:21], v[20:21], v[202:203]
  v_pk_add_f32 v[200:201], v[20:21], v[200:201]
  v_pk_fma_f32 v[202:203], v[22:23], v[22:23], v[202:203]
  v_pk_add_f32 v[200:201], v[22:23], v[200:201]
  s_branch L_khj_71
L_kh1_70:
  ds_read_b128 v[176:179], v243 offset:6144
  ds_read_b128 v[180:183], v243 offset:7168
  ds_read_b128 v[184:187], v243 offset:8192
  ds_read_b128 v[188:191], v243 offset:9216
  s_waitcnt vmcnt(0)
  s_waitcnt lgkmcnt(2)
  v_pk_add_f32 v[24:25], v[24:25], v[176:177]
  v_pk_add_f32 v[26:27], v[26:27], v[178:179]
  v_pk_add_f32 v[28:29], v[28:29], v[180:181]
  v_pk_add_f32 v[30:31], v[30:31], v[182:183]
  v_lshlrev_b32 v176, 16, v164
  v_and_b32 v177, 0xffff0000, v164
  v_lshlrev_b32 v178, 16, v165
  v_and_b32 v179, 0xffff0000, v165
  v_lshlrev_b32 v180, 16, v166
  v_and_b32 v181, 0xffff0000, v166
  v_lshlrev_b32 v182, 16, v167
  v_and_b32 v183, 0xffff0000, v167
  v_permlane32_swap_b32 v24, v28
  v_permlane32_swap_b32 v25, v29
  v_permlane32_swap_b32 v26, v30
  v_permlane32_swap_b32 v27, v31
  v_pk_add_f32 v[24:25], v[24:25], v[176:177]
  v_pk_add_f32 v[26:27], v[26:27], v[178:179]
  v_pk_add_f32 v[28:29], v[28:29], v[180:181]
  v_pk_add_f32 v[30:31], v[30:31], v[182:183]
  v_cvt_pk_bf16_f32 v164, v24, v25
  v_cvt_pk_bf16_f32 v165, v26, v27
  v_cvt_pk_bf16_f32 v166, v28, v29
  v_cvt_pk_bf16_f32 v167, v30, v31
  buffer_store_dwordx4 v[164:167], v239, s[20:23], s88 offen sc1
  v_pk_mul_f32 v[202:203], v[24:25], v[24:25]
  v_pk_add_f32 v[200:201], v[24:25], v[204:205]
  v_pk_fma_f32 v[202:203], v[26:27], v[26:27], v[202:203]
  v_pk_add_f32 v[200:201], v[26:27], v[200:201]
  v_pk_fma_f32 v[202:203], v[28:29], v[28:29], v[202:203]
  v_pk_add_f32 v[200:201], v[28:29], v[200:201]
  v_pk_fma_f32 v[202:203], v[30:31], v[30:31], v[202:203]
  v_pk_add_f32 v[200:201], v[30:31], v[200:201]
  s_waitcnt lgkmcnt(0)
  v_pk_add_f32 v[32:33], v[32:33], v[184:185]
  v_pk_add_f32 v[34:35], v[34:35], v[186:187]
  v_pk_add_f32 v[36:37], v[36:37], v[188:189]
  v_pk_add_f32 v[38:39], v[38:39], v[190:191]
  v_lshlrev_b32 v184, 16, v168
  v_and_b32 v185, 0xffff0000, v168
  v_lshlrev_b32 v186, 16, v169
  v_and_b32 v187, 0xffff0000, v169
  v_lshlrev_b32 v188, 16, v170
  v_and_b32 v189, 0xffff0000, v170
  v_lshlrev_b32 v190, 16, v171
  v_and_b32 v191, 0xffff0000, v171
  v_permlane32_swap_b32 v32, v36
  v_permlane32_swap_b32 v33, v37
  v_permlane32_swap_b32 v34, v38
  v_permlane32_swap_b32 v35, v39
  v_pk_add_f32 v[32:33], v[32:33], v[184:185]
  v_pk_add_f32 v[34:35], v[34:35], v[186:187]
  v_pk_add_f32 v[36:37], v[36:37], v[188:189]
  v_pk_add_f32 v[38:39], v[38:39], v[190:191]
  v_cvt_pk_bf16_f32 v168, v32, v33
  v_cvt_pk_bf16_f32 v169, v34, v35
  v_cvt_pk_bf16_f32 v170, v36, v37
  v_cvt_pk_bf16_f32 v171, v38, v39
  buffer_store_dwordx4 v[168:171], v239, s[20:23], s78 offen sc1
  v_pk_fma_f32 v[202:203], v[32:33], v[32:33], v[202:203]
  v_pk_add_f32 v[200:201], v[32:33], v[200:201]
  v_pk_fma_f32 v[202:203], v[34:35], v[34:35], v[202:203]
  v_pk_add_f32 v[200:201], v[34:35], v[200:201]
  v_pk_fma_f32 v[202:203], v[36:37], v[36:37], v[202:203]
  v_pk_add_f32 v[200:201], v[36:37], v[200:201]
  v_pk_fma_f32 v[202:203], v[38:39], v[38:39], v[202:203]
  v_pk_add_f32 v[200:201], v[38:39], v[200:201]
L_khj_71:
L_ejoin_67:
  v_add_f32 v200, v200, v201
  v_add_f32 v201, v202, v203
  v_mov_b32 v202, v200
  v_mov_b32 v203, v201
  s_nop 0
  v_permlane32_swap_b32 v200, v202
  v_permlane32_swap_b32 v201, v203
  v_add_f32 v200, v200, v202
  v_add_f32 v201, v201, v203
  v_and_b32 v244, 31, v254
  v_lshlrev_b32 v244, 4, v244
  s_mov_b32 exec_hi, 0
  s_cmp_eq_u32 s7, 0
  s_cbranch_scc1 L_slow_72
  buffer_store_dwordx2 v[200:201], v244, s[8:11], s90 offen
  s_branch L_join_73
L_slow_72:
  buffer_store_dwordx2 v[200:201], v244, s[8:11], s90 offen sc1
L_join_73:
  s_mov_b32 exec_hi, -1
  s_cmp_eq_u32 s6, 1
  s_cbranch_scc0 L_notlast_74
  s_waitcnt vmcnt(0)
  s_endpgm
L_notlast_74:
  s_waitcnt vmcnt(0)
  s_add_u32 s66, s66, 1
  s_lshl_b32 s91, s3, 8
  s_add_u32 s91, s91, 0
  s_lshl_b32 s79, s4, 2
  s_add_u32 s79, s79, s5
  s_lshl_b32 s79, s79, 2
  v_mov_b32 v243, s66
  v_mov_b32 v244, s79
  v_lshlrev_b32 v250, 2, v254
  s_mov_b64 exec, 1
  s_cmp_eq_u32 s7, 0
  s_cbranch_scc1 L_slow_75
  buffer_store_dword v243, v244, s[8:11], s91 offen
  s_branch L_join_76
L_slow_75:
  buffer_store_dword v243, v244, s[8:11], s91 offen sc1
L_join_76:
  s_mov_b64 exec, -1
  s_barrier
  s_mov_b32 s6, 1
  s_mul_i32 s84, s6, 5242880
  s_mul_i32 s78, s3, 163840
  s_add_u32 s84, s84, s78
  s_mul_i32 s78, s5, 40960
  s_add_u32 s84, s84, s78
  s_add_u32 s84, s84, 25165824
  s_mov_b32 s96, 0
L_poll_x2_77:
  buffer_load_dword v251, v250, s[8:11], s91 offen sc1
  s_add_u32 s96, s96, 1
  s_cmp_gt_u32 s96, 200000
  s_cbranch_scc1 L_done_x2_78
  s_waitcnt vmcnt(0)
  v_cmp_gt_u32 vcc, s66, v251
  s_cbranch_vccnz L_poll_x2_77
L_done_x2_78:
  s_waitcnt vmcnt(0)
  s_branch L_P_layer
L_helper:
  s_sub_u32 s2, s5, 4
  s_lshl_b32 s0, s2, 10
  s_min_u32 s1, s2, 1
  s_lshl_b32 s1, s1, 10
  v_add_u32 v230, s0, v255
  v_add_u32 v231, s1, v255
  s_mul_i32 s66, s4, 163840
  s_add_u32 s66, s66, 52428800
  s_mul_i32 s97, s4, 286720
  s_add_u32 s97, s97, 55574528
  s_mul_i32 s12, s67, 102400
  s_add_u32 s12, s12, 60817408
  s_mul_i32 s13, s67, 278528
  s_add_u32 s13, s13, 61865984
  s_add_u32 m0, s0, 0
  s_add_u32 s84, s66, 0
  buffer_load_dwordx4 v230, s[8:11], s84 offen lds
  s_add_u32 m0, s0, 4096
  s_add_u32 s84, s66, 4096
  buffer_load_dwordx4 v230, s[8:11], s84 offen lds
  s_add_u32 m0, s0, 8192
  s_add_u32 s84, s66, 8192
  buffer_load_dwordx4 v230, s[8:11], s84 offen lds
  s_add_u32 m0, s0, 12288
  s_add_u32 s84, s66, 12288
  buffer_load_dwordx4 v230, s[8:11], s84 offen lds
  s_add_u32 m0, s0, 16384
  s_add_u32 s84, s66, 16384
  buffer_load_dwordx4 v230, s[8:11], s84 offen lds
  s_add_u32 m0, s0, 20480
  s_add_u32 s84, s66, 20480
  buffer_load_dwordx4 v230, s[8:11], s84 offen lds
  s_add_u32 m0, s0, 24576
  s_add_u32 s84, s66, 24576
  buffer_load_dwordx4 v230, s[8:11], s84 offen lds
  s_add_u32 m0, s0, 28672
  s_add_u32 s84, s66, 28672
  buffer_load_dwordx4 v230, s[8:11], s84 offen lds
  s_add_u32 m0, s0, 61440
  s_add_u32 s84, s66, 32768
  buffer_load_dwordx4 v230, s[8:11], s84 offen lds
  s_add_u32 m0, s0, 65536
  s_add_u32 s84, s66, 36864
  buffer_load_dwordx4 v230, s[8:11], s84 offen lds
  s_add_u32 m0, s0, 69632
  s_add_u32 s84, s66, 40960
  buffer_load_dwordx4 v230, s[8:11], s84 offen lds
  s_add_u32 m0, s0, 73728
  s_add_u32 s84, s66, 45056
  buffer_load_dwordx4 v230, s[8:11], s84 offen lds
  s_add_u32 m0, s0, 77824
  s_add_u32 s84, s66, 49152
  buffer_load_dwordx4 v230, s[8:11], s84 offen lds
  s_add_u32 m0, s0, 81920
  s_add_u32 s84, s66, 53248
  buffer_load_dwordx4 v230, s[8:11], s84 offen lds
  s_add_u32 m0, s0, 86016
  s_add_u32 s84, s66, 57344
  buffer_load_dwordx4 v230, s[8:11], s84 offen lds
  s_add_u32 m0, s0, 90112
  s_add_u32 s84, s66, 61440
  buffer_load_dwordx4 v230, s[8:11], s84 offen lds
L_H_layer:
  s_waitcnt vmcnt(12)
  s_barrier
  s_waitcnt vmcnt(8)
  s_barrier
  s_cmp_eq_u32 s6, 0
  s_cbranch_scc0 L_l0_79
  s_cmp_eq_u32 s2, 0
  s_cbranch_scc0 L_fb_80
  s_lshl_b32 s85, s3, 4
  s_add_u32 s85, s85, s4
  s_lshl_b32 s85, s85, 7
  s_add_u32 s85, s85, 4104
  v_mov_b32 v4, 1
  v_mov_b32 v5, 0
  s_mov_b64 exec, 1
  buffer_store_dword v4, v5, s[8:11], s85 offen sc1
  s_mov_b64 exec, -1
L_fb_80:
L_l0_79:
  s_add_u32 m0, s0, 32768
  s_add_u32 s84, s66, 65536
  buffer_load_dwordx4 v230, s[8:11], s84 offen lds
  s_add_u32 m0, s0, 36864
  s_add_u32 s84, s66, 69632
  buffer_load_dwordx4 v230, s[8:11], s84 offen lds
  s_add_u32 m0, s0, 40960
  s_add_u32 s84, s66, 73728
  buffer_load_dwordx4 v230, s[8:11], s84 offen lds
  s_add_u32 m0, s0, 45056
  s_add_u32 s84, s66, 77824
  buffer_load_dwordx4 v230, s[8:11], s84 offen lds
  s_waitcnt vmcnt(8)
  s_barrier
  s_cmp_eq_u32 s6, 0
  s_cbranch_scc0 L_l0_81
  s_add_u32 s85, s2, 0
  s_cmp_le_u32 s85, 10
  s_cbranch_scc0 L_csb_82
  s_lshl_b32 s86, s85, 11
  s_lshl_b32 s87, s4, 15
  s_add_u32 s86, s86, s87
  s_add_u32 s86, s86, 1572864
  v_and_b32 v1, 31, v254
  v_lshlrev_b32 v2, 2, v1
  v_lshrrev_b32 v3, 5, v254
  v_lshl_add_u32 v2, v3, 10, v2
  buffer_load_dword v8, v2, s[8:11], s86 offen offset:0 sc1
  buffer_load_dword v9, v2, s[8:11], s86 offen offset:128 sc1
  buffer_load_dword v10, v2, s[8:11], s86 offen offset:256 sc1
  buffer_load_dword v11, v2, s[8:11], s86 offen offset:384 sc1
  buffer_load_dword v12, v2, s[8:11], s86 offen offset:512 sc1
  buffer_load_dword v13, v2, s[8:11], s86 offen offset:640 sc1
  buffer_load_dword v14, v2, s[8:11], s86 offen offset:768 sc1
  buffer_load_dword v15, v2, s[8:11], s86 offen offset:896 sc1
  s_waitcnt vmcnt(0)
  v_add_f32 v8, v8, v9
  v_add_f32 v8, v8, v10
  v_add_f32 v8, v8, v11
  v_add_f32 v8, v8, v12
  v_add_f32 v8, v8, v13
  v_add_f32 v8, v8, v14
  v_add_f32 v8, v8, v15
  v_mov_b32 v9, v8
  s_nop 1
  v_permlane32_swap_b32 v8, v9
  v_add_f32 v8, v8, v9
  v_cvt_pk_bf16_f32 v4, v8, v8
  v_and_b32 v5, 0xffff0000, v4
  v_sub_f32 v5, v8, v5
  v_mov_b32 v6, 0
  v_cvt_pk_bf16_f32 v5, v5, v6
  s_lshl_b32 s85, s85, 8
  s_add_u32 s85, s85, 157696
  v_lshlrev_b32 v1, 3, v1
  v_add_u32 v1, s85, v1
  ds_write_b64 v1, v[4:5]
  s_waitcnt lgkmcnt(0)
L_csb_82:
L_l0_81:
  s_add_u32 m0, s0, 0
  s_add_u32 s84, s66, 81920
  buffer_load_dwordx4 v230, s[8:11], s84 offen lds
  s_add_u32 m0, s0, 4096
  s_add_u32 s84, s66, 86016
  buffer_load_dwordx4 v230, s[8:11], s84 offen lds
  s_add_u32 m0, s0, 8192
  s_add_u32 s84, s66, 90112
  buffer_load_dwordx4 v230, s[8:11], s84 offen lds
  s_add_u32 m0, s0, 12288
  s_add_u32 s84, s66, 94208
  buffer_load_dwordx4 v230, s[8:11], s84 offen lds
  s_waitcnt vmcnt(8)
  s_barrier
  s_add_u32 m0, s0, 16384
  s_add_u32 s84, s66, 98304
  buffer_load_dwordx4 v230, s[8:11], s84 offen lds
  s_add_u32 m0, s0, 20480
  s_add_u32 s84, s66, 102400
  buffer_load_dwordx4 v230, s[8:11], s84 offen lds
  s_add_u32 m0, s0, 24576
  s_add_u32 s84, s66, 106496
  buffer_load_dwordx4 v230, s[8:11], s84 offen lds
  s_add_u32 m0, s0, 28672
  s_add_u32 s84, s66, 110592
  buffer_load_dwordx4 v230, s[8:11], s84 offen lds
  s_waitcnt vmcnt(8)
  s_barrier
  s_add_u32 m0, s0, 49152
  s_add_u32 s84, s66, 114688
  buffer_load_dwordx4 v230, s[8:11], s84 offen lds
  s_add_u32 m0, s0, 53248
  s_add_u32 s84, s66, 118784
  buffer_load_dwordx4 v230, s[8:11], s84 offen lds
  s_add_u32 m0, s0, 57344
  s_add_u32 s84, s66, 122880
  buffer_load_dwordx4 v230, s[8:11], s84 offen lds
  s_add_u32 m0, s0, 61440
  s_add_u32 s84, s66, 126976
  buffer_load_dwordx4 v230, s[8:11], s84 offen lds
  s_waitcnt vmcnt(8)
  s_barrier
  s_lshl_b32 s85, s6, 1
  s_lshl_b32 s85, s85, 18
  s_lshl_b32 s86, s3, 14
  s_add_u32 s85, s85, s86
  s_lshl_b32 s86, s2, 12
  s_add_u32 s85, s85, s86
  s_add_u32 s85, s85, 65536
  v_and_b32 v1, 31, v254
  v_lshlrev_b32 v1, 4, v1
  v_lshrrev_b32 v2, 5, v254
  v_lshl_add_u32 v1, v2, 11, v1
  buffer_load_dwordx4 v[8:11], v1, s[8:11], s85 offen offset:0 sc1
  buffer_load_dwordx4 v[12:15], v1, s[8:11], s85 offen offset:512 sc1
  buffer_load_dwordx4 v[16:19], v1, s[8:11], s85 offen offset:1024 sc1
  buffer_load_dwordx4 v[20:23], v1, s[8:11], s85 offen offset:1536 sc1
  s_add_u32 m0, s0, 90112
  s_add_u32 s84, s66, 131072
  buffer_load_dwordx4 v230, s[8:11], s84 offen lds
  s_add_u32 m0, s0, 94208
  s_add_u32 s84, s66, 135168
  buffer_load_dwordx4 v230, s[8:11], s84 offen lds
  s_add_u32 m0, s0, 98304
  s_add_u32 s84, s66, 139264
  buffer_load_dwordx4 v230, s[8:11], s84 offen lds
  s_add_u32 m0, s0, 102400
  s_add_u32 s84, s66, 143360
  buffer_load_dwordx4 v230, s[8:11], s84 offen lds
  s_waitcnt vmcnt(12)
  s_barrier
  s_cmp_eq_u32 s6, 0
  s_cbranch_scc0 L_l0_83
  s_cmp_eq_u32 s2, 0
  s_cbranch_scc0 L_fw_84
  v_lshlrev_b32 v42, 7, v254
  s_mov_b32 s96, 0
L_pB_85:
  s_mov_b32 s85, 4104
  buffer_load_dword v44, v42, s[8:11], s85 offen sc1
  s_mov_b32 s85, 12296
  buffer_load_dword v45, v42, s[8:11], s85 offen sc1
  s_mov_b32 s85, 20488
  buffer_load_dword v46, v42, s[8:11], s85 offen sc1
  s_mov_b32 s85, 28680
  buffer_load_dword v47, v42, s[8:11], s85 offen sc1
  s_add_u32 s96, s96, 1
  s_cmp_gt_u32 s96, 200000
  s_cbranch_scc1 L_dB_86
  s_waitcnt vmcnt(0)
  v_min_u32 v44, v44, v45
  v_min3_u32 v44, v44, v46, v47
  v_cmp_gt_u32 vcc, 1, v44
  s_cbranch_vccnz L_pB_85
L_dB_86:
  s_waitcnt vmcnt(0)
L_fw_84:
L_l0_83:
  s_waitcnt vmcnt(4)
  v_pk_add_f32 v[8:9], v[8:9], v[10:11]
  v_pk_add_f32 v[8:9], v[8:9], v[12:13]
  v_pk_add_f32 v[8:9], v[8:9], v[14:15]
  v_pk_add_f32 v[8:9], v[8:9], v[16:17]
  v_pk_add_f32 v[8:9], v[8:9], v[18:19]
  v_pk_add_f32 v[8:9], v[8:9], v[20:21]
  v_pk_add_f32 v[8:9], v[8:9], v[22:23]
  v_mov_b32 v10, v8
  v_mov_b32 v11, v9
  s_nop 0
  v_permlane32_swap_b32 v8, v10
  v_permlane32_swap_b32 v9, v11
  v_add_f32 v8, v8, v10
  v_add_f32 v9, v9, v11
  v_mul_f32 v8, 0x3acccccd, v8
  v_mul_f32 v9, 0x3acccccd, v9
  v_fma_f32 v9, -v8, v8, v9
  v_max_f32 v9, 0, v9
  v_add_f32 v9, 0x3727c5ac, v9
  v_rsq_f32 v9, v9
  v_sub_f32 v8, 0, v8
  v_cvt_pk_bf16_f32 v10, v8, v8
  v_and_b32 v11, 0xffff0000, v10
  v_sub_f32 v11, v8, v11
  v_cvt_pk_bf16_f32 v12, v8, v11
  v_and_b32 v13, 0xffff, v10
  v_mov_b32 v14, 0
  v_cndmask_b32 v12, v12, v14, s[64:65]
  v_cndmask_b32 v13, v13, v14, s[64:65]
  s_mul_i32 s85, s2, 768
  s_add_u32 s85, s85, 160768
  v_lshlrev_b32 v1, 3, v254
  v_add_u32 v1, s85, v1
  v_lshlrev_b32 v2, 2, v254
  v_add_u32 v2, s85, v2
  ds_write_b64 v1, v[12:13]
  ds_write_b32 v2, v9 offset:512
  s_waitcnt lgkmcnt(0)
  s_add_u32 m0, s0, 73728
  s_add_u32 s84, s66, 147456
  buffer_load_dwordx4 v230, s[8:11], s84 offen lds
  s_add_u32 m0, s0, 77824
  s_add_u32 s84, s66, 151552
  buffer_load_dwordx4 v230, s[8:11], s84 offen lds
  s_add_u32 m0, s0, 81920
  s_add_u32 s84, s66, 155648
  buffer_load_dwordx4 v230, s[8:11], s84 offen lds
  s_add_u32 m0, s0, 86016
  s_add_u32 s84, s66, 159744
  buffer_load_dwordx4 v230, s[8:11], s84 offen lds
  s_barrier
  s_cmp_eq_u32 s6, 0
  s_cbranch_scc0 L_l0_87
  s_add_u32 s85, s2, 4
  s_cmp_le_u32 s85, 10
  s_cbranch_scc0 L_csb_88
  s_lshl_b32 s86, s85, 11
  s_lshl_b32 s87, s4, 15
  s_add_u32 s86, s86, s87
  s_add_u32 s86, s86, 1572864
  v_and_b32 v1, 31, v254
  v_lshlrev_b32 v2, 2, v1
  v_lshrrev_b32 v3, 5, v254
  v_lshl_add_u32 v2, v3, 10, v2
  buffer_load_dword v8, v2, s[8:11], s86 offen offset:0 sc1
  buffer_load_dword v9, v2, s[8:11], s86 offen offset:128 sc1
  buffer_load_dword v10, v2, s[8:11], s86 offen offset:256 sc1
  buffer_load_dword v11, v2, s[8:11], s86 offen offset:384 sc1
  buffer_load_dword v12, v2, s[8:11], s86 offen offset:512 sc1
  buffer_load_dword v13, v2, s[8:11], s86 offen offset:640 sc1
  buffer_load_dword v14, v2, s[8:11], s86 offen offset:768 sc1
  buffer_load_dword v15, v2, s[8:11], s86 offen offset:896 sc1
  s_waitcnt vmcnt(0)
  v_add_f32 v8, v8, v9
  v_add_f32 v8, v8, v10
  v_add_f32 v8, v8, v11
  v_add_f32 v8, v8, v12
  v_add_f32 v8, v8, v13
  v_add_f32 v8, v8, v14
  v_add_f32 v8, v8, v15
  v_mov_b32 v9, v8
  s_nop 1
  v_permlane32_swap_b32 v8, v9
  v_add_f32 v8, v8, v9
  v_cvt_pk_bf16_f32 v4, v8, v8
  v_and_b32 v5, 0xffff0000, v4
  v_sub_f32 v5, v8, v5
  v_mov_b32 v6, 0
  v_cvt_pk_bf16_f32 v5, v5, v6
  s_lshl_b32 s85, s85, 8
  s_add_u32 s85, s85, 157696
  v_lshlrev_b32 v1, 3, v1
  v_add_u32 v1, s85, v1
  ds_write_b64 v1, v[4:5]
  s_waitcnt lgkmcnt(0)
L_csb_88:
L_l0_87:
  s_waitcnt vmcnt(4)
  s_barrier
  s_cmp_eq_u32 s6, 0
  s_cbranch_scc0 L_l0_89
  s_add_u32 s85, s2, 8
  s_cmp_le_u32 s85, 10
  s_cbranch_scc0 L_csb_90
  s_lshl_b32 s86, s85, 11
  s_lshl_b32 s87, s4, 15
  s_add_u32 s86, s86, s87
  s_add_u32 s86, s86, 1572864
  v_and_b32 v1, 31, v254
  v_lshlrev_b32 v2, 2, v1
  v_lshrrev_b32 v3, 5, v254
  v_lshl_add_u32 v2, v3, 10, v2
  buffer_load_dword v8, v2, s[8:11], s86 offen offset:0 sc1
  buffer_load_dword v9, v2, s[8:11], s86 offen offset:128 sc1
  buffer_load_dword v10, v2, s[8:11], s86 offen offset:256 sc1
  buffer_load_dword v11, v2, s[8:11], s86 offen offset:384 sc1
  buffer_load_dword v12, v2, s[8:11], s86 offen offset:512 sc1
  buffer_load_dword v13, v2, s[8:11], s86 offen offset:640 sc1
  buffer_load_dword v14, v2, s[8:11], s86 offen offset:768 sc1
  buffer_load_dword v15, v2, s[8:11], s86 offen offset:896 sc1
  s_waitcnt vmcnt(0)
  v_add_f32 v8, v8, v9
  v_add_f32 v8, v8, v10
  v_add_f32 v8, v8, v11
  v_add_f32 v8, v8, v12
  v_add_f32 v8, v8, v13
  v_add_f32 v8, v8, v14
  v_add_f32 v8, v8, v15
  v_mov_b32 v9, v8
  s_nop 1
  v_permlane32_swap_b32 v8, v9
  v_add_f32 v8, v8, v9
  v_cvt_pk_bf16_f32 v4, v8, v8
  v_and_b32 v5, 0xffff0000, v4
  v_sub_f32 v5, v8, v5
  v_mov_b32 v6, 0
  v_cvt_pk_bf16_f32 v5, v5, v6
  s_lshl_b32 s85, s85, 8
  s_add_u32 s85, s85, 157696
  v_lshlrev_b32 v1, 3, v1
  v_add_u32 v1, s85, v1
  ds_write_b64 v1, v[4:5]
  s_waitcnt lgkmcnt(0)
L_csb_90:
L_l0_89:
  s_lshl_b32 s85, s6, 4
  s_add_u32 s85, s85, s3
  s_mul_i32 s85, s85, 163840
  s_mul_i32 s86, s2, 40960
  s_add_u32 s85, s85, s86
  s_add_u32 s85, s85, 16777216
  s_lshl_b32 s86, s4, 1
  s_add_u32 s87, s86, 4
  s_cmp_lt_u32 s86, 16
  s_cselect_b32 s86, s86, s87
  s_lshl_b32 s86, s86, 10
  s_lshr_b32 s87, s4, 1
  s_add_u32 s88, s87, 16
  s_add_u32 s89, s87, 32
  s_cmp_lt_u32 s87, 4
  s_cselect_b32 s87, s88, s89
  s_lshl_b32 s87, s87, 10
  s_and_b32 s88, s4, 1
  s_lshl_b32 s88, s88, 9
  s_add_u32 s87, s87, s88
  v_and_b32 v1, 15, v254
  v_lshlrev_b32 v1, 7, v1
  v_add_u32 v1, s86, v1
  v_and_b32 v2, 3, v254
  v_lshlrev_b32 v2, 7, v2
  v_add_u32 v2, s87, v2
  v_cmp_gt_u32 vcc, 16, v254
  s_nop 1
  v_cndmask_b32 v1, v2, v1, vcc
  buffer_load_dword v253, v1, s[8:11], s85 offen sc1
  s_lshl_b32 s85, s6, 1
  s_add_u32 s85, s85, 1
  s_mul_i32 s85, s85, 2621440
  s_mul_i32 s86, s3, 163840
  s_add_u32 s85, s85, s86
  s_and_b32 s86, s2, 1
  s_lshl_b32 s87, s68, 1
  s_add_u32 s86, s86, s87
  s_mul_i32 s87, s86, 40960
  s_add_u32 s85, s85, s87
  s_mul_i32 s87, s67, 5120
  s_add_u32 s85, s85, s87
  s_lshr_b32 s87, s2, 1
  s_mul_i32 s87, s87, 2560
  s_add_u32 s85, s85, s87
  s_add_u32 s85, s85, 25165824
  v_min_u32 v1, 19, v254
  v_lshlrev_b32 v1, 7, v1
  buffer_load_dword v253, v1, s[8:11], s85 offen sc1
  s_lshl_b32 s85, s6, 1
  s_add_u32 s85, s85, 1
  s_lshl_b32 s85, s85, 18
  s_lshl_b32 s86, s3, 14
  s_add_u32 s85, s85, s86
  s_and_b32 s86, s2, 1
  s_lshl_b32 s87, s68, 1
  s_add_u32 s86, s86, s87
  s_lshl_b32 s86, s86, 12
  s_add_u32 s85, s85, s86
  s_lshl_b32 s86, s67, 1
  s_lshr_b32 s87, s2, 1
  s_add_u32 s86, s86, s87
  s_lshl_b32 s86, s86, 8
  s_add_u32 s85, s85, s86
  s_add_u32 s85, s85, 65536
  v_and_b32 v1, 1, v254
  v_lshlrev_b32 v1, 7, v1
  buffer_load_dword v253, v1, s[8:11], s85 offen sc1
  s_waitcnt vmcnt(3)
  s_barrier
  s_barrier
  s_and_b32 s78, s5, 3
  s_lshr_b32 s79, s5, 2
  s_mul_i32 s80, s78, 2560
  s_add_u32 s80, s80, 0
  v_lshlrev_b32 v221, 3, v254
  v_add_u32 v221, s80, v221
  s_lshl_b32 s81, s79, 10
  s_add_u32 s80, s80, s81
  v_add_u32 v220, s80, v255
  v_bfe_u32 v224, v254, 2, 2
  v_and_b32 v225, 3, v254
  v_bfe_u32 v226, v254, 4, 1
  v_lshrrev_b32 v227, 5, v254
  v_lshl_add_u32 v224, v227, 2, v224
  s_lshl_b32 s80, s78, 5
  v_add_u32 v224, s80, v224
  v_mul_u32_u24 v224, 48, v224
  v_lshl_add_u32 v224, v226, 5, v224
  v_lshl_add_u32 v224, v225, 3, v224
  s_mul_i32 s80, s79, 18432
  s_add_u32 s80, s80, 30720
  v_add_u32 v222, s80, v224
  v_mov_b32 v224, 0xffff
  v_mov_b32 v225, 0xffff0000
  v_cndmask_b32 v226, 0, v224, s[32:33]
  v_cndmask_b32 v227, 0, v225, s[34:35]
  v_or_b32 v208, v226, v227
  v_cndmask_b32 v226, 0, v224, s[36:37]
  v_cndmask_b32 v227, 0, v225, s[38:39]
  v_or_b32 v209, v226, v227
  v_cndmask_b32 v226, 0, v224, s[40:41]
  v_cndmask_b32 v227, 0, v225, s[42:43]
  v_or_b32 v210, v226, v227
  v_cndmask_b32 v226, 0, v224, s[44:45]
  v_cndmask_b32 v227, 0, v225, s[46:47]
  v_or_b32 v211, v226, v227
  v_cndmask_b32 v226, 0, v224, s[48:49]
  v_cndmask_b32 v227, 0, v225, s[50:51]
  v_or_b32 v212, v226, v227
  v_cndmask_b32 v226, 0, v224, s[52:53]
  v_cndmask_b32 v227, 0, v225, s[54:55]
  v_or_b32 v213, v226, v227
  v_cndmask_b32 v226, 0, v224, s[56:57]
  v_cndmask_b32 v227, 0, v225, s[58:59]
  v_or_b32 v214, v226, v227
  v_cndmask_b32 v226, 0, v224, s[60:61]
  v_cndmask_b32 v227, 0, v225, s[62:63]
  v_or_b32 v215, v226, v227
  v_mov_b32 v224, 0x3f80
  v_cndmask_b32 v150, v224, 0, s[64:65]
  v_mov_b32 v151, 0
  v_mov_b32 v159, 0
  v_mov_b32 v167, 0
  v_mov_b32 v175, 0
  s_mul_i32 s87, s5, 10240
  v_add_u32 v228, s87, v255
  s_mul_i32 s85, s67, 102400
  s_add_u32 s85, s85, 60817408
  s_mul_i32 s86, s4, 286720
  s_add_u32 s86, s86, 55574528
  s_lshl_b32 s78, s6, 4
  s_add_u32 s78, s78, s3
  s_mul_i32 s78, s78, 163840
  s_add_u32 s78, s78, 16777216
  s_and_b32 s79, s5, 3
  s_mul_i32 s79, s79, 40960
  s_add_u32 s78, s78, s79
  s_lshr_b32 s80, s5, 2
  s_lshl_b32 s81, s4, 1
  s_add_u32 s81, s81, s80
  s_add_u32 s82, s81, 4
  s_cmp_lt_u32 s81, 16
  s_cselect_b32 s81, s81, s82
  s_lshl_b32 s81, s81, 10
  s_add_u32 s90, s81, s78
  s_lshr_b32 s82, s4, 1
  s_add_u32 s83, s82, 16
  s_add_u32 s81, s82, 32
  s_cmp_lt_u32 s82, 4
  s_cselect_b32 s82, s83, s81
  s_lshl_b32 s82, s82, 10
  s_and_b32 s83, s4, 1
  s_lshl_b32 s83, s83, 9
  s_add_u32 s82, s82, s83
  s_lshl_b32 s83, s80, 3
  s_add_u32 s82, s82, s83
  s_add_u32 s91, s82, s78
  v_and_b32 v223, 31, v254
  v_lshlrev_b32 v223, 4, v223
  s_lshr_b32 s78, s2, 1
  s_and_b32 s79, s2, 1
  s_lshl_b32 s79, s79, 10
  s_mul_i32 s92, s78, 10240
  s_add_u32 s92, s92, s79
  s_add_u32 s92, s92, 0
  s_add_u32 s94, s3, s78
  s_sub_u32 s94, s94, 2
  s_cmp_ge_i32 s94, 0
  s_cselect_b32 s93, 1, 0
  s_max_i32 s94, s94, 0
  s_lshl_b32 s78, s94, 4
  s_add_u32 s78, s78, s4
  s_lshl_b32 s89, s78, 7
  s_add_u32 s89, s89, 4128
  s_lshl_b32 s94, s6, 8
  s_add_u32 s94, s94, s78
  s_mul_i32 s94, s94, 24576
  s_add_u32 s94, s94, s79
  s_add_u32 s94, s94, 2097152
  v_mov_b32 v239, 0
  s_barrier
  s_add_u32 s88, s6, 1
  s_cmp_eq_u32 s93, 0
  s_cbranch_scc1 L_hz_91
  s_mov_b32 s96, 0
  buffer_load_dwordx4 v[232:235], v239, s[8:11], s89 offen sc1
L_hp_93:
  buffer_load_dwordx4 v[244:247], v239, s[8:11], s89 offen sc1
  s_add_u32 s96, s96, 1
  s_cmp_gt_u32 s96, 200000
  s_cbranch_scc1 L_hq_94
  s_waitcnt vmcnt(1)
L_hc_95:
  v_min_u32 v232, v232, v233
  v_min3_u32 v232, v232, v234, v235
  v_cmp_gt_u32 vcc, s88, v232
  s_cbranch_vccz L_hq_94
  buffer_load_dwordx4 v[232:235], v239, s[8:11], s89 offen sc1
  s_waitcnt vmcnt(1)
  v_min_u32 v244, v244, v245
  v_min3_u32 v244, v244, v246, v247
  v_cmp_gt_u32 vcc, s88, v244
  s_cbranch_vccnz L_hp_93
L_hq_94:
  s_add_u32 m0, s92, 0
  s_nop 0
  buffer_load_dwordx4 v255, s[8:11], s94 offen sc1 lds
  s_add_u32 s94, s94, 2048
  s_add_u32 m0, s92, 2048
  s_nop 0
  buffer_load_dwordx4 v255, s[8:11], s94 offen sc1 lds
  s_add_u32 s94, s94, 2048
  s_add_u32 m0, s92, 4096
  s_nop 0
  buffer_load_dwordx4 v255, s[8:11], s94 offen sc1 lds
  s_add_u32 s94, s94, 2048
  s_add_u32 m0, s92, 6144
  s_nop 0
  buffer_load_dwordx4 v255, s[8:11], s94 offen sc1 lds
  s_add_u32 s94, s94, 2048
  s_add_u32 m0, s92, 8192
  s_nop 0
  buffer_load_dwordx4 v255, s[8:11], s94 offen sc1 lds
  s_add_u32 s94, s94, 2048
  s_branch L_hd_92
L_hz_91:
  v_mov_b32 v232, 0
  v_mov_b32 v233, 0
  v_mov_b32 v234, 0
  v_mov_b32 v235, 0
  s_add_u32 s88, s92, 0
  v_add_u32 v239, s88, v255
  ds_write_b128 v239, v[232:235]
  s_add_u32 s88, s92, 2048
  v_add_u32 v239, s88, v255
  ds_write_b128 v239, v[232:235]
  s_add_u32 s88, s92, 4096
  v_add_u32 v239, s88, v255
  ds_write_b128 v239, v[232:235]
  s_add_u32 s88, s92, 6144
  v_add_u32 v239, s88, v255
  ds_write_b128 v239, v[232:235]
  s_add_u32 s88, s92, 8192
  v_add_u32 v239, s88, v255
  ds_write_b128 v239, v[232:235]
L_hd_92:
  s_waitcnt vmcnt(0)
  s_waitcnt lgkmcnt(0)
  s_barrier
  s_mul_i32 s88, s2, 1536
  s_add_u32 s88, s88, 67584
  v_add_u32 v2, s88, v255
  v_lshlrev_b32 v3, 3, v254
  v_add_u32 v3, s88, v3
  ds_read_b128 v[144:147], v2
  ds_read_b64 v[148:149], v3 offset:1024
  s_setprio 1
  ds_read_b128 v[152:155], v220 offset:0
  ds_read_b64 v[156:157], v221 offset:2048
  v_mov_b32 v158, s70
  ds_read_b128 v[160:163], v220 offset:20480
  ds_read_b64 v[164:165], v221 offset:22528
  v_mov_b32 v166, 0
  ds_read_b128 v[168:171], v220 offset:2560
  ds_read_b64 v[172:173], v221 offset:4608
  v_mov_b32 v174, s71
  s_waitcnt lgkmcnt(4)
  v_mfma_f32_32x32x16_bf16 v[0:15], v[152:155], v[144:147], 0
  v_mfma_f32_32x32x16_bf16 v[0:15], v[156:159], v[148:151], v[0:15]
  ds_read_b128 v[152:155], v220 offset:5120
  ds_read_b64 v[156:157], v221 offset:7168
  v_mov_b32 v158, s72
  s_waitcnt lgkmcnt(4)
  v_mfma_f32_32x32x16_bf16 v[128:143], v[160:163], v[144:147], 0
  v_mfma_f32_32x32x16_bf16 v[128:143], v[164:167], v[148:151], v[128:143]
  ds_read_b128 v[160:163], v220 offset:7680
  ds_read_b64 v[164:165], v221 offset:9728
  v_mov_b32 v166, s73
  s_waitcnt lgkmcnt(4)
  v_mfma_f32_32x32x16_bf16 v[16:31], v[168:171], v[144:147], 0
  v_mfma_f32_32x32x16_bf16 v[16:31], v[172:175], v[148:151], v[16:31]
  ds_read_b128 v[168:171], v220 offset:10240
  ds_read_b64 v[172:173], v221 offset:12288
  v_mov_b32 v174, s74
  s_waitcnt lgkmcnt(4)
  v_mfma_f32_32x32x16_bf16 v[32:47], v[152:155], v[144:147], 0
  v_cndmask_b32 v128, v0, v128, s[32:33]
  v_cndmask_b32 v129, v1, v129, s[34:35]
  v_cndmask_b32 v130, v2, v130, s[36:37]
  v_mfma_f32_32x32x16_bf16 v[32:47], v[156:159], v[148:151], v[32:47]
  v_cndmask_b32 v131, v3, v131, s[38:39]
  v_cndmask_b32 v132, v4, v132, s[40:41]
  v_cndmask_b32 v133, v5, v133, s[42:43]
  ds_read_b128 v[152:155], v220 offset:12800
  ds_read_b64 v[156:157], v221 offset:14848
  v_mov_b32 v158, s75
  s_waitcnt lgkmcnt(4)
  v_mfma_f32_32x32x16_bf16 v[48:63], v[160:163], v[144:147], 0
  v_cndmask_b32 v134, v6, v134, s[44:45]
  v_cndmask_b32 v135, v7, v135, s[46:47]
  v_cndmask_b32 v136, v8, v136, s[48:49]
  v_mfma_f32_32x32x16_bf16 v[48:63], v[164:167], v[148:151], v[48:63]
  v_cndmask_b32 v137, v9, v137, s[50:51]
  v_cndmask_b32 v138, v10, v138, s[52:53]
  v_cndmask_b32 v139, v11, v139, s[54:55]
  ds_read_b128 v[160:163], v220 offset:15360
  ds_read_b64 v[164:165], v221 offset:17408
  v_mov_b32 v166, s76
  s_waitcnt lgkmcnt(4)
  v_mfma_f32_32x32x16_bf16 v[64:79], v[168:171], v[144:147], 0
  v_cndmask_b32 v140, v12, v140, s[56:57]
  v_cndmask_b32 v141, v13, v141, s[58:59]
  v_cndmask_b32 v142, v14, v142, s[60:61]
  v_mfma_f32_32x32x16_bf16 v[64:79], v[172:175], v[148:151], v[64:79]
  v_cndmask_b32 v143, v15, v143, s[62:63]
  v_exp_f32 v16, v16
  v_exp_f32 v17, v17
  ds_read_b128 v[168:171], v220 offset:17920
  ds_read_b64 v[172:173], v221 offset:19968
  v_mov_b32 v174, s77
  s_waitcnt lgkmcnt(4)
  v_mfma_f32_32x32x16_bf16 v[80:95], v[152:155], v[144:147], 0
  v_exp_f32 v18, v18
  v_exp_f32 v19, v19
  v_exp_f32 v20, v20
  v_mfma_f32_32x32x16_bf16 v[80:95], v[156:159], v[148:151], v[80:95]
  v_exp_f32 v21, v21
  v_exp_f32 v22, v22
  v_exp_f32 v23, v23
  s_waitcnt lgkmcnt(2)
  v_mfma_f32_32x32x16_bf16 v[96:111], v[160:163], v[144:147], 0
  v_cvt_pk_bf16_f32 v16, v16, v17
  v_cvt_pk_bf16_f32 v17, v18, v19
  v_exp_f32 v24, v24
  v_mfma_f32_32x32x16_bf16 v[96:111], v[164:167], v[148:151], v[96:111]
  v_exp_f32 v25, v25
  v_exp_f32 v26, v26
  v_exp_f32 v27, v27
  s_waitcnt lgkmcnt(0)
  v_mfma_f32_32x32x16_bf16 v[112:127], v[168:171], v[144:147], 0
  v_cvt_pk_bf16_f32 v18, v20, v21
  v_cvt_pk_bf16_f32 v19, v22, v23
  v_exp_f32 v28, v28
  v_mfma_f32_32x32x16_bf16 v[112:127], v[172:175], v[148:151], v[112:127]
  v_exp_f32 v29, v29
  v_exp_f32 v30, v30
  v_exp_f32 v31, v31
  s_barrier
  ds_read_b64_tr_b16 v[176:177], v222 offset:1536
  ds_read_b64_tr_b16 v[178:179], v222 offset:1920
  ds_read_b64_tr_b16 v[180:181], v222 offset:2304
  ds_read_b64_tr_b16 v[182:183], v222 offset:2688
  ds_read_b64_tr_b16 v[184:185], v222 offset:3072
  ds_read_b64_tr_b16 v[186:187], v222 offset:3456
  ds_read_b64_tr_b16 v[188:189], v222 offset:3840
  ds_read_b64_tr_b16 v[190:191], v222 offset:4224
  v_cvt_pk_bf16_f32 v20, v24, v25
  v_cvt_pk_bf16_f32 v21, v26, v27
  v_cvt_pk_bf16_f32 v22, v28, v29
  v_cvt_pk_bf16_f32 v23, v30, v31
  v_exp_f32 v32, v32
  s_waitcnt lgkmcnt(4)
  v_mfma_f32_32x32x16_bf16 v[192:207], v[176:179], v[16:19], 0
  v_exp_f32 v33, v33
  v_exp_f32 v34, v34
  v_exp_f32 v35, v35
  v_exp_f32 v36, v36
  v_mfma_f32_32x32x16_bf16 v[192:207], v[180:183], v[20:23], v[192:207]
  ds_read_b64_tr_b16 v[176:177], v222 offset:4608
  ds_read_b64_tr_b16 v[178:179], v222 offset:4992
  ds_read_b64_tr_b16 v[180:181], v222 offset:5376
  ds_read_b64_tr_b16 v[182:183], v222 offset:5760
  s_add_u32 m0, s87, 73728
  s_add_u32 s84, s85, 0
  buffer_load_dwordx4 v228, s[8:11], s84 offen offset:0 lds
  buffer_load_dwordx4 v228, s[8:11], s84 offen offset:1024 lds
  buffer_load_dwordx4 v228, s[8:11], s84 offen offset:2048 lds
  buffer_load_dwordx4 v228, s[8:11], s84 offen offset:3072 lds
  v_exp_f32 v37, v37
  v_exp_f32 v38, v38
  v_exp_f32 v39, v39
  v_cvt_pk_bf16_f32 v32, v32, v33
  v_cvt_pk_bf16_f32 v33, v34, v35
  v_exp_f32 v40, v40
  v_exp_f32 v41, v41
  v_exp_f32 v42, v42
  v_exp_f32 v43, v43
  v_cvt_pk_bf16_f32 v34, v36, v37
  v_cvt_pk_bf16_f32 v35, v38, v39
  v_exp_f32 v44, v44
  v_exp_f32 v45, v45
  v_exp_f32 v46, v46
  v_exp_f32 v47, v47
  v_cvt_pk_bf16_f32 v36, v40, v41
  v_cvt_pk_bf16_f32 v37, v42, v43
  v_cvt_pk_bf16_f32 v38, v44, v45
  v_cvt_pk_bf16_f32 v39, v46, v47
  v_exp_f32 v48, v48
  s_waitcnt lgkmcnt(4)
  v_mfma_f32_32x32x16_bf16 v[192:207], v[184:187], v[32:35], v[192:207]
  v_exp_f32 v49, v49
  v_exp_f32 v50, v50
  v_exp_f32 v51, v51
  v_exp_f32 v52, v52
  v_mfma_f32_32x32x16_bf16 v[192:207], v[188:191], v[36:39], v[192:207]
  ds_read_b64_tr_b16 v[184:185], v222 offset:6144
  ds_read_b64_tr_b16 v[186:187], v222 offset:6528
  ds_read_b64_tr_b16 v[188:189], v222 offset:6912
  ds_read_b64_tr_b16 v[190:191], v222 offset:7296
  s_add_u32 m0, s87, 77824
  s_add_u32 s84, s85, 4096
  buffer_load_dwordx4 v228, s[8:11], s84 offen offset:0 lds
  buffer_load_dwordx4 v228, s[8:11], s84 offen offset:1024 lds
  buffer_load_dwordx4 v228, s[8:11], s84 offen offset:2048 lds
  buffer_load_dwordx4 v228, s[8:11], s84 offen offset:3072 lds
  v_exp_f32 v53, v53
  v_exp_f32 v54, v54
  v_exp_f32 v55, v55
  v_cvt_pk_bf16_f32 v48, v48, v49
  v_cvt_pk_bf16_f32 v49, v50, v51
  v_exp_f32 v56, v56
  v_exp_f32 v57, v57
  v_exp_f32 v58, v58
  v_exp_f32 v59, v59
  v_cvt_pk_bf16_f32 v50, v52, v53
  v_cvt_pk_bf16_f32 v51, v54, v55
  v_exp_f32 v60, v60
  v_exp_f32 v61, v61
  v_exp_f32 v62, v62
  v_exp_f32 v63, v63
  v_cvt_pk_bf16_f32 v52, v56, v57
  v_cvt_pk_bf16_f32 v53, v58, v59
  v_cvt_pk_bf16_f32 v54, v60, v61
  v_cvt_pk_bf16_f32 v55, v62, v63
  v_exp_f32 v64, v64
  s_waitcnt lgkmcnt(4)
  v_mfma_f32_32x32x16_bf16 v[192:207], v[176:179], v[48:51], v[192:207]
  v_exp_f32 v65, v65
  v_exp_f32 v66, v66
  v_exp_f32 v67, v67
  v_exp_f32 v68, v68
  v_mfma_f32_32x32x16_bf16 v[192:207], v[180:183], v[52:55], v[192:207]
  ds_read_b64_tr_b16 v[176:177], v222 offset:7680
  ds_read_b64_tr_b16 v[178:179], v222 offset:8064
  ds_read_b64_tr_b16 v[180:181], v222 offset:8448
  ds_read_b64_tr_b16 v[182:183], v222 offset:8832
  s_add_u32 m0, s87, 81920
  s_add_u32 s84, s85, 8192
  buffer_load_dwordx4 v228, s[8:11], s84 offen offset:0 lds
  buffer_load_dwordx4 v228, s[8:11], s84 offen offset:1024 lds
  v_exp_f32 v69, v69
  v_exp_f32 v70, v70
  v_exp_f32 v71, v71
  v_cvt_pk_bf16_f32 v64, v64, v65
  v_cvt_pk_bf16_f32 v65, v66, v67
  v_exp_f32 v72, v72
  v_exp_f32 v73, v73
  v_exp_f32 v74, v74
  v_exp_f32 v75, v75
  v_cvt_pk_bf16_f32 v66, v68, v69
  v_cvt_pk_bf16_f32 v67, v70, v71
  v_exp_f32 v76, v76
  v_exp_f32 v77, v77
  v_exp_f32 v78, v78
  v_exp_f32 v79, v79
  v_cvt_pk_bf16_f32 v68, v72, v73
  v_cvt_pk_bf16_f32 v69, v74, v75
  v_cvt_pk_bf16_f32 v70, v76, v77
  v_cvt_pk_bf16_f32 v71, v78, v79
  v_exp_f32 v80, v80
  s_waitcnt lgkmcnt(4)
  v_mfma_f32_32x32x16_bf16 v[192:207], v[184:187], v[64:67], v[192:207]
  v_exp_f32 v81, v81
  v_exp_f32 v82, v82
  v_exp_f32 v83, v83
  v_exp_f32 v84, v84
  v_mfma_f32_32x32x16_bf16 v[192:207], v[188:191], v[68:71], v[192:207]
  ds_read_b64_tr_b16 v[184:185], v222 offset:9216
  ds_read_b64_tr_b16 v[186:187], v222 offset:9600
  ds_read_b64_tr_b16 v[188:189], v222 offset:9984
  ds_read_b64_tr_b16 v[190:191], v222 offset:10368
  s_and_b32 s88, s3, 1
  s_lshl_b32 s88, s88, 1
  s_add_u32 s88, s88, s68
  s_mul_i32 s88, s88, 5120
  s_add_u32 s88, s88, s85
  s_add_u32 s88, s88, 81920
  v_lshlrev_b32 v229, 7, v254
  s_lshl_b32 s89, s5, 13
  s_add_u32 s89, s89, 0
  v_add_u32 v229, s89, v229
  v_min_u32 v229, 4992, v229
  buffer_load_dword v219, v229, s[8:11], s88 offen
  v_exp_f32 v85, v85
  v_exp_f32 v86, v86
  v_exp_f32 v87, v87
  v_cvt_pk_bf16_f32 v80, v80, v81
  v_cvt_pk_bf16_f32 v81, v82, v83
  v_exp_f32 v88, v88
  v_exp_f32 v89, v89
  v_exp_f32 v90, v90
  v_exp_f32 v91, v91
  v_cvt_pk_bf16_f32 v82, v84, v85
  v_cvt_pk_bf16_f32 v83, v86, v87
  v_exp_f32 v92, v92
  v_exp_f32 v93, v93
  v_exp_f32 v94, v94
  v_exp_f32 v95, v95
  v_cvt_pk_bf16_f32 v84, v88, v89
  v_cvt_pk_bf16_f32 v85, v90, v91
  v_cvt_pk_bf16_f32 v86, v92, v93
  v_cvt_pk_bf16_f32 v87, v94, v95
  v_exp_f32 v96, v96
  s_waitcnt lgkmcnt(4)
  v_mfma_f32_32x32x16_bf16 v[192:207], v[176:179], v[80:83], v[192:207]
  v_exp_f32 v97, v97
  v_exp_f32 v98, v98
  v_exp_f32 v99, v99
  v_exp_f32 v100, v100
  v_mfma_f32_32x32x16_bf16 v[192:207], v[180:183], v[84:87], v[192:207]
  ds_read_b64_tr_b16 v[176:177], v222 offset:10752
  ds_read_b64_tr_b16 v[178:179], v222 offset:11136
  ds_read_b64_tr_b16 v[180:181], v222 offset:11520
  ds_read_b64_tr_b16 v[182:183], v222 offset:11904
  v_exp_f32 v101, v101
  v_exp_f32 v102, v102
  v_exp_f32 v103, v103
  v_cvt_pk_bf16_f32 v96, v96, v97
  v_cvt_pk_bf16_f32 v97, v98, v99
  v_exp_f32 v104, v104
  v_exp_f32 v105, v105
  v_exp_f32 v106, v106
  v_exp_f32 v107, v107
  v_cvt_pk_bf16_f32 v98, v100, v101
  v_cvt_pk_bf16_f32 v99, v102, v103
  v_exp_f32 v108, v108
  v_exp_f32 v109, v109
  v_exp_f32 v110, v110
  v_exp_f32 v111, v111
  v_cvt_pk_bf16_f32 v100, v104, v105
  v_cvt_pk_bf16_f32 v101, v106, v107
  v_cvt_pk_bf16_f32 v102, v108, v109
  v_cvt_pk_bf16_f32 v103, v110, v111
  v_exp_f32 v112, v112
  s_waitcnt lgkmcnt(4)
  v_mfma_f32_32x32x16_bf16 v[192:207], v[184:187], v[96:99], v[192:207]
  v_exp_f32 v113, v113
  v_exp_f32 v114, v114
  v_exp_f32 v115, v115
  v_exp_f32 v116, v116
  v_mfma_f32_32x32x16_bf16 v[192:207], v[188:191], v[100:103], v[192:207]
  ds_read_b64_tr_b16 v[184:185], v222 offset:12288
  ds_read_b64_tr_b16 v[186:187], v222 offset:12672
  ds_read_b64_tr_b16 v[188:189], v222 offset:13056
  ds_read_b64_tr_b16 v[190:191], v222 offset:13440
  v_exp_f32 v117, v117
  v_exp_f32 v118, v118
  v_exp_f32 v119, v119
  v_cvt_pk_bf16_f32 v112, v112, v113
  v_cvt_pk_bf16_f32 v113, v114, v115
  v_exp_f32 v120, v120
  v_exp_f32 v121, v121
  v_exp_f32 v122, v122
  v_exp_f32 v123, v123
  v_cvt_pk_bf16_f32 v114, v116, v117
  v_cvt_pk_bf16_f32 v115, v118, v119
  v_exp_f32 v124, v124
  v_exp_f32 v125, v125
  v_exp_f32 v126, v126
  v_exp_f32 v127, v127
  v_cvt_pk_bf16_f32 v116, v120, v121
  v_cvt_pk_bf16_f32 v117, v122, v123
  v_cvt_pk_bf16_f32 v118, v124, v125
  v_cvt_pk_bf16_f32 v119, v126, v127
  v_exp_f32 v128, v128
  s_waitcnt lgkmcnt(4)
  v_mfma_f32_32x32x16_bf16 v[192:207], v[176:179], v[112:115], v[192:207]
  v_exp_f32 v129, v129
  v_exp_f32 v130, v130
  v_exp_f32 v131, v131
  v_exp_f32 v132, v132
  v_mfma_f32_32x32x16_bf16 v[192:207], v[180:183], v[116:119], v[192:207]
  ds_read_b64_tr_b16 v[176:177], v222 offset:0
  ds_read_b64_tr_b16 v[178:179], v222 offset:384
  ds_read_b64_tr_b16 v[180:181], v222 offset:768
  ds_read_b64_tr_b16 v[182:183], v222 offset:1152
  v_exp_f32 v133, v133
  v_exp_f32 v134, v134
  v_exp_f32 v135, v135
  v_cvt_pk_bf16_f32 v128, v128, v129
  v_cvt_pk_bf16_f32 v129, v130, v131
  v_exp_f32 v136, v136
  v_exp_f32 v137, v137
  v_exp_f32 v138, v138
  v_exp_f32 v139, v139
  v_cvt_pk_bf16_f32 v130, v132, v133
  v_cvt_pk_bf16_f32 v131, v134, v135
  v_exp_f32 v140, v140
  v_exp_f32 v141, v141
  v_exp_f32 v142, v142
  v_exp_f32 v143, v143
  v_cvt_pk_bf16_f32 v132, v136, v137
  v_cvt_pk_bf16_f32 v133, v138, v139
  v_cvt_pk_bf16_f32 v134, v140, v141
  v_cvt_pk_bf16_f32 v135, v142, v143
  v_and_b32 v8, v208, v128
  v_and_b32 v9, v209, v129
  v_and_b32 v10, v210, v130
  v_and_b32 v11, v211, v131
  v_and_b32 v12, v212, v132
  v_and_b32 v13, v213, v133
  v_and_b32 v14, v214, v134
  v_and_b32 v15, v215, v135
  v_xor_b32 v0, v128, v8
  v_xor_b32 v1, v129, v9
  v_xor_b32 v2, v130, v10
  v_xor_b32 v3, v131, v11
  v_xor_b32 v4, v132, v12
  v_xor_b32 v5, v133, v13
  v_xor_b32 v6, v134, v14
  v_xor_b32 v7, v135, v15
  s_waitcnt lgkmcnt(4)
  v_mfma_f32_32x32x16_bf16 v[192:207], v[184:187], v[8:11], v[192:207]
  v_mfma_f32_32x32x16_bf16 v[192:207], v[188:191], v[12:15], v[192:207]
  s_waitcnt lgkmcnt(0)
  v_mfma_f32_32x32x16_bf16 v[192:207], v[176:179], v[0:3], v[192:207]
  v_mfma_f32_32x32x16_bf16 v[192:207], v[180:183], v[4:7], v[192:207]
  s_setprio 0
  s_nop 10
  v_mov_b32 v224, v200
  v_mov_b32 v225, v200
  s_nop 1
  v_permlane32_swap_b32 v224, v225
  v_cmp_nle_f32 vcc, 0x30800000, v225
  v_mov_b32 v227, 0x4e800000
  v_cmp_nge_f32 s[78:79], v227, v225
  s_nop 1
  s_or_b64 vcc, vcc, s[78:79]
  s_cbranch_vccnz L_attfb_H
L_attnorm_H:
  v_rcp_f32 v226, v225
  s_nop 0
  v_pk_mul_f32 v[192:193], v[192:193], v[226:227] op_sel_hi:[1,0]
  v_pk_mul_f32 v[194:195], v[194:195], v[226:227] op_sel_hi:[1,0]
  v_pk_mul_f32 v[196:197], v[196:197], v[226:227] op_sel_hi:[1,0]
  v_pk_mul_f32 v[198:199], v[198:199], v[226:227] op_sel_hi:[1,0]
  v_pk_mul_f32 v[200:201], v[200:201], v[226:227] op_sel_hi:[1,0]
  v_pk_mul_f32 v[202:203], v[202:203], v[226:227] op_sel_hi:[1,0]
  v_cvt_pk_bf16_f32 v192, v192, v193
  v_cvt_pk_bf16_f32 v193, v194, v195
  v_cvt_pk_bf16_f32 v194, v196, v197
  v_cvt_pk_bf16_f32 v195, v198, v199
  v_cvt_pk_bf16_f32 v196, v200, v201
  v_cvt_pk_bf16_f32 v197, v202, v203
  s_cmp_eq_u32 s7, 0
  s_cbranch_scc1 L_slow_96
  buffer_store_dwordx4 v[192:195], v255, s[8:11], s90 offen
  s_branch L_join_97
L_slow_96:
  buffer_store_dwordx4 v[192:195], v255, s[8:11], s90 offen sc1
L_join_97:
  s_mov_b32 exec_hi, 0
  s_cmp_eq_u32 s7, 0
  s_cbranch_scc1 L_slow_98
  buffer_store_dwordx2 v[196:197], v223, s[8:11], s91 offen
  s_branch L_join_99
L_slow_98:
  buffer_store_dwordx2 v[196:197], v223, s[8:11], s91 offen sc1
L_join_99:
  s_mov_b32 exec_hi, -1
  s_waitcnt vmcnt(0)
  s_barrier
  s_barrier
  s_barrier
  s_add_u32 m0, s0, 0
  s_add_u32 s84, s12, 81920
  buffer_load_dwordx4 v230, s[8:11], s84 offen lds
  s_add_u32 m0, s0, 4096
  s_add_u32 s84, s12, 86016
  buffer_load_dwordx4 v230, s[8:11], s84 offen lds
  s_add_u32 m0, s0, 8192
  s_add_u32 s84, s12, 90112
  buffer_load_dwordx4 v230, s[8:11], s84 offen lds
  s_add_u32 m0, s0, 12288
  s_add_u32 s84, s12, 94208
  buffer_load_dwordx4 v230, s[8:11], s84 offen lds
  s_add_u32 m0, s0, 16384
  s_add_u32 s84, s12, 98304
  buffer_load_dwordx4 v230, s[8:11], s84 offen lds
  s_barrier
  s_add_u32 m0, s0, 20480
  s_add_u32 s84, s97, 0
  buffer_load_dwordx4 v230, s[8:11], s84 offen lds
  s_add_u32 m0, s0, 24576
  s_add_u32 s84, s97, 4096
  buffer_load_dwordx4 v230, s[8:11], s84 offen lds
  s_add_u32 m0, s0, 28672
  s_add_u32 s84, s97, 8192
  buffer_load_dwordx4 v230, s[8:11], s84 offen lds
  s_cmp_lt_u32 s2, 2
  s_cbranch_scc0 L_w3_100
  s_add_u32 m0, s0, 32768
  s_add_u32 s84, s97, 12288
  buffer_load_dwordx4 v230, s[8:11], s84 offen lds
L_w3_100:
  s_barrier
  s_add_u32 m0, s0, 34816
  s_add_u32 s84, s97, 14336
  buffer_load_dwordx4 v230, s[8:11], s84 offen lds
  s_add_u32 m0, s0, 38912
  s_add_u32 s84, s97, 18432
  buffer_load_dwordx4 v230, s[8:11], s84 offen lds
  s_add_u32 m0, s0, 43008
  s_add_u32 s84, s97, 22528
  buffer_load_dwordx4 v230, s[8:11], s84 offen lds
  s_cmp_lt_u32 s2, 2
  s_cbranch_scc0 L_w3_101
  s_add_u32 m0, s0, 47104
  s_add_u32 s84, s97, 26624
  buffer_load_dwordx4 v230, s[8:11], s84 offen lds
L_w3_101:
  s_waitcnt vmcnt(6)
  s_barrier
  s_add_u32 m0, s0, 49152
  s_add_u32 s84, s97, 28672
  buffer_load_dwordx4 v230, s[8:11], s84 offen lds
  s_add_u32 m0, s0, 53248
  s_add_u32 s84, s97, 32768
  buffer_load_dwordx4 v230, s[8:11], s84 offen lds
  s_add_u32 m0, s0, 57344
  s_add_u32 s84, s97, 36864
  buffer_load_dwordx4 v230, s[8:11], s84 offen lds
  s_cmp_lt_u32 s2, 2
  s_cbranch_scc0 L_w3_102
  s_add_u32 m0, s0, 61440
  s_add_u32 s84, s97, 40960
  buffer_load_dwordx4 v230, s[8:11], s84 offen lds
L_w3_102:
  s_barrier
  s_add_u32 m0, s0, 83968
  s_add_u32 s84, s97, 43008
  buffer_load_dwordx4 v230, s[8:11], s84 offen lds
  s_add_u32 m0, s0, 88064
  s_add_u32 s84, s97, 47104
  buffer_load_dwordx4 v230, s[8:11], s84 offen lds
  s_add_u32 m0, s0, 92160
  s_add_u32 s84, s97, 51200
  buffer_load_dwordx4 v230, s[8:11], s84 offen lds
  s_cmp_lt_u32 s2, 2
  s_cbranch_scc0 L_w3_103
  s_add_u32 m0, s0, 96256
  s_add_u32 s84, s97, 55296
  buffer_load_dwordx4 v230, s[8:11], s84 offen lds
L_w3_103:
  s_barrier
  s_barrier
  s_waitcnt vmcnt(9)
  s_barrier
  s_waitcnt vmcnt(6)
  s_barrier
  s_add_u32 m0, s0, 0
  s_add_u32 s84, s97, 57344
  buffer_load_dwordx4 v230, s[8:11], s84 offen lds
  s_add_u32 m0, s0, 4096
  s_add_u32 s84, s97, 61440
  buffer_load_dwordx4 v230, s[8:11], s84 offen lds
  s_add_u32 m0, s0, 8192
  s_add_u32 s84, s97, 65536
  buffer_load_dwordx4 v230, s[8:11], s84 offen lds
  s_cmp_lt_u32 s2, 2
  s_cbranch_scc0 L_w3_104
  s_add_u32 m0, s0, 12288
  s_add_u32 s84, s97, 69632
  buffer_load_dwordx4 v230, s[8:11], s84 offen lds
L_w3_104:
  s_add_u32 m0, s0, 63488
  s_add_u32 s84, s97, 71680
  buffer_load_dwordx4 v230, s[8:11], s84 offen lds
  s_add_u32 m0, s0, 67584
  s_add_u32 s84, s97, 75776
  buffer_load_dwordx4 v230, s[8:11], s84 offen lds
  s_add_u32 m0, s0, 71680
  s_add_u32 s84, s97, 79872
  buffer_load_dwordx4 v230, s[8:11], s84 offen lds
  s_cmp_lt_u32 s2, 2
  s_cbranch_scc0 L_w3_105
  s_add_u32 m0, s0, 75776
  s_add_u32 s84, s97, 83968
  buffer_load_dwordx4 v230, s[8:11], s84 offen lds
L_w3_105:
  s_waitcnt vmcnt(9)
  s_barrier
  s_lshl_b32 s85, s6, 1
  s_add_u32 s85, s85, 1
  s_lshl_b32 s85, s85, 18
  s_lshl_b32 s86, s3, 14
  s_add_u32 s85, s85, s86
  s_lshl_b32 s86, s2, 12
  s_add_u32 s85, s85, s86
  s_add_u32 s85, s85, 65536
  v_and_b32 v1, 31, v254
  v_lshlrev_b32 v1, 4, v1
  v_lshrrev_b32 v2, 5, v254
  v_lshl_add_u32 v1, v2, 11, v1
  buffer_load_dwordx4 v[8:11], v1, s[8:11], s85 offen offset:0 sc1
  buffer_load_dwordx4 v[12:15], v1, s[8:11], s85 offen offset:512 sc1
  buffer_load_dwordx4 v[16:19], v1, s[8:11], s85 offen offset:1024 sc1
  buffer_load_dwordx4 v[20:23], v1, s[8:11], s85 offen offset:1536 sc1
  s_add_u32 m0, s0, 14336
  s_add_u32 s84, s97, 86016
  buffer_load_dwordx4 v230, s[8:11], s84 offen lds
  s_add_u32 m0, s0, 18432
  s_add_u32 s84, s97, 90112
  buffer_load_dwordx4 v230, s[8:11], s84 offen lds
  s_add_u32 m0, s0, 22528
  s_add_u32 s84, s97, 94208
  buffer_load_dwordx4 v230, s[8:11], s84 offen lds
  s_cmp_lt_u32 s2, 2
  s_cbranch_scc0 L_w3_106
  s_add_u32 m0, s0, 26624
  s_add_u32 s84, s97, 98304
  buffer_load_dwordx4 v230, s[8:11], s84 offen lds
L_w3_106:
  s_add_u32 m0, s0, 98304
  s_add_u32 s84, s97, 100352
  buffer_load_dwordx4 v230, s[8:11], s84 offen lds
  s_add_u32 m0, s0, 102400
  s_add_u32 s84, s97, 104448
  buffer_load_dwordx4 v230, s[8:11], s84 offen lds
  s_add_u32 m0, s0, 106496
  s_add_u32 s84, s97, 108544
  buffer_load_dwordx4 v230, s[8:11], s84 offen lds
  s_cmp_lt_u32 s2, 2
  s_cbranch_scc0 L_w3_107
  s_add_u32 m0, s0, 110592
  s_add_u32 s84, s97, 112640
  buffer_load_dwordx4 v230, s[8:11], s84 offen lds
L_w3_107:
  s_waitcnt vmcnt(16)
  s_barrier
  s_waitcnt vmcnt(6)
  v_pk_add_f32 v[8:9], v[8:9], v[10:11]
  v_pk_add_f32 v[8:9], v[8:9], v[12:13]
  v_pk_add_f32 v[8:9], v[8:9], v[14:15]
  v_pk_add_f32 v[8:9], v[8:9], v[16:17]
  v_pk_add_f32 v[8:9], v[8:9], v[18:19]
  v_pk_add_f32 v[8:9], v[8:9], v[20:21]
  v_pk_add_f32 v[8:9], v[8:9], v[22:23]
  v_mov_b32 v10, v8
  v_mov_b32 v11, v9
  s_nop 0
  v_permlane32_swap_b32 v8, v10
  v_permlane32_swap_b32 v9, v11
  v_add_f32 v8, v8, v10
  v_add_f32 v9, v9, v11
  v_mul_f32 v8, 0x3acccccd, v8
  v_mul_f32 v9, 0x3acccccd, v9
  v_fma_f32 v9, -v8, v8, v9
  v_max_f32 v9, 0, v9
  v_add_f32 v9, 0x3727c5ac, v9
  v_rsq_f32 v9, v9
  v_sub_f32 v8, 0, v8
  v_cvt_pk_bf16_f32 v10, v8, v8
  v_and_b32 v11, 0xffff0000, v10
  v_sub_f32 v11, v8, v11
  v_cvt_pk_bf16_f32 v12, v8, v11
  v_and_b32 v13, 0xffff, v10
  v_mov_b32 v14, 0
  v_cndmask_b32 v12, v12, v14, s[64:65]
  v_cndmask_b32 v13, v13, v14, s[64:65]
  s_mul_i32 s85, s2, 768
  s_add_u32 s85, s85, 160768
  v_lshlrev_b32 v1, 3, v254
  v_add_u32 v1, s85, v1
  v_lshlrev_b32 v2, 2, v254
  v_add_u32 v2, s85, v2
  ds_write_b64 v1, v[12:13]
  ds_write_b32 v2, v9 offset:512
  s_waitcnt lgkmcnt(0)
  s_add_u32 m0, s0, 28672
  s_add_u32 s84, s97, 114688
  buffer_load_dwordx4 v230, s[8:11], s84 offen lds
  s_add_u32 m0, s0, 32768
  s_add_u32 s84, s97, 118784
  buffer_load_dwordx4 v230, s[8:11], s84 offen lds
  s_add_u32 m0, s0, 36864
  s_add_u32 s84, s97, 122880
  buffer_load_dwordx4 v230, s[8:11], s84 offen lds
  s_cmp_lt_u32 s2, 2
  s_cbranch_scc0 L_w3_108
  s_add_u32 m0, s0, 40960
  s_add_u32 s84, s97, 126976
  buffer_load_dwordx4 v230, s[8:11], s84 offen lds
L_w3_108:
  s_add_u32 m0, s0, 112640
  s_add_u32 s84, s97, 129024
  buffer_load_dwordx4 v230, s[8:11], s84 offen lds
  s_add_u32 m0, s0, 116736
  s_add_u32 s84, s97, 133120
  buffer_load_dwordx4 v230, s[8:11], s84 offen lds
  s_add_u32 m0, s0, 120832
  s_add_u32 s84, s97, 137216
  buffer_load_dwordx4 v230, s[8:11], s84 offen lds
  s_cmp_lt_u32 s2, 2
  s_cbranch_scc0 L_w3_109
  s_add_u32 m0, s0, 124928
  s_add_u32 s84, s97, 141312
  buffer_load_dwordx4 v230, s[8:11], s84 offen lds
L_w3_109:
  s_barrier
  s_add_u32 m0, s0, 43008
  s_add_u32 s84, s97, 143360
  buffer_load_dwordx4 v230, s[8:11], s84 offen lds
  s_add_u32 m0, s0, 47104
  s_add_u32 s84, s97, 147456
  buffer_load_dwordx4 v230, s[8:11], s84 offen lds
  s_add_u32 m0, s0, 51200
  s_add_u32 s84, s97, 151552
  buffer_load_dwordx4 v230, s[8:11], s84 offen lds
  s_cmp_lt_u32 s2, 2
  s_cbranch_scc0 L_w3_110
  s_add_u32 m0, s0, 55296
  s_add_u32 s84, s97, 155648
  buffer_load_dwordx4 v230, s[8:11], s84 offen lds
L_w3_110:
  s_barrier
  s_add_u32 m0, s0, 77824
  s_add_u32 s84, s97, 157696
  buffer_load_dwordx4 v230, s[8:11], s84 offen lds
  s_add_u32 m0, s0, 81920
  s_add_u32 s84, s97, 161792
  buffer_load_dwordx4 v230, s[8:11], s84 offen lds
  s_add_u32 m0, s0, 86016
  s_add_u32 s84, s97, 165888
  buffer_load_dwordx4 v230, s[8:11], s84 offen lds
  s_cmp_lt_u32 s2, 2
  s_cbranch_scc0 L_w3_111
  s_add_u32 m0, s0, 90112
  s_add_u32 s84, s97, 169984
  buffer_load_dwordx4 v230, s[8:11], s84 offen lds
L_w3_111:
  s_waitcnt vmcnt(15)
  s_barrier
  s_add_u32 m0, s0, 0
  s_add_u32 s84, s97, 172032
  buffer_load_dwordx4 v230, s[8:11], s84 offen lds
  s_add_u32 m0, s0, 4096
  s_add_u32 s84, s97, 176128
  buffer_load_dwordx4 v230, s[8:11], s84 offen lds
  s_add_u32 m0, s0, 8192
  s_add_u32 s84, s97, 180224
  buffer_load_dwordx4 v230, s[8:11], s84 offen lds
  s_cmp_lt_u32 s2, 2
  s_cbranch_scc0 L_w3_112
  s_add_u32 m0, s0, 12288
  s_add_u32 s84, s97, 184320
  buffer_load_dwordx4 v230, s[8:11], s84 offen lds
L_w3_112:
  s_waitcnt vmcnt(15)
  s_barrier
  s_add_u32 m0, s0, 57344
  s_add_u32 s84, s97, 186368
  buffer_load_dwordx4 v230, s[8:11], s84 offen lds
  s_add_u32 m0, s0, 61440
  s_add_u32 s84, s97, 190464
  buffer_load_dwordx4 v230, s[8:11], s84 offen lds
  s_add_u32 m0, s0, 65536
  s_add_u32 s84, s97, 194560
  buffer_load_dwordx4 v230, s[8:11], s84 offen lds
  s_cmp_lt_u32 s2, 2
  s_cbranch_scc0 L_w3_113
  s_add_u32 m0, s0, 69632
  s_add_u32 s84, s97, 198656
  buffer_load_dwordx4 v230, s[8:11], s84 offen lds
L_w3_113:
  s_waitcnt vmcnt(15)
  s_barrier
  s_add_u32 m0, s0, 14336
  s_add_u32 s84, s97, 200704
  buffer_load_dwordx4 v230, s[8:11], s84 offen lds
  s_add_u32 m0, s0, 18432
  s_add_u32 s84, s97, 204800
  buffer_load_dwordx4 v230, s[8:11], s84 offen lds
  s_add_u32 m0, s0, 22528
  s_add_u32 s84, s97, 208896
  buffer_load_dwordx4 v230, s[8:11], s84 offen lds
  s_cmp_lt_u32 s2, 2
  s_cbranch_scc0 L_w3_114
  s_add_u32 m0, s0, 26624
  s_add_u32 s84, s97, 212992
  buffer_load_dwordx4 v230, s[8:11], s84 offen lds
L_w3_114:
  s_waitcnt vmcnt(15)
  s_barrier
  s_add_u32 m0, s0, 92160
  s_add_u32 s84, s97, 215040
  buffer_load_dwordx4 v230, s[8:11], s84 offen lds
  s_add_u32 m0, s0, 96256
  s_add_u32 s84, s97, 219136
  buffer_load_dwordx4 v230, s[8:11], s84 offen lds
  s_add_u32 m0, s0, 100352
  s_add_u32 s84, s97, 223232
  buffer_load_dwordx4 v230, s[8:11], s84 offen lds
  s_cmp_lt_u32 s2, 2
  s_cbranch_scc0 L_w3_115
  s_add_u32 m0, s0, 104448
  s_add_u32 s84, s97, 227328
  buffer_load_dwordx4 v230, s[8:11], s84 offen lds
L_w3_115:
  s_waitcnt vmcnt(15)
  s_barrier
  s_lshl_b32 s85, s6, 4
  s_add_u32 s85, s85, s3
  s_mul_i32 s85, s85, 442368
  s_mul_i32 s86, s2, 110592
  s_add_u32 s85, s85, s86
  s_lshl_b32 s86, s69, 10
  s_add_u32 s85, s85, s86
  s_add_u32 s85, s85, 37748736
  v_min_u32 v1, 55, v254
  v_lshlrev_b32 v1, 7, v1
  buffer_load_dword v253, v1, s[8:11], s85 offen sc1
  s_add_u32 m0, s0, 28672
  s_add_u32 s84, s97, 229376
  buffer_load_dwordx4 v230, s[8:11], s84 offen lds
  s_add_u32 m0, s0, 32768
  s_add_u32 s84, s97, 233472
  buffer_load_dwordx4 v230, s[8:11], s84 offen lds
  s_add_u32 m0, s0, 36864
  s_add_u32 s84, s97, 237568
  buffer_load_dwordx4 v230, s[8:11], s84 offen lds
  s_cmp_lt_u32 s2, 2
  s_cbranch_scc0 L_w3_116
  s_add_u32 m0, s0, 40960
  s_add_u32 s84, s97, 241664
  buffer_load_dwordx4 v230, s[8:11], s84 offen lds
L_w3_116:
  s_waitcnt vmcnt(16)
  s_barrier
  s_add_u32 m0, s0, 106496
  s_add_u32 s84, s97, 243712
  buffer_load_dwordx4 v230, s[8:11], s84 offen lds
  s_add_u32 m0, s0, 110592
  s_add_u32 s84, s97, 247808
  buffer_load_dwordx4 v230, s[8:11], s84 offen lds
  s_add_u32 m0, s0, 114688
  s_add_u32 s84, s97, 251904
  buffer_load_dwordx4 v230, s[8:11], s84 offen lds
  s_cmp_lt_u32 s2, 2
  s_cbranch_scc0 L_w3_117
  s_add_u32 m0, s0, 118784
  s_add_u32 s84, s97, 256000
  buffer_load_dwordx4 v230, s[8:11], s84 offen lds
L_w3_117:
  s_waitcnt vmcnt(16)
  s_barrier
  s_add_u32 m0, s0, 43008
  s_add_u32 s84, s97, 258048
  buffer_load_dwordx4 v230, s[8:11], s84 offen lds
  s_add_u32 m0, s0, 47104
  s_add_u32 s84, s97, 262144
  buffer_load_dwordx4 v230, s[8:11], s84 offen lds
  s_add_u32 m0, s0, 51200
  s_add_u32 s84, s97, 266240
  buffer_load_dwordx4 v230, s[8:11], s84 offen lds
  s_cmp_lt_u32 s2, 2
  s_cbranch_scc0 L_w3_118
  s_add_u32 m0, s0, 55296
  s_add_u32 s84, s97, 270336
  buffer_load_dwordx4 v230, s[8:11], s84 offen lds
L_w3_118:
  s_waitcnt vmcnt(16)
  s_barrier
  s_add_u32 m0, s0, 120832
  s_add_u32 s84, s97, 272384
  buffer_load_dwordx4 v230, s[8:11], s84 offen lds
  s_add_u32 m0, s0, 124928
  s_add_u32 s84, s97, 276480
  buffer_load_dwordx4 v230, s[8:11], s84 offen lds
  s_add_u32 m0, s0, 129024
  s_add_u32 s84, s97, 280576
  buffer_load_dwordx4 v230, s[8:11], s84 offen lds
  s_cmp_lt_u32 s2, 2
  s_cbranch_scc0 L_w3_119
  s_add_u32 m0, s0, 133120
  s_add_u32 s84, s97, 284672
  buffer_load_dwordx4 v230, s[8:11], s84 offen lds
L_w3_119:
  s_waitcnt vmcnt(16)
  s_barrier
  s_cmp_eq_u32 s6, 0
  s_cbranch_scc0 L_l0_120
  s_lshl_b32 s85, s6, 1
  s_add_u32 s85, s85, 2
  s_mul_i32 s85, s85, 2621440
  s_mul_i32 s86, s3, 163840
  s_add_u32 s85, s85, s86
  s_and_b32 s86, s2, 1
  s_lshl_b32 s87, s68, 1
  s_add_u32 s86, s86, s87
  s_mul_i32 s87, s86, 40960
  s_add_u32 s85, s85, s87
  s_mul_i32 s87, s67, 5120
  s_add_u32 s85, s85, s87
  s_lshr_b32 s87, s2, 1
  s_mul_i32 s87, s87, 2560
  s_add_u32 s85, s85, s87
  s_add_u32 s85, s85, 25165824
  v_min_u32 v1, 19, v254
  v_lshlrev_b32 v1, 7, v1
  buffer_load_dword v253, v1, s[8:11], s85 offen sc1
  s_lshl_b32 s85, s6, 1
  s_add_u32 s85, s85, 2
  s_lshl_b32 s85, s85, 18
  s_lshl_b32 s86, s3, 14
  s_add_u32 s85, s85, s86
  s_and_b32 s86, s2, 1
  s_lshl_b32 s87, s68, 1
  s_add_u32 s86, s86, s87
  s_lshl_b32 s86, s86, 12
  s_add_u32 s85, s85, s86
  s_lshl_b32 s86, s67, 1
  s_lshr_b32 s87, s2, 1
  s_add_u32 s86, s86, s87
  s_lshl_b32 s86, s86, 8
  s_add_u32 s85, s85, s86
  s_add_u32 s85, s85, 65536
  v_and_b32 v1, 1, v254
  v_lshlrev_b32 v1, 7, v1
  buffer_load_dword v253, v1, s[8:11], s85 offen sc1
L_l0_120:
  s_add_u32 m0, s0, 135168
  s_add_u32 s84, s13, 0
  buffer_load_dwordx4 v230, s[8:11], s84 offen lds
  s_add_u32 m0, s0, 139264
  s_add_u32 s84, s13, 4096
  buffer_load_dwordx4 v230, s[8:11], s84 offen lds
  s_add_u32 m0, s0, 143360
  s_add_u32 s84, s13, 8192
  buffer_load_dwordx4 v230, s[8:11], s84 offen lds
  s_add_u32 m0, s0, 147456
  s_add_u32 s84, s13, 12288
  buffer_load_dwordx4 v230, s[8:11], s84 offen lds
  s_add_u32 m0, s0, 151552
  s_add_u32 s84, s13, 16384
  buffer_load_dwordx4 v230, s[8:11], s84 offen lds
  s_waitcnt vmcnt(18)
  s_barrier
  s_add_u32 m0, s0, 57344
  s_add_u32 s84, s13, 20480
  buffer_load_dwordx4 v230, s[8:11], s84 offen lds
  s_add_u32 m0, s0, 61440
  s_add_u32 s84, s13, 24576
  buffer_load_dwordx4 v230, s[8:11], s84 offen lds
  s_add_u32 m0, s0, 65536
  s_add_u32 s84, s13, 28672
  buffer_load_dwordx4 v230, s[8:11], s84 offen lds
  s_add_u32 m0, s0, 69632
  s_add_u32 s84, s13, 32768
  buffer_load_dwordx4 v230, s[8:11], s84 offen lds
  s_add_u32 m0, s0, 73728
  s_add_u32 s84, s13, 36864
  buffer_load_dwordx4 v230, s[8:11], s84 offen lds
  s_waitcnt vmcnt(19)
  s_barrier
  s_add_u32 m0, s0, 0
  s_add_u32 s84, s13, 40960
  buffer_load_dwordx4 v230, s[8:11], s84 offen lds
  s_add_u32 m0, s0, 4096
  s_add_u32 s84, s13, 45056
  buffer_load_dwordx4 v230, s[8:11], s84 offen lds
  s_add_u32 m0, s0, 8192
  s_add_u32 s84, s13, 49152
  buffer_load_dwordx4 v230, s[8:11], s84 offen lds
  s_add_u32 m0, s0, 12288
  s_add_u32 s84, s13, 53248
  buffer_load_dwordx4 v230, s[8:11], s84 offen lds
  s_add_u32 m0, s0, 16384
  s_add_u32 s84, s13, 57344
  buffer_load_dwordx4 v230, s[8:11], s84 offen lds
  s_waitcnt vmcnt(21)
  s_barrier
  s_add_u32 m0, s0, 77824
  s_add_u32 s84, s13, 61440
  buffer_load_dwordx4 v230, s[8:11], s84 offen lds
  s_add_u32 m0, s0, 81920
  s_add_u32 s84, s13, 65536
  buffer_load_dwordx4 v230, s[8:11], s84 offen lds
  s_add_u32 m0, s0, 86016
  s_add_u32 s84, s13, 69632
  buffer_load_dwordx4 v230, s[8:11], s84 offen lds
  s_add_u32 m0, s0, 90112
  s_add_u32 s84, s13, 73728
  buffer_load_dwordx4 v230, s[8:11], s84 offen lds
  s_add_u32 m0, s0, 94208
  s_add_u32 s84, s13, 77824
  buffer_load_dwordx4 v230, s[8:11], s84 offen lds
  s_waitcnt vmcnt(23)
  s_barrier
  s_add_u32 m0, s0, 20480
  s_add_u32 s84, s13, 81920
  buffer_load_dwordx4 v230, s[8:11], s84 offen lds
  s_add_u32 m0, s0, 24576
  s_add_u32 s84, s13, 86016
  buffer_load_dwordx4 v230, s[8:11], s84 offen lds
  s_add_u32 m0, s0, 28672
  s_add_u32 s84, s13, 90112
  buffer_load_dwordx4 v230, s[8:11], s84 offen lds
  s_add_u32 m0, s0, 32768
  s_add_u32 s84, s13, 94208
  buffer_load_dwordx4 v230, s[8:11], s84 offen lds
  s_add_u32 m0, s0, 36864
  s_add_u32 s84, s13, 98304
  buffer_load_dwordx4 v230, s[8:11], s84 offen lds
  s_waitcnt vmcnt(25)
  s_barrier
  s_barrier
  s_barrier
  s_waitcnt vmcnt(20)
  s_barrier
  s_waitcnt vmcnt(15)
  s_barrier
  s_add_u32 m0, s0, 98304
  s_add_u32 s84, s13, 102400
  buffer_load_dwordx4 v230, s[8:11], s84 offen lds
  s_add_u32 m0, s0, 102400
  s_add_u32 s84, s13, 106496
  buffer_load_dwordx4 v230, s[8:11], s84 offen lds
  s_add_u32 m0, s0, 106496
  s_add_u32 s84, s13, 110592
  buffer_load_dwordx4 v230, s[8:11], s84 offen lds
  s_add_u32 m0, s0, 110592
  s_add_u32 s84, s13, 114688
  buffer_load_dwordx4 v230, s[8:11], s84 offen lds
  s_add_u32 m0, s0, 114688
  s_add_u32 s84, s13, 118784
  buffer_load_dwordx4 v230, s[8:11], s84 offen lds
  s_waitcnt vmcnt(15)
  s_barrier
  s_add_u32 m0, s0, 118784
  s_add_u32 s84, s13, 122880
  buffer_load_dwordx4 v230, s[8:11], s84 offen lds
  s_add_u32 m0, s0, 122880
  s_add_u32 s84, s13, 126976
  buffer_load_dwordx4 v230, s[8:11], s84 offen lds
  s_add_u32 m0, s0, 126976
  s_add_u32 s84, s13, 131072
  buffer_load_dwordx4 v230, s[8:11], s84 offen lds
  s_add_u32 m0, s0, 131072
  s_add_u32 s84, s13, 135168
  buffer_load_dwordx4 v230, s[8:11], s84 offen lds
  s_add_u32 m0, s0, 135168
  s_add_u32 s84, s13, 139264
  buffer_load_dwordx4 v230, s[8:11], s84 offen lds
  s_waitcnt vmcnt(15)
  s_barrier
  s_add_u32 m0, s0, 40960
  s_add_u32 s84, s13, 143360
  buffer_load_dwordx4 v230, s[8:11], s84 offen lds
  s_add_u32 m0, s0, 45056
  s_add_u32 s84, s13, 147456
  buffer_load_dwordx4 v230, s[8:11], s84 offen lds
  s_add_u32 m0, s0, 49152
  s_add_u32 s84, s13, 151552
  buffer_load_dwordx4 v230, s[8:11], s84 offen lds
  s_add_u32 m0, s0, 53248
  s_add_u32 s84, s13, 155648
  buffer_load_dwordx4 v230, s[8:11], s84 offen lds
  s_add_u32 m0, s0, 57344
  s_add_u32 s84, s13, 159744
  buffer_load_dwordx4 v230, s[8:11], s84 offen lds
  s_waitcnt vmcnt(15)
  s_barrier
  s_add_u32 m0, s0, 0
  s_add_u32 s84, s13, 163840
  buffer_load_dwordx4 v230, s[8:11], s84 offen lds
  s_add_u32 m0, s0, 4096
  s_add_u32 s84, s13, 167936
  buffer_load_dwordx4 v230, s[8:11], s84 offen lds
  s_add_u32 m0, s0, 8192
  s_add_u32 s84, s13, 172032
  buffer_load_dwordx4 v230, s[8:11], s84 offen lds
  s_add_u32 m0, s0, 12288
  s_add_u32 s84, s13, 176128
  buffer_load_dwordx4 v230, s[8:11], s84 offen lds
  s_add_u32 m0, s0, 16384
  s_add_u32 s84, s13, 180224
  buffer_load_dwordx4 v230, s[8:11], s84 offen lds
  s_waitcnt vmcnt(15)
  s_barrier
  s_add_u32 m0, s0, 61440
  s_add_u32 s84, s13, 184320
  buffer_load_dwordx4 v230, s[8:11], s84 offen lds
  s_add_u32 m0, s0, 65536
  s_add_u32 s84, s13, 188416
  buffer_load_dwordx4 v230, s[8:11], s84 offen lds
  s_add_u32 m0, s0, 69632
  s_add_u32 s84, s13, 192512
  buffer_load_dwordx4 v230, s[8:11], s84 offen lds
  s_add_u32 m0, s0, 73728
  s_add_u32 s84, s13, 196608
  buffer_load_dwordx4 v230, s[8:11], s84 offen lds
  s_add_u32 m0, s0, 77824
  s_add_u32 s84, s13, 200704
  buffer_load_dwordx4 v230, s[8:11], s84 offen lds
  s_waitcnt vmcnt(15)
  s_barrier
  s_add_u32 m0, s0, 20480
  s_add_u32 s84, s13, 204800
  buffer_load_dwordx4 v230, s[8:11], s84 offen lds
  s_add_u32 m0, s0, 24576
  s_add_u32 s84, s13, 208896
  buffer_load_dwordx4 v230, s[8:11], s84 offen lds
  s_add_u32 m0, s0, 28672
  s_add_u32 s84, s13, 212992
  buffer_load_dwordx4 v230, s[8:11], s84 offen lds
  s_add_u32 m0, s0, 32768
  s_add_u32 s84, s13, 217088
  buffer_load_dwordx4 v230, s[8:11], s84 offen lds
  s_add_u32 m0, s0, 36864
  s_add_u32 s84, s13, 221184
  buffer_load_dwordx4 v230, s[8:11], s84 offen lds
  s_waitcnt vmcnt(15)
  s_barrier
  s_add_u32 m0, s0, 81920
  s_add_u32 s84, s13, 225280
  buffer_load_dwordx4 v230, s[8:11], s84 offen lds
  s_add_u32 m0, s0, 86016
  s_add_u32 s84, s13, 229376
  buffer_load_dwordx4 v230, s[8:11], s84 offen lds
  s_add_u32 m0, s0, 90112
  s_add_u32 s84, s13, 233472
  buffer_load_dwordx4 v230, s[8:11], s84 offen lds
  s_add_u32 m0, s0, 94208
  s_add_u32 s84, s13, 237568
  buffer_load_dwordx4 v230, s[8:11], s84 offen lds
  s_add_u32 m0, s0, 98304
  s_add_u32 s84, s13, 241664
  buffer_load_dwordx4 v230, s[8:11], s84 offen lds
  s_waitcnt vmcnt(15)
  s_barrier
  s_add_u32 m0, s0, 102400
  s_add_u32 s84, s13, 245760
  buffer_load_dwordx4 v230, s[8:11], s84 offen lds
  s_add_u32 m0, s0, 106496
  s_add_u32 s84, s13, 249856
  buffer_load_dwordx4 v230, s[8:11], s84 offen lds
  s_add_u32 m0, s0, 110592
  s_add_u32 s84, s13, 253952
  buffer_load_dwordx4 v230, s[8:11], s84 offen lds
  s_add_u32 m0, s0, 114688
  s_add_u32 s84, s13, 258048
  buffer_load_dwordx4 v230, s[8:11], s84 offen lds
  s_add_u32 m0, s0, 118784
  s_add_u32 s84, s13, 262144
  buffer_load_dwordx4 v230, s[8:11], s84 offen lds
  s_waitcnt vmcnt(15)
  s_barrier
  s_add_u32 m0, s0, 40960
  s_add_u32 s84, s13, 266240
  buffer_load_dwordx4 v230, s[8:11], s84 offen lds
  s_add_u32 m0, s0, 45056
  s_add_u32 s84, s13, 270336
  buffer_load_dwordx4 v230, s[8:11], s84 offen lds
  s_add_u32 m0, s0, 49152
  s_add_u32 s84, s13, 274432
  buffer_load_dwordx4 v230, s[8:11], s84 offen lds
  s_waitcnt vmcnt(13)
  s_barrier
  s_waitcnt vmcnt(8)
  s_barrier
  s_cmp_eq_u32 s6, 0
  s_cbranch_scc0 L_nx_121
  s_add_u32 m0, s0, 0
  s_add_u32 s84, s66, 0
  buffer_load_dwordx4 v230, s[8:11], s84 offen lds
  s_add_u32 m0, s0, 4096
  s_add_u32 s84, s66, 4096
  buffer_load_dwordx4 v230, s[8:11], s84 offen lds
  s_add_u32 m0, s0, 8192
  s_add_u32 s84, s66, 8192
  buffer_load_dwordx4 v230, s[8:11], s84 offen lds
  s_add_u32 m0, s0, 12288
  s_add_u32 s84, s66, 12288
  buffer_load_dwordx4 v230, s[8:11], s84 offen lds
L_nx_121:
  s_waitcnt vmcnt(3)
  s_barrier
  s_cmp_eq_u32 s6, 0
  s_cbranch_scc0 L_nx_122
  s_add_u32 m0, s0, 16384
  s_add_u32 s84, s66, 16384
  buffer_load_dwordx4 v230, s[8:11], s84 offen lds
  s_add_u32 m0, s0, 20480
  s_add_u32 s84, s66, 20480
  buffer_load_dwordx4 v230, s[8:11], s84 offen lds
  s_add_u32 m0, s0, 24576
  s_add_u32 s84, s66, 24576
  buffer_load_dwordx4 v230, s[8:11], s84 offen lds
  s_add_u32 m0, s0, 28672
  s_add_u32 s84, s66, 28672
  buffer_load_dwordx4 v230, s[8:11], s84 offen lds
  s_add_u32 m0, s0, 61440
  s_add_u32 s84, s66, 32768
  buffer_load_dwordx4 v230, s[8:11], s84 offen lds
  s_add_u32 m0, s0, 65536
  s_add_u32 s84, s66, 36864
  buffer_load_dwordx4 v230, s[8:11], s84 offen lds
  s_add_u32 m0, s0, 69632
  s_add_u32 s84, s66, 40960
  buffer_load_dwordx4 v230, s[8:11], s84 offen lds
  s_add_u32 m0, s0, 73728
  s_add_u32 s84, s66, 45056
  buffer_load_dwordx4 v230, s[8:11], s84 offen lds
L_nx_122:
  s_waitcnt vmcnt(0)
  s_barrier
  s_cmp_eq_u32 s6, 0
  s_cbranch_scc0 L_nx_123
  s_add_u32 m0, s0, 77824
  s_add_u32 s84, s66, 49152
  buffer_load_dwordx4 v230, s[8:11], s84 offen lds
  s_add_u32 m0, s0, 81920
  s_add_u32 s84, s66, 53248
  buffer_load_dwordx4 v230, s[8:11], s84 offen lds
  s_add_u32 m0, s0, 86016
  s_add_u32 s84, s66, 57344
  buffer_load_dwordx4 v230, s[8:11], s84 offen lds
  s_add_u32 m0, s0, 90112
  s_add_u32 s84, s66, 61440
  buffer_load_dwordx4 v230, s[8:11], s84 offen lds
L_nx_123:
  s_barrier
  s_barrier
  s_cmp_eq_u32 s6, 1
  s_cbranch_scc0 L_notlast_124
  s_waitcnt vmcnt(0)
  s_endpgm
L_notlast_124:
  s_barrier
  s_mov_b32 s6, 1
  s_branch L_H_layer
L_attfb_P:
  ds_read_b128 v[152:155], v220 offset:0
  ds_read_b64 v[156:157], v221 offset:2048
  v_mov_b32 v158, s70
  ds_read_b128 v[160:163], v220 offset:20480
  ds_read_b64 v[164:165], v221 offset:22528
  v_mov_b32 v166, 0
  ds_read_b128 v[168:171], v220 offset:2560
  ds_read_b64 v[172:173], v221 offset:4608
  v_mov_b32 v174, s71
  s_waitcnt lgkmcnt(4)
  v_mfma_f32_32x32x16_bf16 v[0:15], v[152:155], v[144:147], 0
  v_mfma_f32_32x32x16_bf16 v[0:15], v[156:159], v[148:151], v[0:15]
  ds_read_b128 v[152:155], v220 offset:5120
  ds_read_b64 v[156:157], v221 offset:7168
  v_mov_b32 v158, s72
  s_waitcnt lgkmcnt(4)
  v_mfma_f32_32x32x16_bf16 v[128:143], v[160:163], v[144:147], 0
  v_mfma_f32_32x32x16_bf16 v[128:143], v[164:167], v[148:151], v[128:143]
  ds_read_b128 v[160:163], v220 offset:7680
  ds_read_b64 v[164:165], v221 offset:9728
  v_mov_b32 v166, s73
  s_waitcnt lgkmcnt(4)
  v_mfma_f32_32x32x16_bf16 v[16:31], v[168:171], v[144:147], 0
  v_mfma_f32_32x32x16_bf16 v[16:31], v[172:175], v[148:151], v[16:31]
  ds_read_b128 v[168:171], v220 offset:10240
  ds_read_b64 v[172:173], v221 offset:12288
  v_mov_b32 v174, s74
  s_waitcnt lgkmcnt(4)
  v_mfma_f32_32x32x16_bf16 v[32:47], v[152:155], v[144:147], 0
  v_cndmask_b32 v128, v0, v128, s[32:33]
  v_cndmask_b32 v129, v1, v129, s[34:35]
  v_cndmask_b32 v130, v2, v130, s[36:37]
  v_cndmask_b32 v131, v3, v131, s[38:39]
  v_cndmask_b32 v132, v4, v132, s[40:41]
  v_cndmask_b32 v133, v5, v133, s[42:43]
  v_mfma_f32_32x32x16_bf16 v[32:47], v[156:159], v[148:151], v[32:47]
  v_cndmask_b32 v134, v6, v134, s[44:45]
  v_cndmask_b32 v135, v7, v135, s[46:47]
  v_cndmask_b32 v136, v8, v136, s[48:49]
  v_cndmask_b32 v137, v9, v137, s[50:51]
  v_cndmask_b32 v138, v10, v138, s[52:53]
  v_cndmask_b32 v139, v11, v139, s[54:55]
  ds_read_b128 v[152:155], v220 offset:12800
  ds_read_b64 v[156:157], v221 offset:14848
  v_mov_b32 v158, s75
  s_waitcnt lgkmcnt(4)
  v_mfma_f32_32x32x16_bf16 v[48:63], v[160:163], v[144:147], 0
  v_cndmask_b32 v140, v12, v140, s[56:57]
  v_cndmask_b32 v141, v13, v141, s[58:59]
  v_cndmask_b32 v142, v14, v142, s[60:61]
  v_cndmask_b32 v143, v15, v143, s[62:63]
  v_max_f32 v216, v128, v129
  v_max3_f32 v216, v130, v131, v216
  v_mfma_f32_32x32x16_bf16 v[48:63], v[164:167], v[148:151], v[48:63]
  v_max3_f32 v216, v132, v133, v216
  v_max3_f32 v216, v134, v135, v216
  v_max3_f32 v216, v136, v137, v216
  v_max3_f32 v216, v138, v139, v216
  v_max3_f32 v216, v140, v141, v216
  v_max3_f32 v216, v142, v143, v216
  ds_read_b128 v[160:163], v220 offset:15360
  ds_read_b64 v[164:165], v221 offset:17408
  v_mov_b32 v166, s76
  s_waitcnt lgkmcnt(4)
  v_mfma_f32_32x32x16_bf16 v[64:79], v[168:171], v[144:147], 0
  v_max3_f32 v216, v16, v17, v216
  v_max3_f32 v216, v18, v19, v216
  v_max3_f32 v216, v20, v21, v216
  v_max3_f32 v216, v22, v23, v216
  v_max3_f32 v216, v24, v25, v216
  v_max3_f32 v216, v26, v27, v216
  v_mfma_f32_32x32x16_bf16 v[64:79], v[172:175], v[148:151], v[64:79]
  v_max3_f32 v216, v28, v29, v216
  v_max3_f32 v216, v30, v31, v216
  v_max3_f32 v216, v32, v33, v216
  v_max3_f32 v216, v34, v35, v216
  v_max3_f32 v216, v36, v37, v216
  v_max3_f32 v216, v38, v39, v216
  ds_read_b128 v[168:171], v220 offset:17920
  ds_read_b64 v[172:173], v221 offset:19968
  v_mov_b32 v174, s77
  s_waitcnt lgkmcnt(4)
  v_mfma_f32_32x32x16_bf16 v[80:95], v[152:155], v[144:147], 0
  v_max3_f32 v216, v40, v41, v216
  v_max3_f32 v216, v42, v43, v216
  v_max3_f32 v216, v44, v45, v216
  v_max3_f32 v216, v46, v47, v216
  v_max3_f32 v216, v48, v49, v216
  v_max3_f32 v216, v50, v51, v216
  v_mfma_f32_32x32x16_bf16 v[80:95], v[156:159], v[148:151], v[80:95]
  v_max3_f32 v216, v52, v53, v216
  v_max3_f32 v216, v54, v55, v216
  v_max3_f32 v216, v56, v57, v216
  v_max3_f32 v216, v58, v59, v216
  v_max3_f32 v216, v60, v61, v216
  v_max3_f32 v216, v62, v63, v216
  s_waitcnt lgkmcnt(2)
  v_mfma_f32_32x32x16_bf16 v[96:111], v[160:163], v[144:147], 0
  v_max3_f32 v216, v64, v65, v216
  v_max3_f32 v216, v66, v67, v216
  v_max3_f32 v216, v68, v69, v216
  v_max3_f32 v216, v70, v71, v216
  v_max3_f32 v216, v72, v73, v216
  v_max3_f32 v216, v74, v75, v216
  v_mfma_f32_32x32x16_bf16 v[96:111], v[164:167], v[148:151], v[96:111]
  v_max3_f32 v216, v76, v77, v216
  v_max3_f32 v216, v78, v79, v216
  s_waitcnt lgkmcnt(0)
  v_mfma_f32_32x32x16_bf16 v[112:127], v[168:171], v[144:147], 0
  v_max3_f32 v216, v80, v81, v216
  v_max3_f32 v216, v82, v83, v216
  v_max3_f32 v216, v84, v85, v216
  v_max3_f32 v216, v86, v87, v216
  v_max3_f32 v216, v88, v89, v216
  v_max3_f32 v216, v90, v91, v216
  v_mfma_f32_32x32x16_bf16 v[112:127], v[172:175], v[148:151], v[112:127]
  v_max3_f32 v216, v92, v93, v216
  v_max3_f32 v216, v94, v95, v216
  v_max3_f32 v216, v96, v97, v216
  v_max3_f32 v216, v98, v99, v216
  v_max3_f32 v216, v100, v101, v216
  v_max3_f32 v216, v102, v103, v216
  v_max3_f32 v216, v104, v105, v216
  v_max3_f32 v216, v106, v107, v216
  v_max3_f32 v216, v108, v109, v216
  v_max3_f32 v216, v110, v111, v216
  s_nop 1
  v_max3_f32 v216, v112, v113, v216
  v_max3_f32 v216, v114, v115, v216
  v_max3_f32 v216, v116, v117, v216
  v_max3_f32 v216, v118, v119, v216
  v_max3_f32 v216, v120, v121, v216
  v_max3_f32 v216, v122, v123, v216
  v_max3_f32 v216, v124, v125, v216
  v_max3_f32 v216, v126, v127, v216
  v_mov_b32 v217, v216
  s_nop 1
  v_permlane32_swap_b32 v216, v217
  v_max_f32 v216, v216, v217
  v_sub_f32 v218, 0, v216
  ds_read_b64_tr_b16 v[176:177], v222 offset:1536
  ds_read_b64_tr_b16 v[178:179], v222 offset:1920
  ds_read_b64_tr_b16 v[180:181], v222 offset:2304
  ds_read_b64_tr_b16 v[182:183], v222 offset:2688
  ds_read_b64_tr_b16 v[184:185], v222 offset:3072
  ds_read_b64_tr_b16 v[186:187], v222 offset:3456
  ds_read_b64_tr_b16 v[188:189], v222 offset:3840
  ds_read_b64_tr_b16 v[190:191], v222 offset:4224
  v_pk_add_f32 v[16:17], v[16:17], v[218:219] op_sel_hi:[1,0]
  v_pk_add_f32 v[18:19], v[18:19], v[218:219] op_sel_hi:[1,0]
  v_exp_f32 v16, v16
  v_exp_f32 v17, v17
  v_exp_f32 v18, v18
  v_exp_f32 v19, v19
  v_pk_add_f32 v[20:21], v[20:21], v[218:219] op_sel_hi:[1,0]
  v_pk_add_f32 v[22:23], v[22:23], v[218:219] op_sel_hi:[1,0]
  v_exp_f32 v20, v20
  v_exp_f32 v21, v21
  v_exp_f32 v22, v22
  v_exp_f32 v23, v23
  v_cvt_pk_bf16_f32 v16, v16, v17
  v_cvt_pk_bf16_f32 v17, v18, v19
  v_pk_add_f32 v[24:25], v[24:25], v[218:219] op_sel_hi:[1,0]
  v_pk_add_f32 v[26:27], v[26:27], v[218:219] op_sel_hi:[1,0]
  v_exp_f32 v24, v24
  v_exp_f32 v25, v25
  v_exp_f32 v26, v26
  v_exp_f32 v27, v27
  v_cvt_pk_bf16_f32 v18, v20, v21
  v_cvt_pk_bf16_f32 v19, v22, v23
  v_pk_add_f32 v[28:29], v[28:29], v[218:219] op_sel_hi:[1,0]
  v_pk_add_f32 v[30:31], v[30:31], v[218:219] op_sel_hi:[1,0]
  v_exp_f32 v28, v28
  v_exp_f32 v29, v29
  v_exp_f32 v30, v30
  v_exp_f32 v31, v31
  v_cvt_pk_bf16_f32 v20, v24, v25
  v_cvt_pk_bf16_f32 v21, v26, v27
  v_cvt_pk_bf16_f32 v22, v28, v29
  v_cvt_pk_bf16_f32 v23, v30, v31
  v_pk_add_f32 v[32:33], v[32:33], v[218:219] op_sel_hi:[1,0]
  s_waitcnt lgkmcnt(4)
  v_mfma_f32_32x32x16_bf16 v[192:207], v[176:179], v[16:19], 0
  v_pk_add_f32 v[34:35], v[34:35], v[218:219] op_sel_hi:[1,0]
  v_exp_f32 v32, v32
  v_exp_f32 v33, v33
  v_exp_f32 v34, v34
  v_mfma_f32_32x32x16_bf16 v[192:207], v[180:183], v[20:23], v[192:207]
  ds_read_b64_tr_b16 v[176:177], v222 offset:4608
  ds_read_b64_tr_b16 v[178:179], v222 offset:4992
  ds_read_b64_tr_b16 v[180:181], v222 offset:5376
  ds_read_b64_tr_b16 v[182:183], v222 offset:5760
  v_exp_f32 v35, v35
  v_pk_add_f32 v[36:37], v[36:37], v[218:219] op_sel_hi:[1,0]
  v_pk_add_f32 v[38:39], v[38:39], v[218:219] op_sel_hi:[1,0]
  v_exp_f32 v36, v36
  v_exp_f32 v37, v37
  v_exp_f32 v38, v38
  v_exp_f32 v39, v39
  v_cvt_pk_bf16_f32 v32, v32, v33
  v_cvt_pk_bf16_f32 v33, v34, v35
  v_pk_add_f32 v[40:41], v[40:41], v[218:219] op_sel_hi:[1,0]
  v_pk_add_f32 v[42:43], v[42:43], v[218:219] op_sel_hi:[1,0]
  v_exp_f32 v40, v40
  v_exp_f32 v41, v41
  v_exp_f32 v42, v42
  v_exp_f32 v43, v43
  v_cvt_pk_bf16_f32 v34, v36, v37
  v_cvt_pk_bf16_f32 v35, v38, v39
  v_pk_add_f32 v[44:45], v[44:45], v[218:219] op_sel_hi:[1,0]
  v_pk_add_f32 v[46:47], v[46:47], v[218:219] op_sel_hi:[1,0]
  v_exp_f32 v44, v44
  v_exp_f32 v45, v45
  v_exp_f32 v46, v46
  v_exp_f32 v47, v47
  v_cvt_pk_bf16_f32 v36, v40, v41
  v_cvt_pk_bf16_f32 v37, v42, v43
  v_cvt_pk_bf16_f32 v38, v44, v45
  v_cvt_pk_bf16_f32 v39, v46, v47
  v_pk_add_f32 v[48:49], v[48:49], v[218:219] op_sel_hi:[1,0]
  s_waitcnt lgkmcnt(4)
  v_mfma_f32_32x32x16_bf16 v[192:207], v[184:187], v[32:35], v[192:207]
  v_pk_add_f32 v[50:51], v[50:51], v[218:219] op_sel_hi:[1,0]
  v_exp_f32 v48, v48
  v_exp_f32 v49, v49
  v_exp_f32 v50, v50
  v_mfma_f32_32x32x16_bf16 v[192:207], v[188:191], v[36:39], v[192:207]
  ds_read_b64_tr_b16 v[184:185], v222 offset:6144
  ds_read_b64_tr_b16 v[186:187], v222 offset:6528
  ds_read_b64_tr_b16 v[188:189], v222 offset:6912
  ds_read_b64_tr_b16 v[190:191], v222 offset:7296
  v_exp_f32 v51, v51
  v_pk_add_f32 v[52:53], v[52:53], v[218:219] op_sel_hi:[1,0]
  v_pk_add_f32 v[54:55], v[54:55], v[218:219] op_sel_hi:[1,0]
  v_exp_f32 v52, v52
  v_exp_f32 v53, v53
  v_exp_f32 v54, v54
  v_exp_f32 v55, v55
  v_cvt_pk_bf16_f32 v48, v48, v49
  v_cvt_pk_bf16_f32 v49, v50, v51
  v_pk_add_f32 v[56:57], v[56:57], v[218:219] op_sel_hi:[1,0]
  v_pk_add_f32 v[58:59], v[58:59], v[218:219] op_sel_hi:[1,0]
  v_exp_f32 v56, v56
  v_exp_f32 v57, v57
  v_exp_f32 v58, v58
  v_exp_f32 v59, v59
  v_cvt_pk_bf16_f32 v50, v52, v53
  v_cvt_pk_bf16_f32 v51, v54, v55
  v_pk_add_f32 v[60:61], v[60:61], v[218:219] op_sel_hi:[1,0]
  v_pk_add_f32 v[62:63], v[62:63], v[218:219] op_sel_hi:[1,0]
  v_exp_f32 v60, v60
  v_exp_f32 v61, v61
  v_exp_f32 v62, v62
  v_exp_f32 v63, v63
  v_cvt_pk_bf16_f32 v52, v56, v57
  v_cvt_pk_bf16_f32 v53, v58, v59
  v_cvt_pk_bf16_f32 v54, v60, v61
  v_cvt_pk_bf16_f32 v55, v62, v63
  v_pk_add_f32 v[64:65], v[64:65], v[218:219] op_sel_hi:[1,0]
  s_waitcnt lgkmcnt(4)
  v_mfma_f32_32x32x16_bf16 v[192:207], v[176:179], v[48:51], v[192:207]
  v_pk_add_f32 v[66:67], v[66:67], v[218:219] op_sel_hi:[1,0]
  v_exp_f32 v64, v64
  v_exp_f32 v65, v65
  v_exp_f32 v66, v66
  v_mfma_f32_32x32x16_bf16 v[192:207], v[180:183], v[52:55], v[192:207]
  ds_read_b64_tr_b16 v[176:177], v222 offset:7680
  ds_read_b64_tr_b16 v[178:179], v222 offset:8064
  ds_read_b64_tr_b16 v[180:181], v222 offset:8448
  ds_read_b64_tr_b16 v[182:183], v222 offset:8832
  v_exp_f32 v67, v67
  v_pk_add_f32 v[68:69], v[68:69], v[218:219] op_sel_hi:[1,0]
  v_pk_add_f32 v[70:71], v[70:71], v[218:219] op_sel_hi:[1,0]
  v_exp_f32 v68, v68
  v_exp_f32 v69, v69
  v_exp_f32 v70, v70
  v_exp_f32 v71, v71
  v_cvt_pk_bf16_f32 v64, v64, v65
  v_cvt_pk_bf16_f32 v65, v66, v67
  v_pk_add_f32 v[72:73], v[72:73], v[218:219] op_sel_hi:[1,0]
  v_pk_add_f32 v[74:75], v[74:75], v[218:219] op_sel_hi:[1,0]
  v_exp_f32 v72, v72
  v_exp_f32 v73, v73
  v_exp_f32 v74, v74
  v_exp_f32 v75, v75
  v_cvt_pk_bf16_f32 v66, v68, v69
  v_cvt_pk_bf16_f32 v67, v70, v71
  v_pk_add_f32 v[76:77], v[76:77], v[218:219] op_sel_hi:[1,0]
  v_pk_add_f32 v[78:79], v[78:79], v[218:219] op_sel_hi:[1,0]
  v_exp_f32 v76, v76
  v_exp_f32 v77, v77
  v_exp_f32 v78, v78
  v_exp_f32 v79, v79
  v_cvt_pk_bf16_f32 v68, v72, v73
  v_cvt_pk_bf16_f32 v69, v74, v75
  v_cvt_pk_bf16_f32 v70, v76, v77
  v_cvt_pk_bf16_f32 v71, v78, v79
  v_pk_add_f32 v[80:81], v[80:81], v[218:219] op_sel_hi:[1,0]
  s_waitcnt lgkmcnt(4)
  v_mfma_f32_32x32x16_bf16 v[192:207], v[184:187], v[64:67], v[192:207]
  v_pk_add_f32 v[82:83], v[82:83], v[218:219] op_sel_hi:[1,0]
  v_exp_f32 v80, v80
  v_exp_f32 v81, v81
  v_exp_f32 v82, v82
  v_mfma_f32_32x32x16_bf16 v[192:207], v[188:191], v[68:71], v[192:207]
  ds_read_b64_tr_b16 v[184:185], v222 offset:9216
  ds_read_b64_tr_b16 v[186:187], v222 offset:9600
  ds_read_b64_tr_b16 v[188:189], v222 offset:9984
  ds_read_b64_tr_b16 v[190:191], v222 offset:10368
  v_exp_f32 v83, v83
  v_pk_add_f32 v[84:85], v[84:85], v[218:219] op_sel_hi:[1,0]
  v_pk_add_f32 v[86:87], v[86:87], v[218:219] op_sel_hi:[1,0]
  v_exp_f32 v84, v84
  v_exp_f32 v85, v85
  v_exp_f32 v86, v86
  v_exp_f32 v87, v87
  v_cvt_pk_bf16_f32 v80, v80, v81
  v_cvt_pk_bf16_f32 v81, v82, v83
  v_pk_add_f32 v[88:89], v[88:89], v[218:219] op_sel_hi:[1,0]
  v_pk_add_f32 v[90:91], v[90:91], v[218:219] op_sel_hi:[1,0]
  v_exp_f32 v88, v88
  v_exp_f32 v89, v89
  v_exp_f32 v90, v90
  v_exp_f32 v91, v91
  v_cvt_pk_bf16_f32 v82, v84, v85
  v_cvt_pk_bf16_f32 v83, v86, v87
  v_pk_add_f32 v[92:93], v[92:93], v[218:219] op_sel_hi:[1,0]
  v_pk_add_f32 v[94:95], v[94:95], v[218:219] op_sel_hi:[1,0]
  v_exp_f32 v92, v92
  v_exp_f32 v93, v93
  v_exp_f32 v94, v94
  v_exp_f32 v95, v95
  v_cvt_pk_bf16_f32 v84, v88, v89
  v_cvt_pk_bf16_f32 v85, v90, v91
  v_cvt_pk_bf16_f32 v86, v92, v93
  v_cvt_pk_bf16_f32 v87, v94, v95
  v_pk_add_f32 v[96:97], v[96:97], v[218:219] op_sel_hi:[1,0]
  s_waitcnt lgkmcnt(4)
  v_mfma_f32_32x32x16_bf16 v[192:207], v[176:179], v[80:83], v[192:207]
  v_pk_add_f32 v[98:99], v[98:99], v[218:219] op_sel_hi:[1,0]
  v_exp_f32 v96, v96
  v_exp_f32 v97, v97
  v_exp_f32 v98, v98
  v_mfma_f32_32x32x16_bf16 v[192:207], v[180:183], v[84:87], v[192:207]
  ds_read_b64_tr_b16 v[176:177], v222 offset:10752
  ds_read_b64_tr_b16 v[178:179], v222 offset:11136
  ds_read_b64_tr_b16 v[180:181], v222 offset:11520
  ds_read_b64_tr_b16 v[182:183], v222 offset:11904
  v_exp_f32 v99, v99
  v_pk_add_f32 v[100:101], v[100:101], v[218:219] op_sel_hi:[1,0]
  v_pk_add_f32 v[102:103], v[102:103], v[218:219] op_sel_hi:[1,0]
  v_exp_f32 v100, v100
  v_exp_f32 v101, v101
  v_exp_f32 v102, v102
  v_exp_f32 v103, v103
  v_cvt_pk_bf16_f32 v96, v96, v97
  v_cvt_pk_bf16_f32 v97, v98, v99
  v_pk_add_f32 v[104:105], v[104:105], v[218:219] op_sel_hi:[1,0]
  v_pk_add_f32 v[106:107], v[106:107], v[218:219] op_sel_hi:[1,0]
  v_exp_f32 v104, v104
  v_exp_f32 v105, v105
  v_exp_f32 v106, v106
  v_exp_f32 v107, v107
  v_cvt_pk_bf16_f32 v98, v100, v101
  v_cvt_pk_bf16_f32 v99, v102, v103
  v_pk_add_f32 v[108:109], v[108:109], v[218:219] op_sel_hi:[1,0]
  v_pk_add_f32 v[110:111], v[110:111], v[218:219] op_sel_hi:[1,0]
  v_exp_f32 v108, v108
  v_exp_f32 v109, v109
  v_exp_f32 v110, v110
  v_exp_f32 v111, v111
  v_cvt_pk_bf16_f32 v100, v104, v105
  v_cvt_pk_bf16_f32 v101, v106, v107
  v_cvt_pk_bf16_f32 v102, v108, v109
  v_cvt_pk_bf16_f32 v103, v110, v111
  v_pk_add_f32 v[112:113], v[112:113], v[218:219] op_sel_hi:[1,0]
  s_waitcnt lgkmcnt(4)
  v_mfma_f32_32x32x16_bf16 v[192:207], v[184:187], v[96:99], v[192:207]
  v_pk_add_f32 v[114:115], v[114:115], v[218:219] op_sel_hi:[1,0]
  v_exp_f32 v112, v112
  v_exp_f32 v113, v113
  v_exp_f32 v114, v114
  v_mfma_f32_32x32x16_bf16 v[192:207], v[188:191], v[100:103], v[192:207]
  ds_read_b64_tr_b16 v[184:185], v222 offset:12288
  ds_read_b64_tr_b16 v[186:187], v222 offset:12672
  ds_read_b64_tr_b16 v[188:189], v222 offset:13056
  ds_read_b64_tr_b16 v[190:191], v222 offset:13440
  v_exp_f32 v115, v115
  v_pk_add_f32 v[116:117], v[116:117], v[218:219] op_sel_hi:[1,0]
  v_pk_add_f32 v[118:119], v[118:119], v[218:219] op_sel_hi:[1,0]
  v_exp_f32 v116, v116
  v_exp_f32 v117, v117
  v_exp_f32 v118, v118
  v_exp_f32 v119, v119
  v_cvt_pk_bf16_f32 v112, v112, v113
  v_cvt_pk_bf16_f32 v113, v114, v115
  v_pk_add_f32 v[120:121], v[120:121], v[218:219] op_sel_hi:[1,0]
  v_pk_add_f32 v[122:123], v[122:123], v[218:219] op_sel_hi:[1,0]
  v_exp_f32 v120, v120
  v_exp_f32 v121, v121
  v_exp_f32 v122, v122
  v_exp_f32 v123, v123
  v_cvt_pk_bf16_f32 v114, v116, v117
  v_cvt_pk_bf16_f32 v115, v118, v119
  v_pk_add_f32 v[124:125], v[124:125], v[218:219] op_sel_hi:[1,0]
  v_pk_add_f32 v[126:127], v[126:127], v[218:219] op_sel_hi:[1,0]
  v_exp_f32 v124, v124
  v_exp_f32 v125, v125
  v_exp_f32 v126, v126
  v_exp_f32 v127, v127
  v_cvt_pk_bf16_f32 v116, v120, v121
  v_cvt_pk_bf16_f32 v117, v122, v123
  v_cvt_pk_bf16_f32 v118, v124, v125
  v_cvt_pk_bf16_f32 v119, v126, v127
  v_pk_add_f32 v[128:129], v[128:129], v[218:219] op_sel_hi:[1,0]
  s_waitcnt lgkmcnt(4)
  v_mfma_f32_32x32x16_bf16 v[192:207], v[176:179], v[112:115], v[192:207]
  v_pk_add_f32 v[130:131], v[130:131], v[218:219] op_sel_hi:[1,0]
  v_exp_f32 v128, v128
  v_exp_f32 v129, v129
  v_exp_f32 v130, v130
  v_mfma_f32_32x32x16_bf16 v[192:207], v[180:183], v[116:119], v[192:207]
  ds_read_b64_tr_b16 v[176:177], v222 offset:0
  ds_read_b64_tr_b16 v[178:179], v222 offset:384
  ds_read_b64_tr_b16 v[180:181], v222 offset:768
  ds_read_b64_tr_b16 v[182:183], v222 offset:1152
  v_exp_f32 v131, v131
  v_pk_add_f32 v[132:133], v[132:133], v[218:219] op_sel_hi:[1,0]
  v_pk_add_f32 v[134:135], v[134:135], v[218:219] op_sel_hi:[1,0]
  v_exp_f32 v132, v132
  v_exp_f32 v133, v133
  v_exp_f32 v134, v134
  v_exp_f32 v135, v135
  v_cvt_pk_bf16_f32 v128, v128, v129
  v_cvt_pk_bf16_f32 v129, v130, v131
  v_pk_add_f32 v[136:137], v[136:137], v[218:219] op_sel_hi:[1,0]
  v_pk_add_f32 v[138:139], v[138:139], v[218:219] op_sel_hi:[1,0]
  v_exp_f32 v136, v136
  v_exp_f32 v137, v137
  v_exp_f32 v138, v138
  v_exp_f32 v139, v139
  v_cvt_pk_bf16_f32 v130, v132, v133
  v_cvt_pk_bf16_f32 v131, v134, v135
  v_pk_add_f32 v[140:141], v[140:141], v[218:219] op_sel_hi:[1,0]
  v_pk_add_f32 v[142:143], v[142:143], v[218:219] op_sel_hi:[1,0]
  v_exp_f32 v140, v140
  v_exp_f32 v141, v141
  v_exp_f32 v142, v142
  v_exp_f32 v143, v143
  v_cvt_pk_bf16_f32 v132, v136, v137
  v_cvt_pk_bf16_f32 v133, v138, v139
  v_cvt_pk_bf16_f32 v134, v140, v141
  v_cvt_pk_bf16_f32 v135, v142, v143
  v_and_b32 v8, v208, v128
  v_and_b32 v9, v209, v129
  v_and_b32 v10, v210, v130
  v_and_b32 v11, v211, v131
  v_and_b32 v12, v212, v132
  v_and_b32 v13, v213, v133
  v_and_b32 v14, v214, v134
  v_and_b32 v15, v215, v135
  v_xor_b32 v0, v128, v8
  v_xor_b32 v1, v129, v9
  v_xor_b32 v2, v130, v10
  v_xor_b32 v3, v131, v11
  v_xor_b32 v4, v132, v12
  v_xor_b32 v5, v133, v13
  v_xor_b32 v6, v134, v14
  v_xor_b32 v7, v135, v15
  s_waitcnt lgkmcnt(4)
  v_mfma_f32_32x32x16_bf16 v[192:207], v[184:187], v[8:11], v[192:207]
  v_mfma_f32_32x32x16_bf16 v[192:207], v[188:191], v[12:15], v[192:207]
  s_waitcnt lgkmcnt(0)
  v_mfma_f32_32x32x16_bf16 v[192:207], v[176:179], v[0:3], v[192:207]
  v_mfma_f32_32x32x16_bf16 v[192:207], v[180:183], v[4:7], v[192:207]
  s_nop 11
  v_mov_b32 v224, v200
  v_mov_b32 v225, v200
  s_nop 1
  v_permlane32_swap_b32 v224, v225
  s_nop 1
  s_branch L_attnorm_P
L_attfb_H:
  ds_read_b128 v[152:155], v220 offset:0
  ds_read_b64 v[156:157], v221 offset:2048
  v_mov_b32 v158, s70
  ds_read_b128 v[160:163], v220 offset:20480
  ds_read_b64 v[164:165], v221 offset:22528
  v_mov_b32 v166, 0
  ds_read_b128 v[168:171], v220 offset:2560
  ds_read_b64 v[172:173], v221 offset:4608
  v_mov_b32 v174, s71
  s_waitcnt lgkmcnt(4)
  v_mfma_f32_32x32x16_bf16 v[0:15], v[152:155], v[144:147], 0
  v_mfma_f32_32x32x16_bf16 v[0:15], v[156:159], v[148:151], v[0:15]
  ds_read_b128 v[152:155], v220 offset:5120
  ds_read_b64 v[156:157], v221 offset:7168
  v_mov_b32 v158, s72
  s_waitcnt lgkmcnt(4)
  v_mfma_f32_32x32x16_bf16 v[128:143], v[160:163], v[144:147], 0
  v_mfma_f32_32x32x16_bf16 v[128:143], v[164:167], v[148:151], v[128:143]
  ds_read_b128 v[160:163], v220 offset:7680
  ds_read_b64 v[164:165], v221 offset:9728
  v_mov_b32 v166, s73
  s_waitcnt lgkmcnt(4)
  v_mfma_f32_32x32x16_bf16 v[16:31], v[168:171], v[144:147], 0
  v_mfma_f32_32x32x16_bf16 v[16:31], v[172:175], v[148:151], v[16:31]
  ds_read_b128 v[168:171], v220 offset:10240
  ds_read_b64 v[172:173], v221 offset:12288
  v_mov_b32 v174, s74
  s_waitcnt lgkmcnt(4)
  v_mfma_f32_32x32x16_bf16 v[32:47], v[152:155], v[144:147], 0
  v_cndmask_b32 v128, v0, v128, s[32:33]
  v_cndmask_b32 v129, v1, v129, s[34:35]
  v_cndmask_b32 v130, v2, v130, s[36:37]
  v_cndmask_b32 v131, v3, v131, s[38:39]
  v_cndmask_b32 v132, v4, v132, s[40:41]
  v_cndmask_b32 v133, v5, v133, s[42:43]
  v_mfma_f32_32x32x16_bf16 v[32:47], v[156:159], v[148:151], v[32:47]
  v_cndmask_b32 v134, v6, v134, s[44:45]
  v_cndmask_b32 v135, v7, v135, s[46:47]
  v_cndmask_b32 v136, v8, v136, s[48:49]
  v_cndmask_b32 v137, v9, v137, s[50:51]
  v_cndmask_b32 v138, v10, v138, s[52:53]
  v_cndmask_b32 v139, v11, v139, s[54:55]
  ds_read_b128 v[152:155], v220 offset:12800
  ds_read_b64 v[156:157], v221 offset:14848
  v_mov_b32 v158, s75
  s_waitcnt lgkmcnt(4)
  v_mfma_f32_32x32x16_bf16 v[48:63], v[160:163], v[144:147], 0
  v_cndmask_b32 v140, v12, v140, s[56:57]
  v_cndmask_b32 v141, v13, v141, s[58:59]
  v_cndmask_b32 v142, v14, v142, s[60:61]
  v_cndmask_b32 v143, v15, v143, s[62:63]
  v_max_f32 v216, v128, v129
  v_max3_f32 v216, v130, v131, v216
  v_mfma_f32_32x32x16_bf16 v[48:63], v[164:167], v[148:151], v[48:63]
  v_max3_f32 v216, v132, v133, v216
  v_max3_f32 v216, v134, v135, v216
  v_max3_f32 v216, v136, v137, v216
  v_max3_f32 v216, v138, v139, v216
  v_max3_f32 v216, v140, v141, v216
  v_max3_f32 v216, v142, v143, v216
  ds_read_b128 v[160:163], v220 offset:15360
  ds_read_b64 v[164:165], v221 offset:17408
  v_mov_b32 v166, s76
  s_waitcnt lgkmcnt(4)
  v_mfma_f32_32x32x16_bf16 v[64:79], v[168:171], v[144:147], 0
  v_max3_f32 v216, v16, v17, v216
  v_max3_f32 v216, v18, v19, v216
  v_max3_f32 v216, v20, v21, v216
  v_max3_f32 v216, v22, v23, v216
  v_max3_f32 v216, v24, v25, v216
  v_max3_f32 v216, v26, v27, v216
  v_mfma_f32_32x32x16_bf16 v[64:79], v[172:175], v[148:151], v[64:79]
  v_max3_f32 v216, v28, v29, v216
  v_max3_f32 v216, v30, v31, v216
  v_max3_f32 v216, v32, v33, v216
  v_max3_f32 v216, v34, v35, v216
  v_max3_f32 v216, v36, v37, v216
  v_max3_f32 v216, v38, v39, v216
  ds_read_b128 v[168:171], v220 offset:17920
  ds_read_b64 v[172:173], v221 offset:19968
  v_mov_b32 v174, s77
  s_waitcnt lgkmcnt(4)
  v_mfma_f32_32x32x16_bf16 v[80:95], v[152:155], v[144:147], 0
  v_max3_f32 v216, v40, v41, v216
  v_max3_f32 v216, v42, v43, v216
  v_max3_f32 v216, v44, v45, v216
  v_max3_f32 v216, v46, v47, v216
  v_max3_f32 v216, v48, v49, v216
  v_max3_f32 v216, v50, v51, v216
  v_mfma_f32_32x32x16_bf16 v[80:95], v[156:159], v[148:151], v[80:95]
  v_max3_f32 v216, v52, v53, v216
  v_max3_f32 v216, v54, v55, v216
  v_max3_f32 v216, v56, v57, v216
  v_max3_f32 v216, v58, v59, v216
  v_max3_f32 v216, v60, v61, v216
  v_max3_f32 v216, v62, v63, v216
  s_waitcnt lgkmcnt(2)
  v_mfma_f32_32x32x16_bf16 v[96:111], v[160:163], v[144:147], 0
  v_max3_f32 v216, v64, v65, v216
  v_max3_f32 v216, v66, v67, v216
  v_max3_f32 v216, v68, v69, v216
  v_max3_f32 v216, v70, v71, v216
  v_max3_f32 v216, v72, v73, v216
  v_max3_f32 v216, v74, v75, v216
  v_mfma_f32_32x32x16_bf16 v[96:111], v[164:167], v[148:151], v[96:111]
  v_max3_f32 v216, v76, v77, v216
  v_max3_f32 v216, v78, v79, v216
  s_waitcnt lgkmcnt(0)
  v_mfma_f32_32x32x16_bf16 v[112:127], v[168:171], v[144:147], 0
  v_max3_f32 v216, v80, v81, v216
  v_max3_f32 v216, v82, v83, v216
  v_max3_f32 v216, v84, v85, v216
  v_max3_f32 v216, v86, v87, v216
  v_max3_f32 v216, v88, v89, v216
  v_max3_f32 v216, v90, v91, v216
  v_mfma_f32_32x32x16_bf16 v[112:127], v[172:175], v[148:151], v[112:127]
  v_max3_f32 v216, v92, v93, v216
  v_max3_f32 v216, v94, v95, v216
  v_max3_f32 v216, v96, v97, v216
  v_max3_f32 v216, v98, v99, v216
  v_max3_f32 v216, v100, v101, v216
  v_max3_f32 v216, v102, v103, v216
  v_max3_f32 v216, v104, v105, v216
  v_max3_f32 v216, v106, v107, v216
  v_max3_f32 v216, v108, v109, v216
  v_max3_f32 v216, v110, v111, v216
  s_nop 1
  v_max3_f32 v216, v112, v113, v216
  v_max3_f32 v216, v114, v115, v216
  v_max3_f32 v216, v116, v117, v216
  v_max3_f32 v216, v118, v119, v216
  v_max3_f32 v216, v120, v121, v216
  v_max3_f32 v216, v122, v123, v216
  v_max3_f32 v216, v124, v125, v216
  v_max3_f32 v216, v126, v127, v216
  v_mov_b32 v217, v216
  s_nop 1
  v_permlane32_swap_b32 v216, v217
  v_max_f32 v216, v216, v217
  v_sub_f32 v218, 0, v216
  ds_read_b64_tr_b16 v[176:177], v222 offset:1536
  ds_read_b64_tr_b16 v[178:179], v222 offset:1920
  ds_read_b64_tr_b16 v[180:181], v222 offset:2304
  ds_read_b64_tr_b16 v[182:183], v222 offset:2688
  ds_read_b64_tr_b16 v[184:185], v222 offset:3072
  ds_read_b64_tr_b16 v[186:187], v222 offset:3456
  ds_read_b64_tr_b16 v[188:189], v222 offset:3840
  ds_read_b64_tr_b16 v[190:191], v222 offset:4224
  v_pk_add_f32 v[16:17], v[16:17], v[218:219] op_sel_hi:[1,0]
  v_pk_add_f32 v[18:19], v[18:19], v[218:219] op_sel_hi:[1,0]
  v_exp_f32 v16, v16
  v_exp_f32 v17, v17
  v_exp_f32 v18, v18
  v_exp_f32 v19, v19
  v_pk_add_f32 v[20:21], v[20:21], v[218:219] op_sel_hi:[1,0]
  v_pk_add_f32 v[22:23], v[22:23], v[218:219] op_sel_hi:[1,0]
  v_exp_f32 v20, v20
  v_exp_f32 v21, v21
  v_exp_f32 v22, v22
  v_exp_f32 v23, v23
  v_cvt_pk_bf16_f32 v16, v16, v17
  v_cvt_pk_bf16_f32 v17, v18, v19
  v_pk_add_f32 v[24:25], v[24:25], v[218:219] op_sel_hi:[1,0]
  v_pk_add_f32 v[26:27], v[26:27], v[218:219] op_sel_hi:[1,0]
  v_exp_f32 v24, v24
  v_exp_f32 v25, v25
  v_exp_f32 v26, v26
  v_exp_f32 v27, v27
  v_cvt_pk_bf16_f32 v18, v20, v21
  v_cvt_pk_bf16_f32 v19, v22, v23
  v_pk_add_f32 v[28:29], v[28:29], v[218:219] op_sel_hi:[1,0]
  v_pk_add_f32 v[30:31], v[30:31], v[218:219] op_sel_hi:[1,0]
  v_exp_f32 v28, v28
  v_exp_f32 v29, v29
  v_exp_f32 v30, v30
  v_exp_f32 v31, v31
  v_cvt_pk_bf16_f32 v20, v24, v25
  v_cvt_pk_bf16_f32 v21, v26, v27
  v_cvt_pk_bf16_f32 v22, v28, v29
  v_cvt_pk_bf16_f32 v23, v30, v31
  v_pk_add_f32 v[32:33], v[32:33], v[218:219] op_sel_hi:[1,0]
  s_waitcnt lgkmcnt(4)
  v_mfma_f32_32x32x16_bf16 v[192:207], v[176:179], v[16:19], 0
  v_pk_add_f32 v[34:35], v[34:35], v[218:219] op_sel_hi:[1,0]
  v_exp_f32 v32, v32
  v_exp_f32 v33, v33
  v_exp_f32 v34, v34
  v_mfma_f32_32x32x16_bf16 v[192:207], v[180:183], v[20:23], v[192:207]
  ds_read_b64_tr_b16 v[176:177], v222 offset:4608
  ds_read_b64_tr_b16 v[178:179], v222 offset:4992
  ds_read_b64_tr_b16 v[180:181], v222 offset:5376
  ds_read_b64_tr_b16 v[182:183], v222 offset:5760
  v_exp_f32 v35, v35
  v_pk_add_f32 v[36:37], v[36:37], v[218:219] op_sel_hi:[1,0]
  v_pk_add_f32 v[38:39], v[38:39], v[218:219] op_sel_hi:[1,0]
  v_exp_f32 v36, v36
  v_exp_f32 v37, v37
  v_exp_f32 v38, v38
  v_exp_f32 v39, v39
  v_cvt_pk_bf16_f32 v32, v32, v33
  v_cvt_pk_bf16_f32 v33, v34, v35
  v_pk_add_f32 v[40:41], v[40:41], v[218:219] op_sel_hi:[1,0]
  v_pk_add_f32 v[42:43], v[42:43], v[218:219] op_sel_hi:[1,0]
  v_exp_f32 v40, v40
  v_exp_f32 v41, v41
  v_exp_f32 v42, v42
  v_exp_f32 v43, v43
  v_cvt_pk_bf16_f32 v34, v36, v37
  v_cvt_pk_bf16_f32 v35, v38, v39
  v_pk_add_f32 v[44:45], v[44:45], v[218:219] op_sel_hi:[1,0]
  v_pk_add_f32 v[46:47], v[46:47], v[218:219] op_sel_hi:[1,0]
  v_exp_f32 v44, v44
  v_exp_f32 v45, v45
  v_exp_f32 v46, v46
  v_exp_f32 v47, v47
  v_cvt_pk_bf16_f32 v36, v40, v41
  v_cvt_pk_bf16_f32 v37, v42, v43
  v_cvt_pk_bf16_f32 v38, v44, v45
  v_cvt_pk_bf16_f32 v39, v46, v47
  v_pk_add_f32 v[48:49], v[48:49], v[218:219] op_sel_hi:[1,0]
  s_waitcnt lgkmcnt(4)
  v_mfma_f32_32x32x16_bf16 v[192:207], v[184:187], v[32:35], v[192:207]
  v_pk_add_f32 v[50:51], v[50:51], v[218:219] op_sel_hi:[1,0]
  v_exp_f32 v48, v48
  v_exp_f32 v49, v49
  v_exp_f32 v50, v50
  v_mfma_f32_32x32x16_bf16 v[192:207], v[188:191], v[36:39], v[192:207]
  ds_read_b64_tr_b16 v[184:185], v222 offset:6144
  ds_read_b64_tr_b16 v[186:187], v222 offset:6528
  ds_read_b64_tr_b16 v[188:189], v222 offset:6912
  ds_read_b64_tr_b16 v[190:191], v222 offset:7296
  v_exp_f32 v51, v51
  v_pk_add_f32 v[52:53], v[52:53], v[218:219] op_sel_hi:[1,0]
  v_pk_add_f32 v[54:55], v[54:55], v[218:219] op_sel_hi:[1,0]
  v_exp_f32 v52, v52
  v_exp_f32 v53, v53
  v_exp_f32 v54, v54
  v_exp_f32 v55, v55
  v_cvt_pk_bf16_f32 v48, v48, v49
  v_cvt_pk_bf16_f32 v49, v50, v51
  v_pk_add_f32 v[56:57], v[56:57], v[218:219] op_sel_hi:[1,0]
  v_pk_add_f32 v[58:59], v[58:59], v[218:219] op_sel_hi:[1,0]
  v_exp_f32 v56, v56
  v_exp_f32 v57, v57
  v_exp_f32 v58, v58
  v_exp_f32 v59, v59
  v_cvt_pk_bf16_f32 v50, v52, v53
  v_cvt_pk_bf16_f32 v51, v54, v55
  v_pk_add_f32 v[60:61], v[60:61], v[218:219] op_sel_hi:[1,0]
  v_pk_add_f32 v[62:63], v[62:63], v[218:219] op_sel_hi:[1,0]
  v_exp_f32 v60, v60
  v_exp_f32 v61, v61
  v_exp_f32 v62, v62
  v_exp_f32 v63, v63
  v_cvt_pk_bf16_f32 v52, v56, v57
  v_cvt_pk_bf16_f32 v53, v58, v59
  v_cvt_pk_bf16_f32 v54, v60, v61
  v_cvt_pk_bf16_f32 v55, v62, v63
  v_pk_add_f32 v[64:65], v[64:65], v[218:219] op_sel_hi:[1,0]
  s_waitcnt lgkmcnt(4)
  v_mfma_f32_32x32x16_bf16 v[192:207], v[176:179], v[48:51], v[192:207]
  v_pk_add_f32 v[66:67], v[66:67], v[218:219] op_sel_hi:[1,0]
  v_exp_f32 v64, v64
  v_exp_f32 v65, v65
  v_exp_f32 v66, v66
  v_mfma_f32_32x32x16_bf16 v[192:207], v[180:183], v[52:55], v[192:207]
  ds_read_b64_tr_b16 v[176:177], v222 offset:7680
  ds_read_b64_tr_b16 v[178:179], v222 offset:8064
  ds_read_b64_tr_b16 v[180:181], v222 offset:8448
  ds_read_b64_tr_b16 v[182:183], v222 offset:8832
  v_exp_f32 v67, v67
  v_pk_add_f32 v[68:69], v[68:69], v[218:219] op_sel_hi:[1,0]
  v_pk_add_f32 v[70:71], v[70:71], v[218:219] op_sel_hi:[1,0]
  v_exp_f32 v68, v68
  v_exp_f32 v69, v69
  v_exp_f32 v70, v70
  v_exp_f32 v71, v71
  v_cvt_pk_bf16_f32 v64, v64, v65
  v_cvt_pk_bf16_f32 v65, v66, v67
  v_pk_add_f32 v[72:73], v[72:73], v[218:219] op_sel_hi:[1,0]
  v_pk_add_f32 v[74:75], v[74:75], v[218:219] op_sel_hi:[1,0]
  v_exp_f32 v72, v72
  v_exp_f32 v73, v73
  v_exp_f32 v74, v74
  v_exp_f32 v75, v75
  v_cvt_pk_bf16_f32 v66, v68, v69
  v_cvt_pk_bf16_f32 v67, v70, v71
  v_pk_add_f32 v[76:77], v[76:77], v[218:219] op_sel_hi:[1,0]
  v_pk_add_f32 v[78:79], v[78:79], v[218:219] op_sel_hi:[1,0]
  v_exp_f32 v76, v76
  v_exp_f32 v77, v77
  v_exp_f32 v78, v78
  v_exp_f32 v79, v79
  v_cvt_pk_bf16_f32 v68, v72, v73
  v_cvt_pk_bf16_f32 v69, v74, v75
  v_cvt_pk_bf16_f32 v70, v76, v77
  v_cvt_pk_bf16_f32 v71, v78, v79
  v_pk_add_f32 v[80:81], v[80:81], v[218:219] op_sel_hi:[1,0]
  s_waitcnt lgkmcnt(4)
  v_mfma_f32_32x32x16_bf16 v[192:207], v[184:187], v[64:67], v[192:207]
  v_pk_add_f32 v[82:83], v[82:83], v[218:219] op_sel_hi:[1,0]
  v_exp_f32 v80, v80
  v_exp_f32 v81, v81
  v_exp_f32 v82, v82
  v_mfma_f32_32x32x16_bf16 v[192:207], v[188:191], v[68:71], v[192:207]
  ds_read_b64_tr_b16 v[184:185], v222 offset:9216
  ds_read_b64_tr_b16 v[186:187], v222 offset:9600
  ds_read_b64_tr_b16 v[188:189], v222 offset:9984
  ds_read_b64_tr_b16 v[190:191], v222 offset:10368
  v_exp_f32 v83, v83
  v_pk_add_f32 v[84:85], v[84:85], v[218:219] op_sel_hi:[1,0]
  v_pk_add_f32 v[86:87], v[86:87], v[218:219] op_sel_hi:[1,0]
  v_exp_f32 v84, v84
  v_exp_f32 v85, v85
  v_exp_f32 v86, v86
  v_exp_f32 v87, v87
  v_cvt_pk_bf16_f32 v80, v80, v81
  v_cvt_pk_bf16_f32 v81, v82, v83
  v_pk_add_f32 v[88:89], v[88:89], v[218:219] op_sel_hi:[1,0]
  v_pk_add_f32 v[90:91], v[90:91], v[218:219] op_sel_hi:[1,0]
  v_exp_f32 v88, v88
  v_exp_f32 v89, v89
  v_exp_f32 v90, v90
  v_exp_f32 v91, v91
  v_cvt_pk_bf16_f32 v82, v84, v85
  v_cvt_pk_bf16_f32 v83, v86, v87
  v_pk_add_f32 v[92:93], v[92:93], v[218:219] op_sel_hi:[1,0]
  v_pk_add_f32 v[94:95], v[94:95], v[218:219] op_sel_hi:[1,0]
  v_exp_f32 v92, v92
  v_exp_f32 v93, v93
  v_exp_f32 v94, v94
  v_exp_f32 v95, v95
  v_cvt_pk_bf16_f32 v84, v88, v89
  v_cvt_pk_bf16_f32 v85, v90, v91
  v_cvt_pk_bf16_f32 v86, v92, v93
  v_cvt_pk_bf16_f32 v87, v94, v95
  v_pk_add_f32 v[96:97], v[96:97], v[218:219] op_sel_hi:[1,0]
  s_waitcnt lgkmcnt(4)
  v_mfma_f32_32x32x16_bf16 v[192:207], v[176:179], v[80:83], v[192:207]
  v_pk_add_f32 v[98:99], v[98:99], v[218:219] op_sel_hi:[1,0]
  v_exp_f32 v96, v96
  v_exp_f32 v97, v97
  v_exp_f32 v98, v98
  v_mfma_f32_32x32x16_bf16 v[192:207], v[180:183], v[84:87], v[192:207]
  ds_read_b64_tr_b16 v[176:177], v222 offset:10752
  ds_read_b64_tr_b16 v[178:179], v222 offset:11136
  ds_read_b64_tr_b16 v[180:181], v222 offset:11520
  ds_read_b64_tr_b16 v[182:183], v222 offset:11904
  v_exp_f32 v99, v99
  v_pk_add_f32 v[100:101], v[100:101], v[218:219] op_sel_hi:[1,0]
  v_pk_add_f32 v[102:103], v[102:103], v[218:219] op_sel_hi:[1,0]
  v_exp_f32 v100, v100
  v_exp_f32 v101, v101
  v_exp_f32 v102, v102
  v_exp_f32 v103, v103
  v_cvt_pk_bf16_f32 v96, v96, v97
  v_cvt_pk_bf16_f32 v97, v98, v99
  v_pk_add_f32 v[104:105], v[104:105], v[218:219] op_sel_hi:[1,0]
  v_pk_add_f32 v[106:107], v[106:107], v[218:219] op_sel_hi:[1,0]
  v_exp_f32 v104, v104
  v_exp_f32 v105, v105
  v_exp_f32 v106, v106
  v_exp_f32 v107, v107
  v_cvt_pk_bf16_f32 v98, v100, v101
  v_cvt_pk_bf16_f32 v99, v102, v103
  v_pk_add_f32 v[108:109], v[108:109], v[218:219] op_sel_hi:[1,0]
  v_pk_add_f32 v[110:111], v[110:111], v[218:219] op_sel_hi:[1,0]
  v_exp_f32 v108, v108
  v_exp_f32 v109, v109
  v_exp_f32 v110, v110
  v_exp_f32 v111, v111
  v_cvt_pk_bf16_f32 v100, v104, v105
  v_cvt_pk_bf16_f32 v101, v106, v107
  v_cvt_pk_bf16_f32 v102, v108, v109
  v_cvt_pk_bf16_f32 v103, v110, v111
  v_pk_add_f32 v[112:113], v[112:113], v[218:219] op_sel_hi:[1,0]
  s_waitcnt lgkmcnt(4)
  v_mfma_f32_32x32x16_bf16 v[192:207], v[184:187], v[96:99], v[192:207]
  v_pk_add_f32 v[114:115], v[114:115], v[218:219] op_sel_hi:[1,0]
  v_exp_f32 v112, v112
  v_exp_f32 v113, v113
  v_exp_f32 v114, v114
  v_mfma_f32_32x32x16_bf16 v[192:207], v[188:191], v[100:103], v[192:207]
  ds_read_b64_tr_b16 v[184:185], v222 offset:12288
  ds_read_b64_tr_b16 v[186:187], v222 offset:12672
  ds_read_b64_tr_b16 v[188:189], v222 offset:13056
  ds_read_b64_tr_b16 v[190:191], v222 offset:13440
  v_exp_f32 v115, v115
  v_pk_add_f32 v[116:117], v[116:117], v[218:219] op_sel_hi:[1,0]
  v_pk_add_f32 v[118:119], v[118:119], v[218:219] op_sel_hi:[1,0]
  v_exp_f32 v116, v116
  v_exp_f32 v117, v117
  v_exp_f32 v118, v118
  v_exp_f32 v119, v119
  v_cvt_pk_bf16_f32 v112, v112, v113
  v_cvt_pk_bf16_f32 v113, v114, v115
  v_pk_add_f32 v[120:121], v[120:121], v[218:219] op_sel_hi:[1,0]
  v_pk_add_f32 v[122:123], v[122:123], v[218:219] op_sel_hi:[1,0]
  v_exp_f32 v120, v120
  v_exp_f32 v121, v121
  v_exp_f32 v122, v122
  v_exp_f32 v123, v123
  v_cvt_pk_bf16_f32 v114, v116, v117
  v_cvt_pk_bf16_f32 v115, v118, v119
  v_pk_add_f32 v[124:125], v[124:125], v[218:219] op_sel_hi:[1,0]
  v_pk_add_f32 v[126:127], v[126:127], v[218:219] op_sel_hi:[1,0]
  v_exp_f32 v124, v124
  v_exp_f32 v125, v125
  v_exp_f32 v126, v126
  v_exp_f32 v127, v127
  v_cvt_pk_bf16_f32 v116, v120, v121
  v_cvt_pk_bf16_f32 v117, v122, v123
  v_cvt_pk_bf16_f32 v118, v124, v125
  v_cvt_pk_bf16_f32 v119, v126, v127
  v_pk_add_f32 v[128:129], v[128:129], v[218:219] op_sel_hi:[1,0]
  s_waitcnt lgkmcnt(4)
  v_mfma_f32_32x32x16_bf16 v[192:207], v[176:179], v[112:115], v[192:207]
  v_pk_add_f32 v[130:131], v[130:131], v[218:219] op_sel_hi:[1,0]
  v_exp_f32 v128, v128
  v_exp_f32 v129, v129
  v_exp_f32 v130, v130
  v_mfma_f32_32x32x16_bf16 v[192:207], v[180:183], v[116:119], v[192:207]
  ds_read_b64_tr_b16 v[176:177], v222 offset:0
  ds_read_b64_tr_b16 v[178:179], v222 offset:384
  ds_read_b64_tr_b16 v[180:181], v222 offset:768
  ds_read_b64_tr_b16 v[182:183], v222 offset:1152
  v_exp_f32 v131, v131
  v_pk_add_f32 v[132:133], v[132:133], v[218:219] op_sel_hi:[1,0]
  v_pk_add_f32 v[134:135], v[134:135], v[218:219] op_sel_hi:[1,0]
  v_exp_f32 v132, v132
  v_exp_f32 v133, v133
  v_exp_f32 v134, v134
  v_exp_f32 v135, v135
  v_cvt_pk_bf16_f32 v128, v128, v129
  v_cvt_pk_bf16_f32 v129, v130, v131
  v_pk_add_f32 v[136:137], v[136:137], v[218:219] op_sel_hi:[1,0]
  v_pk_add_f32 v[138:139], v[138:139], v[218:219] op_sel_hi:[1,0]
  v_exp_f32 v136, v136
  v_exp_f32 v137, v137
  v_exp_f32 v138, v138
  v_exp_f32 v139, v139
  v_cvt_pk_bf16_f32 v130, v132, v133
  v_cvt_pk_bf16_f32 v131, v134, v135
  v_pk_add_f32 v[140:141], v[140:141], v[218:219] op_sel_hi:[1,0]
  v_pk_add_f32 v[142:143], v[142:143], v[218:219] op_sel_hi:[1,0]
  v_exp_f32 v140, v140
  v_exp_f32 v141, v141
  v_exp_f32 v142, v142
  v_exp_f32 v143, v143
  v_cvt_pk_bf16_f32 v132, v136, v137
  v_cvt_pk_bf16_f32 v133, v138, v139
  v_cvt_pk_bf16_f32 v134, v140, v141
  v_cvt_pk_bf16_f32 v135, v142, v143
  v_and_b32 v8, v208, v128
  v_and_b32 v9, v209, v129
  v_and_b32 v10, v210, v130
  v_and_b32 v11, v211, v131
  v_and_b32 v12, v212, v132
  v_and_b32 v13, v213, v133
  v_and_b32 v14, v214, v134
  v_and_b32 v15, v215, v135
  v_xor_b32 v0, v128, v8
  v_xor_b32 v1, v129, v9
  v_xor_b32 v2, v130, v10
  v_xor_b32 v3, v131, v11
  v_xor_b32 v4, v132, v12
  v_xor_b32 v5, v133, v13
  v_xor_b32 v6, v134, v14
  v_xor_b32 v7, v135, v15
  s_waitcnt lgkmcnt(4)
  v_mfma_f32_32x32x16_bf16 v[192:207], v[184:187], v[8:11], v[192:207]
  v_mfma_f32_32x32x16_bf16 v[192:207], v[188:191], v[12:15], v[192:207]
  s_waitcnt lgkmcnt(0)
  v_mfma_f32_32x32x16_bf16 v[192:207], v[176:179], v[0:3], v[192:207]
  v_mfma_f32_32x32x16_bf16 v[192:207], v[180:183], v[4:7], v[192:207]
  s_nop 11
  v_mov_b32 v224, v200
  v_mov_b32 v225, v200
  s_nop 1
  v_permlane32_swap_b32 v224, v225
  s_nop 1
  s_branch L_attnorm_H

.section .rodata,"a"
.p2align 6
.amdhsa_kernel interleave_layers__sliding_block__glu_gated_bilinear__prompt_kernel
  .amdhsa_next_free_vgpr 256
  .amdhsa_next_free_sgpr 102
  .amdhsa_accum_offset 256
  .amdhsa_group_segment_fixed_size 0
  .amdhsa_kernarg_size 80
  .amdhsa_user_sgpr_count 2
  .amdhsa_user_sgpr_kernarg_segment_ptr 1
  .amdhsa_system_sgpr_workgroup_id_x 1
.end_amdhsa_kernel
```
